```python
import torch

def _softmax(x, axis=-1):
    return torch.softmax(x, dim=axis)

def _gelu(x):
    return torch.nn.functional.gelu(x, approximate='tanh')

def _silu(x):
    return torch.nn.functional.silu(x)

def _sigmoid(x):
    return torch.sigmoid(x)

def _layernorm(x, axis=-1, eps=1e-05):
    m = x.mean(dim=axis, keepdim=True)
    v = x.var(dim=axis, keepdim=True, unbiased=False)
    return (x - m) / torch.sqrt(v + eps)

def _scatter_add(tgt, idx, src, axis=0):
    return tgt.clone().index_add_(axis, idx, src)

def _segment_sum(src, seg, n):
    out = torch.zeros((n,) + src.shape[1:], dtype=src.dtype)
    return out.index_add_(0, seg, src)

def _pad(x, pw):
    flat = tuple((v for pair in reversed(pw) for v in pair))
    return torch.nn.functional.pad(x, flat)
kernel_name = 'adaLN_cond__ssm_conv_s4__dense_activation_silu__prompt'

def setup_inputs():

    _w = lambda a: (lambda t: t.to(torch.bfloat16) if t.is_floating_point() else t)(torch.as_tensor(a))

    def _A_setup():
        B, L, D, N = (1, 2048, 640, 192)
        A_re = -(lambda _x: torch.exp(torch.as_tensor(_x)))((lambda *s: torch.randn(*s, dtype=torch.bfloat16) * 3.2)(D, N))
        A_im = torch.pi * (lambda *s: torch.randn(*s, dtype=torch.bfloat16) * 0.05)(D, N)
        B_re = (lambda *s: torch.randn(*s, dtype=torch.bfloat16) * 0.1)(D, N)
        B_im = (lambda *s: torch.randn(*s, dtype=torch.bfloat16) * 0.1)(D, N)
        C_re = (lambda *s: torch.randn(*s, dtype=torch.bfloat16) * 0.1)(D, N)
        C_im = (lambda *s: torch.randn(*s, dtype=torch.bfloat16) * 0.1)(D, N)
        log_dt = (lambda *s: torch.randn(*s, dtype=torch.bfloat16) * 0.05)(D) * 0.5 - 4.0
        Dskip = (lambda *s: torch.randn(*s, dtype=torch.bfloat16) * 0.05)(D)
        return {'u': _w((lambda *s: torch.randn(*s, dtype=torch.bfloat16) * 0.05)(B, L, D)), 'A_re': _w(A_re), 'A_im': _w(A_im), 'B_re': _w(B_re), 'B_im': _w(B_im), 'C_re': _w(C_re), 'C_im': _w(C_im), 'log_dt': _w(log_dt), 'Dskip': _w(Dskip)}
    _A_in = _A_setup()

    def _B_setup():
        B, S, D, F = (1, 2048, 640, 1536)
        return {'x': _w((lambda *s: torch.randn(*s, dtype=torch.bfloat16) * 0.05)(B, S, D)), 'w1': _w((lambda *s: torch.randn(*s, dtype=torch.bfloat16) * 3.2)(D, F) * D ** (-0.5)), 'w2': _w((lambda *s: torch.randn(*s, dtype=torch.bfloat16) * 0.2)(F, D) * F ** (-0.5))}
    _B_in = _B_setup()
    return {'A_u': _A_in['u'], 'A_A_re': _A_in['A_re'], 'A_A_im': _A_in['A_im'], 'A_B_re': _A_in['B_re'], 'A_B_im': _A_in['B_im'], 'A_C_re': _A_in['C_re'], 'A_C_im': _A_in['C_im'], 'A_log_dt': _A_in['log_dt'], 'A_Dskip': _A_in['Dskip'], 'B_x': _B_in['x'], 'B_w1': _B_in['w1'], 'B_w2': _B_in['w2'], 'c': _w((lambda *s: torch.randn(*s, dtype=torch.bfloat16) * 0.2)(1, 640) * 8.0), 'w_mod': _w((lambda *s: torch.randn(*s, dtype=torch.bfloat16) * 0.2)(640, 6 * 640) * 640 ** (-0.5) * 8.0)}

def reference(A_u, A_A_re, A_A_im, A_B_re, A_B_im, A_C_re, A_C_im, A_log_dt, A_Dskip, B_x, B_w1, B_w2, c, w_mod):

    def _A_ref(u, A_re, A_im, B_re, B_im, C_re, C_im, log_dt, Dskip):
        Bsz, L, D = u.shape
        dt = torch.exp(log_dt)[:, None]
        A = A_re + 1j * A_im
        Bc = B_re + 1j * B_im
        Cc = C_re + 1j * C_im
        logdA = dt * A
        dB = dt * Bc
        l = (lambda x, dt: x.to(dt))(torch.arange(L), A_re.dtype)
        P = torch.exp(logdA[:, :, None] * l[None, None, :])
        K = torch.einsum('dn,dnl,dn->dl', Cc, P, dB).real
        L2 = 2 * L
        Kp = _pad(K, ((0, 0), (0, L)))
        up = (lambda x, *d: x.permute(*d))(u, 0, 2, 1)
        up = _pad(up, ((0, 0), (0, 0), (0, L)))
        Kf = (lambda x, axes=(-2, -1): torch.fft.rfft2(x.float(), dim=axes))(Kp[:, None, :], axes=(-2, -1))
        Uf = (lambda x, axes=(-2, -1): torch.fft.rfft2(x.float(), dim=axes))(up[:, :, None, :], axes=(-2, -1))
        Yf = Uf * Kf[None, :, :, :]
        y = (lambda x, s, axes=(-2, -1): torch.fft.irfft2(x, s=s, dim=axes).to(torch.bfloat16))(Yf, (1, L2), axes=(-2, -1))[:, :, 0, :L]
        y = (lambda x, *d: x.permute(*d))(y, 0, 2, 1) + u * Dskip[None, None, :]
        return y

    def _B_ref(x, w1, w2):
        h = torch.einsum('bsd,df->bsf', x, w1)
        h = _silu(h)
        out = torch.einsum('bsf,fd->bsd', h, w2)
        return out
    x = A_u
    mod = (_silu(c) @ w_mod).reshape(c.shape[0], 6, 1, -1)
    sa, ca, ga, sb, cb, gb = (mod[:, 0].clone(), mod[:, 1].clone(), mod[:, 2].clone(), mod[:, 3].clone(), mod[:, 4].clone(), mod[:, 5].clone())
    h = _layernorm(x, axis=-1) * (1 + ca) + sa
    x = x + ga * _A_ref(h, A_A_re, A_A_im, A_B_re, A_B_im, A_C_re, A_C_im, A_log_dt, A_Dskip)
    h = _layernorm(x, axis=-1) * (1 + cb) + sb
    x = x + gb * _B_ref(h, B_w1, B_w2)
    return x
```

```asm
; @launch grid=(256,1,1) block=(256,1,1) lds=163840
.amdgcn_target "amdgcn-amd-amdhsa--gfx950"
.text
.globl adaLN_cond__ssm_conv_s4__dense_activation_silu__prompt_kernel
.p2align 8
.type adaLN_cond__ssm_conv_s4__dense_activation_silu__prompt_kernel,@function
adaLN_cond__ssm_conv_s4__dense_activation_silu__prompt_kernel:
    s_cmp_ge_u32 s2, 256
    s_cbranch_scc1 L_EXIT
    s_load_dwordx16 s[16:31], s[0:1], 0
    s_load_dwordx16 s[32:47], s[0:1], 64
    s_load_dwordx2 s[48:49], s[0:1], 128
    s_getpc_b64 s[4:5]
L_PC:
    v_and_b32 v4, 0xc0, v0
    s_lshr_b32 s8, s2, 3
    s_lshl_b32 s8, s8, 9
    v_lshl_add_u32 v4, v4, 1, s8
    v_and_b32 v5, 63, v0
    v_min_u32 v5, 2, v5
    v_lshl_add_u32 v4, v5, 14, v4
    v_min_u32 v4, L_CODE_END-L_PC-4, v4
    global_load_dword v253, v4, s[4:5]
    v_and_b32 v1, 63, v0
    v_lshrrev_b32 v2, 6, v0
    v_lshlrev_b32 v3, 4, v0
    v_readfirstlane_b32 s3, v2
    v_lshlrev_b32 v2, 4, v1
    s_mul_i32 s6, s2, 10240
    v_add_u32 v3, s6, v3
    s_lshl_b32 s7, s3, 10
    s_add_u32 s7, s7, 113664
    s_mov_b32 m0, s7
    s_and_b32 s8, s2, 7
    s_mul_i32 s51, s8, 27
    s_lshr_b32 s9, s2, 3
    s_add_u32 s51, s51, s9
    s_cmp_eq_u32 s8, 7
    s_cselect_b32 s8, 1, 0
    s_sub_u32 s51, s51, s8
    s_mul_i32 s51, s51, 3
    v_pk_mov_b32 v[4:5], 0, 0
    v_pk_mov_b32 v[6:7], 0, 0
    s_nop 1
    v_mfma_f32_32x32x16_bf16 v[48:63], v[4:7], v[4:7], 0
    v_mfma_f32_32x32x16_bf16 v[96:111], v[4:7], v[4:7], 0
    v_mfma_f32_32x32x16_bf16 v[112:127], v[4:7], v[4:7], 0
    v_mfma_f32_32x32x16_bf16 v[204:219], v[4:7], v[4:7], 0
    v_mfma_f32_32x32x16_bf16 v[236:251], v[4:7], v[4:7], 0
    v_pk_mov_b32 v[234:235], 0, 0
    s_waitcnt lgkmcnt(0)
    s_load_dword s50, s[48:49], 0
    global_load_lds_dwordx4 v3, s[16:17]
    s_add_u32 m0, s7, 4096
    v_add_u32 v3, 4096, v3
    global_load_lds_dwordx4 v3, s[16:17]
    s_cmp_ge_u32 s3, 2
    s_cbranch_scc1 L_X2
    s_add_u32 m0, s7, 8192
    v_add_u32 v3, 4096, v3
    global_load_lds_dwordx4 v3, s[16:17]
L_X2:
    v_mov_b32 v20, 0
    v_mov_b32 v21, 0
    v_mov_b32 v22, 0
    v_mov_b32 v23, 0
    v_lshlrev_b32 v24, 4, v0
    v_cmp_gt_u32 vcc, 90, v0
    v_add_u32 v24, 99936, v24
    v_mov_b32 v25, 126016
    v_cndmask_b32 v24, v25, v24, vcc
    ds_write_b128 v24, v[20:23]
    v_lshrrev_b32 v4, 5, v1
    s_lshl_b32 s6, s3, 1
    v_add_u32 v4, s6, v4
    v_mul_u32_u24 v5, 1280, v4
    v_and_b32 v6, 31, v1
    v_lshl_add_u32 v5, v6, 3, v5
    v_add_u32 v61, 113664, v5
    v_lshlrev_b32 v4, 2, v4
    v_add_u32 v60, 125952, v4
    v_bfe_u32 v26, v1, 2, 2
    v_mul_u32_u24 v26, 1280, v26
    v_lshrrev_b32 v27, 4, v1
    v_lshl_add_u32 v26, v27, 5, v26
    v_and_b32 v27, 3, v1
    v_lshl_add_u32 v26, v27, 3, v26
    v_add_u32 v62, 113664, v26
    v_lshrrev_b32 v63, 2, v1
    v_mul_u32_u24 v63, 16512, v63
    v_lshl_add_u32 v63, v27, 4, v63
    s_lshl_b32 s6, s2, 6
    s_add_u32 s6, s6, 1048576
    v_add_u32 v63, s6, v63
    s_and_b32 s6, s2, 7
    s_lshr_b32 s7, s2, 3
    s_lshr_b32 s61, s6, 0
    s_lshl_b32 s61, s61, 2
    s_lshr_b32 s8, s7, 3
    s_add_u32 s61, s61, s8
    s_and_b32 s62, s6, 0
    s_lshl_b32 s62, s62, 3
    s_and_b32 s8, s7, 7
    s_add_u32 s62, s62, s8
    s_lshl_b32 s63, s61, 3
    s_add_u32 s63, s63, s62
    s_lshl_b32 s6, s62, 2
    s_add_u32 s6, s6, s3
    s_mul_i32 s6, s6, 61440
    s_add_u32 s7, s6, 6426624
    s_add_u32 s64, s48, s7
    s_addc_u32 s65, s49, 0
    s_add_u32 s7, s6, 8392704
    s_add_u32 s66, s48, s7
    s_addc_u32 s67, s49, 0
    s_cmp_eq_u32 s3, 3
    s_cbranch_scc1 L_W3_LOADS
    s_cmp_ge_u32 s2, 214
    s_cbranch_scc1 L_SIDE_LOADS
    s_add_u32 s52, s51, s3
    s_min_u32 s52, s52, 639
    s_mul_i32 s6, s52, 384
    v_lshl_add_u32 v4, v1, 2, s6
    v_lshl_add_u32 v5, v1, 1, s6
    s_lshr_b32 s7, s52, 1
    s_lshl_b32 s7, s7, 2
    s_load_dword s53, s[30:31], s7
    global_load_dword v8, v4, s[18:19]
    global_load_dword v9, v4, s[20:21]
    global_load_dword v10, v4, s[22:23]
    global_load_dword v11, v4, s[24:25]
    global_load_dword v12, v4, s[26:27]
    global_load_dword v13, v4, s[28:29]
    global_load_ushort v14, v5, s[18:19] offset:256
    global_load_ushort v15, v5, s[20:21] offset:256
    global_load_ushort v16, v5, s[22:23] offset:256
    global_load_ushort v17, v5, s[24:25] offset:256
    global_load_ushort v18, v5, s[26:27] offset:256
    global_load_ushort v19, v5, s[28:29] offset:256
    s_mul_i32 s6, s3, 2720
    s_add_u32 s6, s6, 126992
    v_and_b32 v20, 31, v1
    v_lshrrev_b32 v21, 5, v1
    v_lshlrev_b32 v216, 5, v20
    v_lshl_add_u32 v216, v21, 4, v216
    v_add_u32 v216, s6, v216
    v_lshl_add_u32 v217, v20, 4, s6
    v_lshl_add_u32 v218, v20, 3, s6
    v_lshl_add_u32 v219, v20, 2, s6
    v_lshlrev_b32 v20, 1, v1
    v_sub_u32 v20, 125, v20
    v_lshl_add_u32 v220, v20, 2, s6
    s_sub_u32 s7, s6, 4
    v_mov_b32 v22, s7
    v_mov_b32 v23, 0
    ds_write_b32 v22, v23
    s_add_u32 s7, s6, 4294899200
    v_add_u32 v221, 256, v20
    v_cvt_f32_u32 v221, v221
    v_cvt_pk_bf16_f32 v221, v221, 0
    v_lshl_add_u32 v221, v221, 2, s7
    v_add_u32 v222, 257, v20
    v_cvt_f32_u32 v222, v222
    v_cvt_pk_bf16_f32 v222, v222, 0
    v_lshl_add_u32 v222, v222, 2, s7
    v_add_u32 v223, 258, v20
    v_cvt_f32_u32 v223, v223
    v_cvt_pk_bf16_f32 v223, v223, 0
    v_lshl_add_u32 v223, v223, 2, s7
    v_add_u32 v224, 384, v20
    v_cvt_f32_u32 v224, v224
    v_cvt_pk_bf16_f32 v224, v224, 0
    v_lshl_add_u32 v224, v224, 2, s7
    v_add_u32 v225, 385, v20
    v_cvt_f32_u32 v225, v225
    v_cvt_pk_bf16_f32 v225, v225, 0
    v_lshl_add_u32 v225, v225, 2, s7
    v_add_u32 v226, 386, v20
    v_cvt_f32_u32 v226, v226
    v_cvt_pk_bf16_f32 v226, v226, 0
    v_lshl_add_u32 v226, v226, 2, s7
    v_add_u32 v227, 512, v20
    v_cvt_f32_u32 v227, v227
    v_cvt_pk_bf16_f32 v227, v227, 0
    v_add_u32 v228, 514, v20
    v_cvt_f32_u32 v228, v228
    v_cvt_pk_bf16_f32 v228, v228, 0
    v_add_u32 v229, 513, v20
    v_cvt_f32_u32 v229, v229
    v_cvt_pk_bf16_f32 v229, v229, 0
    v_sub_u32 v228, v228, v227
    v_sub_u32_e64 v229, v229, v227
    v_lshl_add_u32 v227, v227, 2, s7
    v_mul_u32_u24 v228, 0x0404, v228
    v_mul_u32_u24 v229, 0x0404, v229
    v_lshl_add_u32 v228, v229, 16, v228
    v_add_u32 v228, 0x01000100, v228
    v_add_u32 v229, 0x01000100, v229
    v_add_u32 v230, 1024, v20
    v_cvt_f32_u32 v230, v230
    v_cvt_pk_bf16_f32 v230, v230, 0
    v_add_u32 v231, 1026, v20
    v_cvt_f32_u32 v231, v231
    v_cvt_pk_bf16_f32 v231, v231, 0
    v_add_u32 v232, 1025, v20
    v_cvt_f32_u32 v232, v232
    v_cvt_pk_bf16_f32 v232, v232, 0
    v_sub_u32 v231, v231, v230
    v_sub_u32_e64 v232, v232, v230
    v_lshl_add_u32 v230, v230, 2, s7
    v_mul_u32_u24 v231, 0x0404, v231
    v_mul_u32_u24 v232, 0x0404, v232
    v_lshl_add_u32 v231, v232, 16, v231
    v_add_u32 v231, 0x01000100, v231
    v_add_u32 v232, 0x01000100, v232
    v_lshrrev_b32 v21, 3, v1
    v_and_b32 v22, 1, v21
    v_lshrrev_b32 v23, 2, v21
    v_lshl_add_u32 v22, v22, 1, v23
    v_mul_u32_u24 v22, 4128, v22
    v_bfe_u32 v23, v21, 1, 1
    v_mul_u32_u24 v23, 49792, v23
    v_add_u32 v22, v22, v23
    v_lshrrev_b32 v21, 1, v21
    v_and_b32 v23, 7, v1
    v_min_u32 v23, 6, v23
    v_add_u32 v21, v21, v23
    v_lshl_add_u32 v22, v21, 2, v22
    s_mul_i32 s6, s3, 16528
    s_add_u32 s6, s6, 4100
    v_add_u32 v233, s6, v22
    v_and_b32 v20, 7, v1
    v_and_b32 v21, 1, v20
    v_lshrrev_b32 v22, 2, v20
    v_lshl_add_u32 v21, v21, 1, v22
    v_mul_u32_u24 v21, 4128, v21
    v_bfe_u32 v22, v20, 1, 1
    v_mul_u32_u24 v22, 49792, v22
    v_add_u32 v21, v21, v22
    v_lshrrev_b32 v22, 4, v1
    v_bfe_u32 v23, v1, 3, 1
    v_sub_u32 v23, v22, v23
    v_lshl_add_u32 v21, v23, 4, v21
    v_and_b32 v23, 15, v1
    v_lshl_add_u32 v24, v23, 1, v22
    v_mul_u32_u24 v24, 48, v24
    v_lshrrev_b32 v25, 1, v22
    v_lshl_add_u32 v26, v23, 1, v25
    v_mul_u32_u24 v26, 48, v26
    v_and_b32 v27, 1, v22
    v_lshl_add_u32 v26, v27, 3, v26
    v_lshrrev_b32 v28, 1, v23
    v_mul_u32_u24 v28, 40960, v28
    v_lshl_add_u32 v28, v25, 4, v28
    v_mul_u32_u24 v27, 2621440, v27
    v_add_u32 v28, v28, v27
    v_and_b32 v23, 1, v23
    v_lshl_add_u32 v28, v23, 5, v28
    s_mul_i32 s6, s3, 16528
    s_add_u32 s6, s6, 32
    v_add_u32 v234, s6, v21
    s_lshl_b32 s6, s3, 4
    s_add_u32 s7, s6, 99936
    v_add_u32 v237, s7, v24
    s_add_u32 s7, s6, 101376
    v_add_u32 v238, s7, v26
    s_add_u32 s6, s51, s3
    s_lshl_b32 s7, s6, 6
    s_add_u32 s8, s7, 12582912
    s_cmp_ge_u32 s6, 640
    s_cselect_b32 s7, s8, s7
    s_add_u32 s7, s7, 10485760
    s_lshl_b32 s6, s6, 3
    s_and_b32 s6, s6, 32
    v_xor_b32 v239, s6, v28
    v_add_u32 v239, s7, v239
    v_mul_u32_u24 v242, 48, v0
    v_add_u32 v242, 101376, v242
    v_bfe_u32 v21, v0, 2, 2
    v_lshlrev_b32 v21, 4, v21
    v_lshl_add_u32 v21, v0, 6, v21
    v_add_u32 v243, 135168, v21
    v_min_u32 v244, 59, v1
    v_lshlrev_b32 v244, 4, v244
    v_add_u32 v244, 36864, v244
    s_lshl_b32 s6, s3, 2
    s_add_u32 s6, s6, 126080
    v_mov_b32 v251, s6
    v_min_u32 v250, 41, v1
    v_lshlrev_b32 v250, 5, v250
    v_add_u32 v250, 207552, v250
    v_min_u32 v245, 213, v0
    v_lshlrev_b32 v245, 5, v245
    v_add_u32 v245, 69632, v245
    s_waitcnt vmcnt(12)
    s_branch L_P1
L_SIDE_LOADS:
    s_cmp_lt_u32 s2, 240
    s_cbranch_scc1 L_NOPF
    s_cmp_lg_u32 s3, 0
    s_cbranch_scc1 L_NOPF
    s_sub_u32 s52, s2, 214
    s_mul_i32 s52, s52, 3
    s_add_u32 s52, s52, s3
    s_lshl_b32 s56, s3, 15
    v_lshrrev_b32 v20, 3, v1
    v_and_b32 v21, 7, v1
    v_lshlrev_b32 v21, 4, v21
    v_mul_u32_u24 v205, 1280, v20
    v_add_u32 v205, v205, v21
    v_mul_u32_u24 v204, 3072, v20
    v_add_u32 v204, v204, v21
    v_lshrrev_b32 v4, 2, v1
    v_lshlrev_b32 v4, 7, v4
    v_and_b32 v5, 3, v1
    v_lshl_add_u32 v4, v5, 3, v4
    v_add_u32 v206, s56, v4
    s_add_u32 s8, s52, 0
    s_min_u32 s8, s8, 479
    s_mul_i32 s9, s8, 6554
    s_lshr_b32 s70, s9, 16
    s_mul_i32 s9, s70, 10
    s_sub_u32 s71, s8, s9
    s_add_u32 s8, s52, 126
    s_min_u32 s8, s8, 479
    s_mul_i32 s9, s8, 6554
    s_lshr_b32 s72, s9, 16
    s_mul_i32 s9, s72, 10
    s_sub_u32 s73, s8, s9
    s_add_u32 s8, s52, 252
    s_min_u32 s8, s8, 479
    s_mul_i32 s9, s8, 6554
    s_lshr_b32 s74, s9, 16
    s_mul_i32 s9, s74, 10
    s_sub_u32 s75, s8, s9
    s_add_u32 s8, s52, 378
    s_min_u32 s8, s8, 479
    s_mul_i32 s9, s8, 6554
    s_lshr_b32 s76, s9, 16
    s_mul_i32 s9, s76, 10
    s_sub_u32 s77, s8, s9
    v_lshrrev_b32 v20, 2, v1
    v_mul_u32_u24 v20, 126, v20
    v_add_u32 v20, s52, v20
    v_min_u32 v20, 479, v20
    v_and_b32 v21, 3, v1
    v_mul_u32_u24 v22, 6554, v20
    v_lshrrev_b32 v22, 16, v22
    v_mul_u32_u24 v23, 10, v22
    v_sub_u32 v23, v20, v23
    v_lshl_add_u32 v23, v23, 2, v21
    v_mul_u32_u24 v25, 13108, v23
    v_lshrrev_b32 v25, 16, v25
    v_mul_u32_u24 v26, 5, v25
    v_sub_u32 v23, v23, v26
    v_mul_u32_u24 v26, 5462, v22
    v_lshrrev_b32 v26, 16, v26
    v_sub_u32 v26, v23, v26
    v_and_b32 v26, 3, v26
    v_cmp_eq_u32 vcc, 4, v23
    v_mul_u32_u24 v25, 240, v25
    v_mad_u32_u24 v25, v22, 5, v25
    v_cndmask_b32 v23, v26, v23, vcc
    v_add_u32 v25, v25, v23
    v_lshlrev_b32 v25, 10, v25
    v_add_u32 v25, 8388608, v25
    s_nop 0
    v_readlane_b32 s8, v25, 0
    v_readlane_b32 s9, v25, 1
    v_readlane_b32 s10, v25, 2
    v_readlane_b32 s11, v25, 3
    v_add_u32 v96, s8, v2
    v_add_u32 v97, s9, v2
    v_add_u32 v98, s10, v2
    v_add_u32 v99, s11, v2
    v_readlane_b32 s8, v25, 4
    v_readlane_b32 s9, v25, 5
    v_readlane_b32 s10, v25, 6
    v_readlane_b32 s11, v25, 7
    v_add_u32 v100, s8, v2
    v_add_u32 v101, s9, v2
    v_add_u32 v102, s10, v2
    v_add_u32 v103, s11, v2
    v_readlane_b32 s8, v25, 8
    v_readlane_b32 s9, v25, 9
    v_readlane_b32 s10, v25, 10
    v_readlane_b32 s11, v25, 11
    v_add_u32 v104, s8, v2
    v_add_u32 v105, s9, v2
    v_add_u32 v106, s10, v2
    v_add_u32 v107, s11, v2
    v_readlane_b32 s8, v25, 12
    v_readlane_b32 s9, v25, 13
    v_readlane_b32 s10, v25, 14
    v_readlane_b32 s11, v25, 15
    v_add_u32 v108, s8, v2
    v_add_u32 v109, s9, v2
    v_add_u32 v110, s10, v2
    v_add_u32 v111, s11, v2
    s_waitcnt vmcnt(0)
    s_branch L_P1
L_NOPF:
    s_sub_u32 s52, s2, 214
    s_mul_i32 s52, s52, 3
    s_add_u32 s52, s52, s3
    s_lshl_b32 s56, s3, 15
    v_lshrrev_b32 v20, 3, v1
    v_and_b32 v21, 7, v1
    v_lshlrev_b32 v21, 4, v21
    v_mul_u32_u24 v205, 1280, v20
    v_add_u32 v205, v205, v21
    v_mul_u32_u24 v204, 3072, v20
    v_add_u32 v204, v204, v21
    v_lshrrev_b32 v4, 2, v1
    v_lshlrev_b32 v4, 7, v4
    v_and_b32 v5, 3, v1
    v_lshl_add_u32 v4, v5, 3, v4
    v_add_u32 v206, s56, v4
    s_add_u32 s8, s52, 0
    s_min_u32 s8, s8, 479
    s_mul_i32 s9, s8, 6554
    s_lshr_b32 s70, s9, 16
    s_mul_i32 s9, s70, 10
    s_sub_u32 s71, s8, s9
    s_add_u32 s8, s52, 126
    s_min_u32 s8, s8, 479
    s_mul_i32 s9, s8, 6554
    s_lshr_b32 s72, s9, 16
    s_mul_i32 s9, s72, 10
    s_sub_u32 s73, s8, s9
    s_add_u32 s8, s52, 252
    s_min_u32 s8, s8, 479
    s_mul_i32 s9, s8, 6554
    s_lshr_b32 s74, s9, 16
    s_mul_i32 s9, s74, 10
    s_sub_u32 s75, s8, s9
    s_add_u32 s8, s52, 378
    s_min_u32 s8, s8, 479
    s_mul_i32 s9, s8, 6554
    s_lshr_b32 s76, s9, 16
    s_mul_i32 s9, s76, 10
    s_sub_u32 s77, s8, s9
    v_lshrrev_b32 v20, 2, v1
    v_mul_u32_u24 v20, 126, v20
    v_add_u32 v20, s52, v20
    v_min_u32 v20, 479, v20
    v_and_b32 v21, 3, v1
    v_mul_u32_u24 v22, 6554, v20
    v_lshrrev_b32 v22, 16, v22
    v_mul_u32_u24 v23, 10, v22
    v_sub_u32 v23, v20, v23
    v_lshl_add_u32 v23, v23, 2, v21
    v_mul_u32_u24 v25, 13108, v23
    v_lshrrev_b32 v25, 16, v25
    v_mul_u32_u24 v26, 5, v25
    v_sub_u32 v23, v23, v26
    v_mul_u32_u24 v26, 5462, v22
    v_lshrrev_b32 v26, 16, v26
    v_sub_u32 v26, v23, v26
    v_and_b32 v26, 3, v26
    v_cmp_eq_u32 vcc, 4, v23
    v_mul_u32_u24 v25, 240, v25
    v_mad_u32_u24 v25, v22, 5, v25
    v_cndmask_b32 v23, v26, v23, vcc
    v_add_u32 v25, v25, v23
    v_lshlrev_b32 v25, 10, v25
    v_add_u32 v25, 8388608, v25
    s_nop 0
    v_readlane_b32 s8, v25, 0
    v_readlane_b32 s9, v25, 1
    v_readlane_b32 s10, v25, 2
    v_readlane_b32 s11, v25, 3
    v_add_u32 v96, s8, v2
    v_add_u32 v97, s9, v2
    v_add_u32 v98, s10, v2
    v_add_u32 v99, s11, v2
    v_readlane_b32 s8, v25, 4
    v_readlane_b32 s9, v25, 5
    v_readlane_b32 s10, v25, 6
    v_readlane_b32 s11, v25, 7
    v_add_u32 v100, s8, v2
    v_add_u32 v101, s9, v2
    v_add_u32 v102, s10, v2
    v_add_u32 v103, s11, v2
    v_readlane_b32 s8, v25, 8
    v_readlane_b32 s9, v25, 9
    v_readlane_b32 s10, v25, 10
    v_readlane_b32 s11, v25, 11
    v_add_u32 v104, s8, v2
    v_add_u32 v105, s9, v2
    v_add_u32 v106, s10, v2
    v_add_u32 v107, s11, v2
    v_readlane_b32 s8, v25, 12
    v_readlane_b32 s9, v25, 13
    v_readlane_b32 s10, v25, 14
    v_readlane_b32 s11, v25, 15
    v_add_u32 v108, s8, v2
    v_add_u32 v109, s9, v2
    v_add_u32 v110, s10, v2
    v_add_u32 v111, s11, v2
    s_waitcnt vmcnt(0)
    s_branch L_P1
L_W3_LOADS:
    s_cmp_ge_u32 s2, 240
    s_cbranch_scc1 L_W3_PF
    s_mul_i32 s57, s2, 1093
    s_lshr_b32 s57, s57, 16
    s_mul_i32 s6, s57, 60
    s_sub_u32 s58, s2, s6
    s_mul_i32 s6, s57, 320
    v_lshl_add_u32 v5, v1, 1, s6
    v_min_u32 v4, 31, v1
    v_lshl_add_u32 v4, v4, 1, s6
    global_load_ushort v8, v5, s[40:41]
    global_load_ushort v9, v5, s[40:41] offset:128
    global_load_ushort v10, v4, s[40:41] offset:256
    v_lshrrev_b32 v4, 3, v1
    s_mul_i32 s54, s2, 5462
    s_lshr_b32 s54, s54, 16
    s_mul_i32 s6, s54, 12
    s_sub_u32 s55, s2, s6
    s_mul_i32 s6, s54, 98304
    s_lshl_b32 s7, s55, 8
    s_add_u32 s6, s6, s7
    v_lshrrev_b32 v20, 4, v1
    v_mul_u32_u24 v20, 3072, v20
    v_and_b32 v21, 15, v1
    v_lshl_add_u32 v20, v21, 4, v20
    v_add_u32 v20, s6, v20
    s_mov_b32 m0, 135168
    s_nop 0
    global_load_lds_dwordx4 v20, s[36:37]
    s_mov_b32 m0, 136192
    v_add_u32 v20, 12288, v20
    global_load_lds_dwordx4 v20, s[36:37]
    s_mov_b32 m0, 137216
    v_add_u32 v20, 12288, v20
    global_load_lds_dwordx4 v20, s[36:37]
    s_mov_b32 m0, 138240
    v_add_u32 v20, 12288, v20
    global_load_lds_dwordx4 v20, s[36:37]
    s_mov_b32 m0, 139264
    v_add_u32 v20, 12288, v20
    global_load_lds_dwordx4 v20, s[36:37]
    s_mov_b32 m0, 140288
    v_add_u32 v20, 12288, v20
    global_load_lds_dwordx4 v20, s[36:37]
    s_mov_b32 m0, 141312
    v_add_u32 v20, 12288, v20
    global_load_lds_dwordx4 v20, s[36:37]
    s_mov_b32 m0, 142336
    v_add_u32 v20, 12288, v20
    global_load_lds_dwordx4 v20, s[36:37]
    s_lshl_b32 s6, s55, 3
    v_add_u32 v23, s6, v1
    v_mul_u32_u24 v24, 21846, v23
    v_lshrrev_b32 v24, 16, v24
    v_mul_u32_u24 v24, 58368, v24
    v_lshl_add_u32 v24, v23, 10, v24
    s_mul_i32 s6, s54, 3072
    s_add_u32 s6, s6, 6422528
    v_add_u32 v24, s6, v24
    v_lshrrev_b32 v58, 2, v1
    v_lshlrev_b32 v58, 8, v58
    v_and_b32_e64 v21, 3, v1
    v_lshl_add_u32 v58, v21, 3, v58
    v_add_u32 v58, 135168, v58
    v_readlane_b32 s8, v24, 0
    v_readlane_b32 s9, v24, 1
    v_readlane_b32 s10, v24, 2
    v_readlane_b32 s11, v24, 3
    v_add_u32 v50, s8, v2
    v_add_u32 v51, s9, v2
    v_add_u32 v52, s10, v2
    v_add_u32 v53, s11, v2
    v_readlane_b32 s8, v24, 4
    v_readlane_b32 s9, v24, 5
    v_readlane_b32 s10, v24, 6
    v_readlane_b32 s11, v24, 7
    v_add_u32 v54, s8, v2
    v_add_u32 v55, s9, v2
    v_add_u32 v56, s10, v2
    v_add_u32 v57, s11, v2
    s_mov_b32 s6, 153600
    v_mul_lo_u32 v4, v4, s6
    v_and_b32 v5, 7, v1
    v_lshl_add_u32 v4, v5, 4, v4
    s_mul_i32 s6, s57, 1228800
    s_lshl_b32 s7, s58, 7
    s_add_u32 s6, s6, s7
    v_add_u32 v215, s6, v4
    v_bfe_u32 v4, v1, 3, 1
    v_bfe_u32 v5, v1, 4, 1
    v_lshl_add_u32 v4, v5, 1, v4
    v_lshrrev_b32 v5, 5, v1
    v_lshl_add_u32 v4, v5, 2, v4
    v_and_b32 v5, 7, v1
    v_lshl_add_u32 v4, v5, 3, v4
    s_mul_i32 s6, s57, 30720
    s_lshl_b32 s7, s58, 9
    s_add_u32 s6, s6, s7
    s_add_u32 s6, s6, 851968
    v_lshl_add_u32 v246, v4, 3, s6
    s_waitcnt vmcnt(11)
    s_branch L_P1
L_W3_PF:
    s_waitcnt vmcnt(0)
L_P1:
    s_waitcnt lgkmcnt(0)
    s_mul_i32 s50, s50, 0x9e3779b1
    s_add_u32 s50, s50, 0x7f4a7c15
    s_barrier
    ds_read_b64 v[28:29], v61 offset:0
    ds_read_b64 v[30:31], v61 offset:256
    ds_read_b64 v[32:33], v61 offset:512
    ds_read_b64 v[34:35], v61 offset:768
    ds_read_b64 v[36:37], v61 offset:1024
    s_cmp_eq_u32 s3, 3
    s_cbranch_scc1 L_W3_P1
    v_mov_b32 v38, 0
    v_mov_b32 v39, 0
    v_mov_b32 v40, 0x3f803f80
    s_waitcnt lgkmcnt(0)
    v_dot2c_f32_bf16 v38, v28, v40
    v_dot2c_f32_bf16 v39, v28, v28
    v_dot2c_f32_bf16 v38, v29, v40
    v_dot2c_f32_bf16 v39, v29, v29
    v_dot2c_f32_bf16 v38, v30, v40
    v_dot2c_f32_bf16 v39, v30, v30
    v_dot2c_f32_bf16 v38, v31, v40
    v_dot2c_f32_bf16 v39, v31, v31
    v_dot2c_f32_bf16 v38, v32, v40
    v_dot2c_f32_bf16 v39, v32, v32
    v_dot2c_f32_bf16 v38, v33, v40
    v_dot2c_f32_bf16 v39, v33, v33
    v_dot2c_f32_bf16 v38, v34, v40
    v_dot2c_f32_bf16 v39, v34, v34
    v_dot2c_f32_bf16 v38, v35, v40
    v_dot2c_f32_bf16 v39, v35, v35
    v_dot2c_f32_bf16 v38, v36, v40
    v_dot2c_f32_bf16 v39, v36, v36
    v_dot2c_f32_bf16 v38, v37, v40
    v_dot2c_f32_bf16 v39, v37, v37
    s_nop 2
    v_permlane16_swap_b32 v38, v39
    v_add_f32 v38, v38, v39
    s_nop 1
    v_add_f32_dpp v38, v38, v38 quad_perm:[1,0,3,2] row_mask:0xf bank_mask:0xf
    s_nop 1
    v_add_f32_dpp v38, v38, v38 quad_perm:[2,3,0,1] row_mask:0xf bank_mask:0xf
    s_nop 1
    v_add_f32_dpp v38, v38, v38 row_half_mirror row_mask:0xf bank_mask:0xf
    s_nop 1
    v_add_f32_dpp v38, v38, v38 row_mirror row_mask:0xf bank_mask:0xf
    v_mov_b32 v39, v38
    s_nop 1
    v_permlane16_swap_b32 v38, v39
    v_mul_f32 v38, 0x3acccccd, v38
    v_mul_f32 v39, 0x3acccccd, v39
    v_fma_f32 v39, -v38, v38, v39
    v_max_f32 v39, 0, v39
    v_cvt_pk_bf16_f32 v41, v38, v39
    v_and_b32 v39, 0xffff0000, v41
    v_lshlrev_b32 v38, 16, v41
    v_add_f32 v39, 0x3727c5ac, v39
    v_cvt_pk_bf16_f32 v39, v39, v39
    v_lshlrev_b32 v39, 16, v39
    v_sqrt_f32 v39, v39
    s_nop 0
    v_cvt_pk_bf16_f32 v39, v39, v39
    v_lshlrev_b32 v39, 16, v39
    v_rcp_f32 v39, v39
    s_nop 0
    v_mul_f32 v38, -v38, v39
    ds_write2_b32 v60, v39, v38 offset0:0 offset1:8
    v_mov_b32 v4, 126016
    v_mov_b32 v5, 1
    s_mov_b64 exec, 1
    ds_add_u32 v4, v5
    s_mov_b64 exec, -1
    s_cmp_ge_u32 s2, 214
    s_cbranch_scc1 L_SIDE_W
    s_waitcnt vmcnt(0)
    s_mul_i32 s59, s3, 16528
    s_mov_b32 m0, s59
    v_and_b32 v20, 31, v1
    v_mul_u32_u24 v20, 272, v20
    v_lshrrev_b32 v21, 5, v1
    v_lshl_add_u32 v20, v21, 4, v20
    v_add_u32 v5, s59, v20
    s_bitcmp1_b32 s52, 0
    s_cselect_b32 s6, 0, 16
    s_lshl_b32 s6, s53, s6
    s_and_b32 s6, s6, 0xffff0000
    v_mov_b32 v20, 0x3fb8aa3b
    v_mul_f32 v20, s6, v20
    v_exp_f32 v20, v20
    v_mov_b32 v21, 0x3f80
    v_cvt_pk_bf16_f32 v20, v20, v20
    ds_write_addtid_b32 v21 offset:0
    v_lshlrev_b32 v6, 16, v20
    v_lshlrev_b32 v20, 16, v8
    v_lshlrev_b32 v21, 16, v9
    v_lshlrev_b32 v24, 16, v10
    v_lshlrev_b32 v25, 16, v11
    v_lshlrev_b32 v26, 16, v12
    v_lshlrev_b32 v27, 16, v13
    v_pk_mul_f32 v[20:21], v[20:21], v[6:7] op_sel_hi:[1,0]
    v_pk_mul_f32 v[24:25], v[24:25], v[6:7] op_sel_hi:[1,0]
    v_mul_f32 v20, 0x3fb8aa3b, v20
    v_mul_f32 v21, 0x3e22f983, v21
    v_pk_mul_f32 v[76:77], v[26:27], v[24:25] op_sel_hi:[0,1]
    v_pk_fma_f32 v[76:77], v[26:27], v[24:25], v[76:77] op_sel:[1,1,0] op_sel_hi:[1,0,1] neg_lo:[1,0,0]
    v_mul_f32 v128, 0x42800000, v20
    v_mov_b32 v130, v20
    v_mul_f32 v129, 0x42800000, v21
    v_mov_b32 v131, v21
    v_exp_f32 v128, v128
    v_exp_f32 v130, v130
    v_fract_f32 v129, v129
    v_fract_f32 v131, v131
    v_cos_f32 v46, v129
    v_cos_f32 v64, v131
    v_sin_f32 v47, v129
    v_sin_f32 v65, v131
    v_pk_mul_f32 v[46:47], v[46:47], v[128:129] op_sel_hi:[1,0]
    v_pk_mul_f32 v[64:65], v[64:65], v[130:131] op_sel_hi:[1,0]
    v_pk_mul_f32 v[62:63], v[46:47], v[46:47] op_sel_hi:[0,1]
    v_pk_mul_f32 v[66:67], v[64:65], v[64:65] op_sel_hi:[0,1]
    v_pk_fma_f32 v[62:63], v[46:47], v[46:47], v[62:63] op_sel:[1,1,0] op_sel_hi:[1,0,1] neg_lo:[1,0,0]
    v_pk_fma_f32 v[66:67], v[64:65], v[64:65], v[66:67] op_sel:[1,1,0] op_sel_hi:[1,0,1] neg_lo:[1,0,0]
    v_pk_mul_f32 v[70:71], v[62:63], v[62:63] op_sel_hi:[0,1]
    v_pk_mul_f32 v[68:69], v[66:67], v[66:67] op_sel_hi:[0,1]
    v_pk_fma_f32 v[70:71], v[62:63], v[62:63], v[70:71] op_sel:[1,1,0] op_sel_hi:[1,0,1] neg_lo:[1,0,0]
    v_pk_fma_f32 v[68:69], v[66:67], v[66:67], v[68:69] op_sel:[1,1,0] op_sel_hi:[1,0,1] neg_lo:[1,0,0]
    v_pk_mul_f32 v[72:73], v[70:71], v[70:71] op_sel_hi:[0,1]
    v_pk_mul_f32 v[32:33], v[68:69], v[68:69] op_sel_hi:[0,1]
    v_pk_fma_f32 v[72:73], v[70:71], v[70:71], v[72:73] op_sel:[1,1,0] op_sel_hi:[1,0,1] neg_lo:[1,0,0]
    v_pk_fma_f32 v[32:33], v[68:69], v[68:69], v[32:33] op_sel:[1,1,0] op_sel_hi:[1,0,1] neg_lo:[1,0,0]
    v_pk_mul_f32 v[74:75], v[72:73], v[72:73] op_sel_hi:[0,1]
    v_pk_mul_f32 v[34:35], v[32:33], v[32:33] op_sel_hi:[0,1]
    v_pk_fma_f32 v[74:75], v[72:73], v[72:73], v[74:75] op_sel:[1,1,0] op_sel_hi:[1,0,1] neg_lo:[1,0,0]
    v_pk_fma_f32 v[34:35], v[32:33], v[32:33], v[34:35] op_sel:[1,1,0] op_sel_hi:[1,0,1] neg_lo:[1,0,0]
    v_pk_mul_f32 v[38:39], v[34:35], v[34:35] op_sel_hi:[0,1]
    v_pk_mul_f32 v[36:37], v[34:35], v[32:33] op_sel_hi:[0,1]
    v_pk_fma_f32 v[38:39], v[34:35], v[34:35], v[38:39] op_sel:[1,1,0] op_sel_hi:[1,0,1] neg_lo:[1,0,0]
    v_pk_fma_f32 v[36:37], v[34:35], v[32:33], v[36:37] op_sel:[1,1,0] op_sel_hi:[1,0,1] neg_lo:[1,0,0]
    v_cvt_pk_bf16_f32 v118, v32, v33
    v_cvt_pk_bf16_f32 v119, v34, v35
    v_cvt_pk_bf16_f32 v120, v46, v47
    v_cvt_pk_bf16_f32 v121, v62, v63
    v_cvt_pk_bf16_f32 v122, v38, v39
    v_cvt_pk_bf16_f32 v123, v36, v37
    v_cvt_pk_bf16_f32 v124, v76, -v77
    v_pk_mul_f32 v[40:41], v[38:39], v[32:33] op_sel_hi:[0,1]
    v_pk_mul_f32 v[42:43], v[38:39], v[34:35] op_sel_hi:[0,1]
    v_pk_fma_f32 v[40:41], v[38:39], v[32:33], v[40:41] op_sel:[1,1,0] op_sel_hi:[1,0,1] neg_lo:[1,0,0]
    v_pk_fma_f32 v[42:43], v[38:39], v[34:35], v[42:43] op_sel:[1,1,0] op_sel_hi:[1,0,1] neg_lo:[1,0,0]
    v_cvt_pk_bf16_f32 v125, v40, v41
    ds_write_addtid_b32 v118 offset:272
    ds_write_addtid_b32 v119 offset:544
    ds_write_addtid_b32 v120 offset:2176
    ds_write_addtid_b32 v121 offset:4352
    ds_write_addtid_b32 v122 offset:1088
    ds_write_addtid_b32 v123 offset:816
    ds_write_addtid_b32 v124 offset:8704
    ds_write_addtid_b32 v125 offset:1360
    v_cvt_pk_bf16_f32 v118, v42, v43
    v_pk_mul_f32 v[44:45], v[38:39], v[36:37] op_sel_hi:[0,1]
    v_pk_mul_f32 v[78:79], v[76:77], v[64:65] op_sel_hi:[0,1]
    v_pk_fma_f32 v[44:45], v[38:39], v[36:37], v[44:45] op_sel:[1,1,0] op_sel_hi:[1,0,1] neg_lo:[1,0,0]
    v_pk_fma_f32 v[78:79], v[76:77], v[64:65], v[78:79] op_sel:[1,1,0] op_sel_hi:[1,0,1] neg_lo:[1,0,0]
    v_cvt_pk_bf16_f32 v119, v44, v45
    v_cvt_pk_bf16_f32 v120, v78, -v79
    v_pk_mul_f32 v[80:81], v[76:77], v[66:67] op_sel_hi:[0,1]
    v_pk_mul_f32 v[84:85], v[76:77], v[68:69] op_sel_hi:[0,1]
    v_pk_fma_f32 v[80:81], v[76:77], v[66:67], v[80:81] op_sel:[1,1,0] op_sel_hi:[1,0,1] neg_lo:[1,0,0]
    v_pk_fma_f32 v[84:85], v[76:77], v[68:69], v[84:85] op_sel:[1,1,0] op_sel_hi:[1,0,1] neg_lo:[1,0,0]
    v_cvt_pk_bf16_f32 v121, v80, -v81
    v_cvt_pk_bf16_f32 v122, v84, -v85
    v_pk_mul_f32 v[48:49], v[46:47], v[32:33] op_sel_hi:[0,1]
    v_pk_mul_f32 v[50:51], v[46:47], v[34:35] op_sel_hi:[0,1]
    v_pk_fma_f32 v[48:49], v[46:47], v[32:33], v[48:49] op_sel:[1,1,0] op_sel_hi:[1,0,1] neg_lo:[1,0,0]
    v_pk_fma_f32 v[50:51], v[46:47], v[34:35], v[50:51] op_sel:[1,1,0] op_sel_hi:[1,0,1] neg_lo:[1,0,0]
    v_cvt_pk_bf16_f32 v123, v48, v49
    v_cvt_pk_bf16_f32 v124, v50, v51
    v_pk_mul_f32 v[52:53], v[46:47], v[36:37] op_sel_hi:[0,1]
    v_pk_mul_f32 v[54:55], v[46:47], v[38:39] op_sel_hi:[0,1]
    v_pk_fma_f32 v[52:53], v[46:47], v[36:37], v[52:53] op_sel:[1,1,0] op_sel_hi:[1,0,1] neg_lo:[1,0,0]
    v_pk_fma_f32 v[54:55], v[46:47], v[38:39], v[54:55] op_sel:[1,1,0] op_sel_hi:[1,0,1] neg_lo:[1,0,0]
    v_cvt_pk_bf16_f32 v125, v52, v53
    ds_write_addtid_b32 v118 offset:1632
    ds_write_addtid_b32 v119 offset:1904
    ds_write_addtid_b32 v120 offset:8976
    ds_write_addtid_b32 v121 offset:9248
    ds_write_addtid_b32 v122 offset:9792
    ds_write_addtid_b32 v123 offset:2448
    ds_write_addtid_b32 v124 offset:2720
    ds_write_addtid_b32 v125 offset:2992
    v_cvt_pk_bf16_f32 v118, v54, v55
    v_pk_mul_f32 v[56:57], v[46:47], v[40:41] op_sel_hi:[0,1]
    v_pk_mul_f32 v[58:59], v[46:47], v[42:43] op_sel_hi:[0,1]
    v_pk_fma_f32 v[56:57], v[46:47], v[40:41], v[56:57] op_sel:[1,1,0] op_sel_hi:[1,0,1] neg_lo:[1,0,0]
    v_pk_fma_f32 v[58:59], v[46:47], v[42:43], v[58:59] op_sel:[1,1,0] op_sel_hi:[1,0,1] neg_lo:[1,0,0]
    v_cvt_pk_bf16_f32 v119, v56, v57
    v_cvt_pk_bf16_f32 v120, v58, v59
    v_pk_mul_f32 v[60:61], v[46:47], v[44:45] op_sel_hi:[0,1]
    v_pk_mul_f32 v[82:83], v[78:79], v[66:67] op_sel_hi:[0,1]
    v_pk_fma_f32 v[60:61], v[46:47], v[44:45], v[60:61] op_sel:[1,1,0] op_sel_hi:[1,0,1] neg_lo:[1,0,0]
    v_pk_fma_f32 v[82:83], v[78:79], v[66:67], v[82:83] op_sel:[1,1,0] op_sel_hi:[1,0,1] neg_lo:[1,0,0]
    v_cvt_pk_bf16_f32 v121, v60, v61
    v_cvt_pk_bf16_f32 v122, v82, -v83
    v_pk_mul_f32 v[86:87], v[78:79], v[68:69] op_sel_hi:[0,1]
    v_pk_mul_f32 v[88:89], v[80:81], v[68:69] op_sel_hi:[0,1]
    v_pk_fma_f32 v[86:87], v[78:79], v[68:69], v[86:87] op_sel:[1,1,0] op_sel_hi:[1,0,1] neg_lo:[1,0,0]
    v_pk_fma_f32 v[88:89], v[80:81], v[68:69], v[88:89] op_sel:[1,1,0] op_sel_hi:[1,0,1] neg_lo:[1,0,0]
    v_cvt_pk_bf16_f32 v123, v86, -v87
    v_cvt_pk_bf16_f32 v124, v88, -v89
    v_pk_mul_f32 v[92:93], v[76:77], v[70:71] op_sel_hi:[0,1]
    v_pk_mul_f32 v[100:101], v[76:77], v[72:73] op_sel_hi:[0,1]
    v_pk_fma_f32 v[92:93], v[76:77], v[70:71], v[92:93] op_sel:[1,1,0] op_sel_hi:[1,0,1] neg_lo:[1,0,0]
    v_pk_fma_f32 v[100:101], v[76:77], v[72:73], v[100:101] op_sel:[1,1,0] op_sel_hi:[1,0,1] neg_lo:[1,0,0]
    v_cvt_pk_bf16_f32 v125, v92, -v93
    ds_write_addtid_b32 v118 offset:3264
    ds_write_addtid_b32 v119 offset:3536
    ds_write_addtid_b32 v120 offset:3808
    ds_write_addtid_b32 v121 offset:4080
    ds_write_addtid_b32 v122 offset:9520
    ds_write_addtid_b32 v123 offset:10064
    ds_write_addtid_b32 v124 offset:10336
    ds_write_addtid_b32 v125 offset:10880
    v_cvt_pk_bf16_f32 v118, v100, -v101
    v_pk_mul_f32 v[108:109], v[76:77], v[74:75] op_sel_hi:[0,1]
    v_pk_mul_f32 v[90:91], v[82:83], v[68:69] op_sel_hi:[0,1]
    v_pk_fma_f32 v[108:109], v[76:77], v[74:75], v[108:109] op_sel:[1,1,0] op_sel_hi:[1,0,1] neg_lo:[1,0,0]
    v_pk_fma_f32 v[90:91], v[82:83], v[68:69], v[90:91] op_sel:[1,1,0] op_sel_hi:[1,0,1] neg_lo:[1,0,0]
    v_cvt_pk_bf16_f32 v119, v108, -v109
    v_cvt_pk_bf16_f32 v120, v90, -v91
    v_pk_mul_f32 v[94:95], v[80:81], v[70:71] op_sel_hi:[0,1]
    v_pk_mul_f32 v[96:97], v[84:85], v[70:71] op_sel_hi:[0,1]
    v_pk_fma_f32 v[94:95], v[80:81], v[70:71], v[94:95] op_sel:[1,1,0] op_sel_hi:[1,0,1] neg_lo:[1,0,0]
    v_pk_fma_f32 v[96:97], v[84:85], v[70:71], v[96:97] op_sel:[1,1,0] op_sel_hi:[1,0,1] neg_lo:[1,0,0]
    v_cvt_pk_bf16_f32 v121, v94, -v95
    v_cvt_pk_bf16_f32 v122, v96, -v97
    v_pk_mul_f32 v[98:99], v[88:89], v[70:71] op_sel_hi:[0,1]
    v_pk_mul_f32 v[102:103], v[84:85], v[72:73] op_sel_hi:[0,1]
    v_pk_fma_f32 v[98:99], v[88:89], v[70:71], v[98:99] op_sel:[1,1,0] op_sel_hi:[1,0,1] neg_lo:[1,0,0]
    v_pk_fma_f32 v[102:103], v[84:85], v[72:73], v[102:103] op_sel:[1,1,0] op_sel_hi:[1,0,1] neg_lo:[1,0,0]
    v_cvt_pk_bf16_f32 v123, v98, -v99
    v_cvt_pk_bf16_f32 v124, v102, -v103
    v_pk_mul_f32 v[104:105], v[92:93], v[72:73] op_sel_hi:[0,1]
    v_pk_mul_f32 v[106:107], v[96:97], v[72:73] op_sel_hi:[0,1]
    v_pk_fma_f32 v[104:105], v[92:93], v[72:73], v[104:105] op_sel:[1,1,0] op_sel_hi:[1,0,1] neg_lo:[1,0,0]
    v_pk_fma_f32 v[106:107], v[96:97], v[72:73], v[106:107] op_sel:[1,1,0] op_sel_hi:[1,0,1] neg_lo:[1,0,0]
    v_cvt_pk_bf16_f32 v125, v104, -v105
    ds_write_addtid_b32 v118 offset:11968
    ds_write_addtid_b32 v119 offset:13056
    ds_write_addtid_b32 v120 offset:10608
    ds_write_addtid_b32 v121 offset:11152
    ds_write_addtid_b32 v122 offset:11424
    ds_write_addtid_b32 v123 offset:11696
    ds_write_addtid_b32 v124 offset:12240
    ds_write_addtid_b32 v125 offset:12512
    v_cvt_pk_bf16_f32 v118, v106, -v107
    v_pk_mul_f32 v[110:111], v[92:93], v[74:75] op_sel_hi:[0,1]
    v_pk_mul_f32 v[112:113], v[100:101], v[74:75] op_sel_hi:[0,1]
    v_pk_fma_f32 v[110:111], v[92:93], v[74:75], v[110:111] op_sel:[1,1,0] op_sel_hi:[1,0,1] neg_lo:[1,0,0]
    v_pk_fma_f32 v[112:113], v[100:101], v[74:75], v[112:113] op_sel:[1,1,0] op_sel_hi:[1,0,1] neg_lo:[1,0,0]
    v_cvt_pk_bf16_f32 v119, v110, -v111
    v_cvt_pk_bf16_f32 v120, v112, -v113
    v_pk_mul_f32 v[114:115], v[104:105], v[74:75] op_sel_hi:[0,1]
    v_pk_mul_f32 v[116:117], v[108:109], v[74:75] op_sel_hi:[0,1]
    v_pk_fma_f32 v[114:115], v[104:105], v[74:75], v[114:115] op_sel:[1,1,0] op_sel_hi:[1,0,1] neg_lo:[1,0,0]
    v_pk_fma_f32 v[116:117], v[108:109], v[74:75], v[116:117] op_sel:[1,1,0] op_sel_hi:[1,0,1] neg_lo:[1,0,0]
    v_cvt_pk_bf16_f32 v121, v114, -v115
    v_cvt_pk_bf16_f32 v122, v116, -v117
    v_pk_mul_f32 v[126:127], v[62:63], v[32:33] op_sel_hi:[0,1]
    v_pk_mul_f32 v[128:129], v[62:63], v[34:35] op_sel_hi:[0,1]
    v_pk_fma_f32 v[126:127], v[62:63], v[32:33], v[126:127] op_sel:[1,1,0] op_sel_hi:[1,0,1] neg_lo:[1,0,0]
    v_pk_fma_f32 v[128:129], v[62:63], v[34:35], v[128:129] op_sel:[1,1,0] op_sel_hi:[1,0,1] neg_lo:[1,0,0]
    v_cvt_pk_bf16_f32 v123, v126, v127
    v_cvt_pk_bf16_f32 v124, v128, v129
    v_pk_mul_f32 v[130:131], v[62:63], v[36:37] op_sel_hi:[0,1]
    v_pk_mul_f32 v[132:133], v[62:63], v[38:39] op_sel_hi:[0,1]
    v_pk_fma_f32 v[130:131], v[62:63], v[36:37], v[130:131] op_sel:[1,1,0] op_sel_hi:[1,0,1] neg_lo:[1,0,0]
    v_pk_fma_f32 v[132:133], v[62:63], v[38:39], v[132:133] op_sel:[1,1,0] op_sel_hi:[1,0,1] neg_lo:[1,0,0]
    v_cvt_pk_bf16_f32 v125, v130, v131
    ds_write_addtid_b32 v118 offset:12784
    ds_write_addtid_b32 v119 offset:13328
    ds_write_addtid_b32 v120 offset:13600
    ds_write_addtid_b32 v121 offset:13872
    ds_write_addtid_b32 v122 offset:14144
    ds_write_addtid_b32 v123 offset:4624
    ds_write_addtid_b32 v124 offset:4896
    ds_write_addtid_b32 v125 offset:5168
    v_cvt_pk_bf16_f32 v118, v132, v133
    v_pk_mul_f32 v[126:127], v[62:63], v[40:41] op_sel_hi:[0,1]
    v_pk_mul_f32 v[128:129], v[62:63], v[42:43] op_sel_hi:[0,1]
    v_pk_fma_f32 v[126:127], v[62:63], v[40:41], v[126:127] op_sel:[1,1,0] op_sel_hi:[1,0,1] neg_lo:[1,0,0]
    v_pk_fma_f32 v[128:129], v[62:63], v[42:43], v[128:129] op_sel:[1,1,0] op_sel_hi:[1,0,1] neg_lo:[1,0,0]
    v_cvt_pk_bf16_f32 v119, v126, v127
    v_cvt_pk_bf16_f32 v120, v128, v129
    v_pk_mul_f32 v[130:131], v[62:63], v[44:45] op_sel_hi:[0,1]
    v_pk_mul_f32 v[132:133], v[62:63], v[46:47] op_sel_hi:[0,1]
    v_pk_fma_f32 v[130:131], v[62:63], v[44:45], v[130:131] op_sel:[1,1,0] op_sel_hi:[1,0,1] neg_lo:[1,0,0]
    v_pk_fma_f32 v[132:133], v[62:63], v[46:47], v[132:133] op_sel:[1,1,0] op_sel_hi:[1,0,1] neg_lo:[1,0,0]
    v_cvt_pk_bf16_f32 v121, v130, v131
    v_cvt_pk_bf16_f32 v122, v132, v133
    v_pk_mul_f32 v[126:127], v[62:63], v[48:49] op_sel_hi:[0,1]
    v_pk_mul_f32 v[128:129], v[62:63], v[50:51] op_sel_hi:[0,1]
    v_pk_fma_f32 v[126:127], v[62:63], v[48:49], v[126:127] op_sel:[1,1,0] op_sel_hi:[1,0,1] neg_lo:[1,0,0]
    v_pk_fma_f32 v[128:129], v[62:63], v[50:51], v[128:129] op_sel:[1,1,0] op_sel_hi:[1,0,1] neg_lo:[1,0,0]
    v_cvt_pk_bf16_f32 v123, v126, v127
    v_cvt_pk_bf16_f32 v124, v128, v129
    v_pk_mul_f32 v[130:131], v[62:63], v[52:53] op_sel_hi:[0,1]
    v_pk_mul_f32 v[132:133], v[62:63], v[54:55] op_sel_hi:[0,1]
    v_pk_fma_f32 v[130:131], v[62:63], v[52:53], v[130:131] op_sel:[1,1,0] op_sel_hi:[1,0,1] neg_lo:[1,0,0]
    v_pk_fma_f32 v[132:133], v[62:63], v[54:55], v[132:133] op_sel:[1,1,0] op_sel_hi:[1,0,1] neg_lo:[1,0,0]
    v_cvt_pk_bf16_f32 v125, v130, v131
    ds_write_addtid_b32 v118 offset:5440
    ds_write_addtid_b32 v119 offset:5712
    ds_write_addtid_b32 v120 offset:5984
    ds_write_addtid_b32 v121 offset:6256
    ds_write_addtid_b32 v122 offset:6528
    ds_write_addtid_b32 v123 offset:6800
    ds_write_addtid_b32 v124 offset:7072
    ds_write_addtid_b32 v125 offset:7344
    v_cvt_pk_bf16_f32 v118, v132, v133
    v_pk_mul_f32 v[126:127], v[62:63], v[56:57] op_sel_hi:[0,1]
    v_pk_mul_f32 v[128:129], v[62:63], v[58:59] op_sel_hi:[0,1]
    v_pk_fma_f32 v[126:127], v[62:63], v[56:57], v[126:127] op_sel:[1,1,0] op_sel_hi:[1,0,1] neg_lo:[1,0,0]
    v_pk_fma_f32 v[128:129], v[62:63], v[58:59], v[128:129] op_sel:[1,1,0] op_sel_hi:[1,0,1] neg_lo:[1,0,0]
    v_cvt_pk_bf16_f32 v119, v126, v127
    v_cvt_pk_bf16_f32 v120, v128, v129
    v_pk_mul_f32 v[130:131], v[62:63], v[60:61] op_sel_hi:[0,1]
    v_pk_fma_f32 v[130:131], v[62:63], v[60:61], v[130:131] op_sel:[1,1,0] op_sel_hi:[1,0,1] neg_lo:[1,0,0]
    v_cvt_pk_bf16_f32 v121, v130, v131
    ds_write_addtid_b32 v118 offset:7616
    ds_write_addtid_b32 v119 offset:7888
    ds_write_addtid_b32 v120 offset:8160
    ds_write_addtid_b32 v121 offset:8432
    s_waitcnt lgkmcnt(0)
    s_nop 0
    ds_read_b128 v[152:155], v5 offset:8704
    ds_read_b128 v[156:159], v5 offset:0
    ds_read_b128 v[160:163], v5 offset:8736
    ds_read_b128 v[164:167], v5 offset:32
    ds_read_b128 v[168:171], v5 offset:8768
    ds_read_b128 v[172:175], v5 offset:64
    ds_read_b128 v[176:179], v5 offset:8800
    ds_read_b128 v[180:183], v5 offset:96
    ds_read_b128 v[184:187], v5 offset:8832
    ds_read_b128 v[188:191], v5 offset:128
    ds_read_b128 v[192:195], v5 offset:8864
    ds_read_b128 v[196:199], v5 offset:160
    ds_read_b128 v[200:203], v5 offset:8896
    ds_read_b128 v[204:207], v5 offset:192
    ds_read_b128 v[208:211], v5 offset:8928
    ds_read_b128 v[212:215], v5 offset:224
    v_and_b32 v20, 0xffff0000, v8
    v_and_b32 v21, 0xffff0000, v9
    v_and_b32 v24, 0xffff0000, v10
    v_and_b32 v25, 0xffff0000, v11
    v_and_b32 v26, 0xffff0000, v12
    v_and_b32 v27, 0xffff0000, v13
    v_pk_mul_f32 v[20:21], v[20:21], v[6:7] op_sel_hi:[1,0]
    v_pk_mul_f32 v[24:25], v[24:25], v[6:7] op_sel_hi:[1,0]
    v_mul_f32 v20, 0x3fb8aa3b, v20
    v_mul_f32 v21, 0x3e22f983, v21
    v_pk_mul_f32 v[76:77], v[26:27], v[24:25] op_sel_hi:[0,1]
    v_pk_fma_f32 v[76:77], v[26:27], v[24:25], v[76:77] op_sel:[1,1,0] op_sel_hi:[1,0,1] neg_lo:[1,0,0]
    v_mul_f32 v128, 0x42800000, v20
    v_mov_b32 v130, v20
    v_mul_f32 v129, 0x42800000, v21
    v_mov_b32 v131, v21
    v_exp_f32 v128, v128
    v_exp_f32 v130, v130
    v_fract_f32 v129, v129
    v_fract_f32 v131, v131
    v_cos_f32 v46, v129
    v_cos_f32 v64, v131
    v_sin_f32 v47, v129
    v_sin_f32_e64 v65, v131
    v_pk_mul_f32 v[46:47], v[46:47], v[128:129] op_sel_hi:[1,0]
    v_pk_mul_f32 v[64:65], v[64:65], v[130:131] op_sel_hi:[1,0]
    v_pk_mul_f32 v[62:63], v[46:47], v[46:47] op_sel_hi:[0,1]
    v_pk_mul_f32 v[66:67], v[64:65], v[64:65] op_sel_hi:[0,1]
    v_pk_fma_f32 v[62:63], v[46:47], v[46:47], v[62:63] op_sel:[1,1,0] op_sel_hi:[1,0,1] neg_lo:[1,0,0]
    v_pk_fma_f32 v[66:67], v[64:65], v[64:65], v[66:67] op_sel:[1,1,0] op_sel_hi:[1,0,1] neg_lo:[1,0,0]
    v_pk_mul_f32 v[70:71], v[62:63], v[62:63] op_sel_hi:[0,1]
    v_pk_mul_f32 v[68:69], v[66:67], v[66:67] op_sel_hi:[0,1]
    v_pk_fma_f32 v[70:71], v[62:63], v[62:63], v[70:71] op_sel:[1,1,0] op_sel_hi:[1,0,1] neg_lo:[1,0,0]
    v_pk_fma_f32 v[68:69], v[66:67], v[66:67], v[68:69] op_sel:[1,1,0] op_sel_hi:[1,0,1] neg_lo:[1,0,0]
    v_pk_mul_f32 v[72:73], v[70:71], v[70:71] op_sel_hi:[0,1]
    v_pk_mul_f32 v[32:33], v[68:69], v[68:69] op_sel_hi:[0,1]
    v_pk_fma_f32 v[72:73], v[70:71], v[70:71], v[72:73] op_sel:[1,1,0] op_sel_hi:[1,0,1] neg_lo:[1,0,0]
    v_pk_fma_f32 v[32:33], v[68:69], v[68:69], v[32:33] op_sel:[1,1,0] op_sel_hi:[1,0,1] neg_lo:[1,0,0]
    v_pk_mul_f32 v[74:75], v[72:73], v[72:73] op_sel_hi:[0,1]
    v_pk_mul_f32 v[34:35], v[32:33], v[32:33] op_sel_hi:[0,1]
    v_pk_fma_f32 v[74:75], v[72:73], v[72:73], v[74:75] op_sel:[1,1,0] op_sel_hi:[1,0,1] neg_lo:[1,0,0]
    v_pk_fma_f32 v[34:35], v[32:33], v[32:33], v[34:35] op_sel:[1,1,0] op_sel_hi:[1,0,1] neg_lo:[1,0,0]
    v_pk_mul_f32 v[38:39], v[34:35], v[34:35] op_sel_hi:[0,1]
    v_pk_mul_f32 v[36:37], v[34:35], v[32:33] op_sel_hi:[0,1]
    v_pk_fma_f32 v[38:39], v[34:35], v[34:35], v[38:39] op_sel:[1,1,0] op_sel_hi:[1,0,1] neg_lo:[1,0,0]
    v_pk_fma_f32 v[36:37], v[34:35], v[32:33], v[36:37] op_sel:[1,1,0] op_sel_hi:[1,0,1] neg_lo:[1,0,0]
    s_waitcnt lgkmcnt(0)
    s_nop 0
    v_cvt_pk_bf16_f32 v118, v32, v33
    v_cvt_pk_bf16_f32 v119, v34, v35
    v_cvt_pk_bf16_f32 v120, v46, v47
    v_cvt_pk_bf16_f32 v121, v62, v63
    v_cvt_pk_bf16_f32 v122, v38, v39
    v_cvt_pk_bf16_f32 v123, v36, v37
    v_cvt_pk_bf16_f32 v124, v76, -v77
    v_pk_mul_f32 v[40:41], v[38:39], v[32:33] op_sel_hi:[0,1]
    v_pk_mul_f32 v[42:43], v[38:39], v[34:35] op_sel_hi:[0,1]
    v_pk_fma_f32 v[40:41], v[38:39], v[32:33], v[40:41] op_sel:[1,1,0] op_sel_hi:[1,0,1] neg_lo:[1,0,0]
    v_pk_fma_f32 v[42:43], v[38:39], v[34:35], v[42:43] op_sel:[1,1,0] op_sel_hi:[1,0,1] neg_lo:[1,0,0]
    v_cvt_pk_bf16_f32 v125, v40, v41
    v_mfma_f32_32x32x16_bf16 v[136:151], v[152:155], v[156:159], 0
    ds_write_addtid_b32 v118 offset:272
    ds_write_addtid_b32 v119 offset:544
    ds_write_addtid_b32 v120 offset:2176
    ds_write_addtid_b32 v121 offset:4352
    ds_write_addtid_b32 v122 offset:1088
    ds_write_addtid_b32 v123 offset:816
    ds_write_addtid_b32 v124 offset:8704
    ds_write_addtid_b32 v125 offset:1360
    v_cvt_pk_bf16_f32 v118, v42, v43
    v_pk_mul_f32 v[44:45], v[38:39], v[36:37] op_sel_hi:[0,1]
    v_pk_mul_f32 v[78:79], v[76:77], v[64:65] op_sel_hi:[0,1]
    v_pk_fma_f32 v[44:45], v[38:39], v[36:37], v[44:45] op_sel:[1,1,0] op_sel_hi:[1,0,1] neg_lo:[1,0,0]
    v_pk_fma_f32 v[78:79], v[76:77], v[64:65], v[78:79] op_sel:[1,1,0] op_sel_hi:[1,0,1] neg_lo:[1,0,0]
    v_cvt_pk_bf16_f32 v119, v44, v45
    v_cvt_pk_bf16_f32 v120, v78, -v79
    v_pk_mul_f32 v[80:81], v[76:77], v[66:67] op_sel_hi:[0,1]
    v_pk_mul_f32 v[84:85], v[76:77], v[68:69] op_sel_hi:[0,1]
    v_pk_fma_f32 v[80:81], v[76:77], v[66:67], v[80:81] op_sel:[1,1,0] op_sel_hi:[1,0,1] neg_lo:[1,0,0]
    v_pk_fma_f32 v[84:85], v[76:77], v[68:69], v[84:85] op_sel:[1,1,0] op_sel_hi:[1,0,1] neg_lo:[1,0,0]
    v_cvt_pk_bf16_f32 v121, v80, -v81
    v_cvt_pk_bf16_f32 v122, v84, -v85
    v_pk_mul_f32 v[48:49], v[46:47], v[32:33] op_sel_hi:[0,1]
    v_pk_mul_f32 v[50:51], v[46:47], v[34:35] op_sel_hi:[0,1]
    v_pk_fma_f32 v[48:49], v[46:47], v[32:33], v[48:49] op_sel:[1,1,0] op_sel_hi:[1,0,1] neg_lo:[1,0,0]
    v_pk_fma_f32 v[50:51], v[46:47], v[34:35], v[50:51] op_sel:[1,1,0] op_sel_hi:[1,0,1] neg_lo:[1,0,0]
    v_cvt_pk_bf16_f32 v123, v48, v49
    v_cvt_pk_bf16_f32 v124, v50, v51
    v_pk_mul_f32 v[52:53], v[46:47], v[36:37] op_sel_hi:[0,1]
    v_pk_mul_f32 v[54:55], v[46:47], v[38:39] op_sel_hi:[0,1]
    v_pk_fma_f32 v[52:53], v[46:47], v[36:37], v[52:53] op_sel:[1,1,0] op_sel_hi:[1,0,1] neg_lo:[1,0,0]
    v_pk_fma_f32 v[54:55], v[46:47], v[38:39], v[54:55] op_sel:[1,1,0] op_sel_hi:[1,0,1] neg_lo:[1,0,0]
    v_cvt_pk_bf16_f32 v125, v52, v53
    v_mfma_f32_32x32x16_bf16 v[136:151], v[160:163], v[164:167], v[136:151]
    ds_write_addtid_b32 v118 offset:1632
    ds_write_addtid_b32 v119 offset:1904
    ds_write_addtid_b32 v120 offset:8976
    ds_write_addtid_b32 v121 offset:9248
    ds_write_addtid_b32 v122 offset:9792
    ds_write_addtid_b32 v123 offset:2448
    ds_write_addtid_b32 v124 offset:2720
    ds_write_addtid_b32 v125 offset:2992
    v_cvt_pk_bf16_f32 v118, v54, v55
    v_pk_mul_f32 v[56:57], v[46:47], v[40:41] op_sel_hi:[0,1]
    v_pk_mul_f32 v[58:59], v[46:47], v[42:43] op_sel_hi:[0,1]
    v_pk_fma_f32 v[56:57], v[46:47], v[40:41], v[56:57] op_sel:[1,1,0] op_sel_hi:[1,0,1] neg_lo:[1,0,0]
    v_pk_fma_f32 v[58:59], v[46:47], v[42:43], v[58:59] op_sel:[1,1,0] op_sel_hi:[1,0,1] neg_lo:[1,0,0]
    v_cvt_pk_bf16_f32 v119, v56, v57
    v_cvt_pk_bf16_f32 v120, v58, v59
    v_pk_mul_f32 v[60:61], v[46:47], v[44:45] op_sel_hi:[0,1]
    v_pk_mul_f32 v[82:83], v[78:79], v[66:67] op_sel_hi:[0,1]
    v_pk_fma_f32 v[60:61], v[46:47], v[44:45], v[60:61] op_sel:[1,1,0] op_sel_hi:[1,0,1] neg_lo:[1,0,0]
    v_pk_fma_f32 v[82:83], v[78:79], v[66:67], v[82:83] op_sel:[1,1,0] op_sel_hi:[1,0,1] neg_lo:[1,0,0]
    v_cvt_pk_bf16_f32 v121, v60, v61
    v_cvt_pk_bf16_f32 v122, v82, -v83
    v_pk_mul_f32 v[86:87], v[78:79], v[68:69] op_sel_hi:[0,1]
    v_pk_mul_f32 v[88:89], v[80:81], v[68:69] op_sel_hi:[0,1]
    v_pk_fma_f32 v[86:87], v[78:79], v[68:69], v[86:87] op_sel:[1,1,0] op_sel_hi:[1,0,1] neg_lo:[1,0,0]
    v_pk_fma_f32 v[88:89], v[80:81], v[68:69], v[88:89] op_sel:[1,1,0] op_sel_hi:[1,0,1] neg_lo:[1,0,0]
    v_cvt_pk_bf16_f32 v123, v86, -v87
    v_cvt_pk_bf16_f32 v124, v88, -v89
    v_pk_mul_f32 v[92:93], v[76:77], v[70:71] op_sel_hi:[0,1]
    v_pk_mul_f32 v[100:101], v[76:77], v[72:73] op_sel_hi:[0,1]
    v_pk_fma_f32 v[92:93], v[76:77], v[70:71], v[92:93] op_sel:[1,1,0] op_sel_hi:[1,0,1] neg_lo:[1,0,0]
    v_pk_fma_f32 v[100:101], v[76:77], v[72:73], v[100:101] op_sel:[1,1,0] op_sel_hi:[1,0,1] neg_lo:[1,0,0]
    v_cvt_pk_bf16_f32 v125, v92, -v93
    v_mfma_f32_32x32x16_bf16 v[136:151], v[168:171], v[172:175], v[136:151]
    ds_write_addtid_b32 v118 offset:3264
    ds_write_addtid_b32 v119 offset:3536
    ds_write_addtid_b32 v120 offset:3808
    ds_write_addtid_b32 v121 offset:4080
    ds_write_addtid_b32 v122 offset:9520
    ds_write_addtid_b32 v123 offset:10064
    ds_write_addtid_b32 v124 offset:10336
    ds_write_addtid_b32 v125 offset:10880
    v_cvt_pk_bf16_f32 v118, v100, -v101
    v_pk_mul_f32 v[108:109], v[76:77], v[74:75] op_sel_hi:[0,1]
    v_pk_mul_f32 v[90:91], v[82:83], v[68:69] op_sel_hi:[0,1]
    v_pk_fma_f32 v[108:109], v[76:77], v[74:75], v[108:109] op_sel:[1,1,0] op_sel_hi:[1,0,1] neg_lo:[1,0,0]
    v_pk_fma_f32 v[90:91], v[82:83], v[68:69], v[90:91] op_sel:[1,1,0] op_sel_hi:[1,0,1] neg_lo:[1,0,0]
    v_cvt_pk_bf16_f32 v119, v108, -v109
    v_cvt_pk_bf16_f32 v120, v90, -v91
    v_pk_mul_f32 v[94:95], v[80:81], v[70:71] op_sel_hi:[0,1]
    v_pk_mul_f32 v[96:97], v[84:85], v[70:71] op_sel_hi:[0,1]
    v_pk_fma_f32 v[94:95], v[80:81], v[70:71], v[94:95] op_sel:[1,1,0] op_sel_hi:[1,0,1] neg_lo:[1,0,0]
    v_pk_fma_f32 v[96:97], v[84:85], v[70:71], v[96:97] op_sel:[1,1,0] op_sel_hi:[1,0,1] neg_lo:[1,0,0]
    v_cvt_pk_bf16_f32 v121, v94, -v95
    v_cvt_pk_bf16_f32 v122, v96, -v97
    v_pk_mul_f32 v[98:99], v[88:89], v[70:71] op_sel_hi:[0,1]
    v_pk_mul_f32 v[102:103], v[84:85], v[72:73] op_sel_hi:[0,1]
    v_pk_fma_f32 v[98:99], v[88:89], v[70:71], v[98:99] op_sel:[1,1,0] op_sel_hi:[1,0,1] neg_lo:[1,0,0]
    v_pk_fma_f32 v[102:103], v[84:85], v[72:73], v[102:103] op_sel:[1,1,0] op_sel_hi:[1,0,1] neg_lo:[1,0,0]
    v_cvt_pk_bf16_f32 v123, v98, -v99
    v_cvt_pk_bf16_f32 v124, v102, -v103
    v_pk_mul_f32 v[104:105], v[92:93], v[72:73] op_sel_hi:[0,1]
    v_pk_mul_f32 v[106:107], v[96:97], v[72:73] op_sel_hi:[0,1]
    v_pk_fma_f32 v[104:105], v[92:93], v[72:73], v[104:105] op_sel:[1,1,0] op_sel_hi:[1,0,1] neg_lo:[1,0,0]
    v_pk_fma_f32 v[106:107], v[96:97], v[72:73], v[106:107] op_sel:[1,1,0] op_sel_hi:[1,0,1] neg_lo:[1,0,0]
    v_cvt_pk_bf16_f32 v125, v104, -v105
    v_mfma_f32_32x32x16_bf16 v[136:151], v[176:179], v[180:183], v[136:151]
    ds_write_addtid_b32 v118 offset:11968
    ds_write_addtid_b32 v119 offset:13056
    ds_write_addtid_b32 v120 offset:10608
    ds_write_addtid_b32 v121 offset:11152
    ds_write_addtid_b32 v122 offset:11424
    ds_write_addtid_b32 v123 offset:11696
    ds_write_addtid_b32 v124 offset:12240
    ds_write_addtid_b32 v125 offset:12512
    v_cvt_pk_bf16_f32 v118, v106, -v107
    v_pk_mul_f32 v[110:111], v[92:93], v[74:75] op_sel_hi:[0,1]
    v_pk_mul_f32 v[112:113], v[100:101], v[74:75] op_sel_hi:[0,1]
    v_pk_fma_f32 v[110:111], v[92:93], v[74:75], v[110:111] op_sel:[1,1,0] op_sel_hi:[1,0,1] neg_lo:[1,0,0]
    v_pk_fma_f32 v[112:113], v[100:101], v[74:75], v[112:113] op_sel:[1,1,0] op_sel_hi:[1,0,1] neg_lo:[1,0,0]
    v_cvt_pk_bf16_f32 v119, v110, -v111
    v_cvt_pk_bf16_f32 v120, v112, -v113
    v_pk_mul_f32 v[114:115], v[104:105], v[74:75] op_sel_hi:[0,1]
    v_pk_mul_f32 v[116:117], v[108:109], v[74:75] op_sel_hi:[0,1]
    v_pk_fma_f32 v[114:115], v[104:105], v[74:75], v[114:115] op_sel:[1,1,0] op_sel_hi:[1,0,1] neg_lo:[1,0,0]
    v_pk_fma_f32 v[116:117], v[108:109], v[74:75], v[116:117] op_sel:[1,1,0] op_sel_hi:[1,0,1] neg_lo:[1,0,0]
    v_cvt_pk_bf16_f32 v121, v114, -v115
    v_cvt_pk_bf16_f32 v122, v116, -v117
    v_pk_mul_f32 v[126:127], v[62:63], v[32:33] op_sel_hi:[0,1]
    v_pk_mul_f32 v[128:129], v[62:63], v[34:35] op_sel_hi:[0,1]
    v_pk_fma_f32 v[126:127], v[62:63], v[32:33], v[126:127] op_sel:[1,1,0] op_sel_hi:[1,0,1] neg_lo:[1,0,0]
    v_pk_fma_f32 v[128:129], v[62:63], v[34:35], v[128:129] op_sel:[1,1,0] op_sel_hi:[1,0,1] neg_lo:[1,0,0]
    v_cvt_pk_bf16_f32 v123, v126, v127
    v_cvt_pk_bf16_f32 v124, v128, v129
    v_pk_mul_f32 v[130:131], v[62:63], v[36:37] op_sel_hi:[0,1]
    v_pk_mul_f32 v[132:133], v[62:63], v[38:39] op_sel_hi:[0,1]
    v_pk_fma_f32 v[130:131], v[62:63], v[36:37], v[130:131] op_sel:[1,1,0] op_sel_hi:[1,0,1] neg_lo:[1,0,0]
    v_pk_fma_f32 v[132:133], v[62:63], v[38:39], v[132:133] op_sel:[1,1,0] op_sel_hi:[1,0,1] neg_lo:[1,0,0]
    v_cvt_pk_bf16_f32 v125, v130, v131
    v_mfma_f32_32x32x16_bf16 v[136:151], v[184:187], v[188:191], v[136:151]
    ds_write_addtid_b32 v118 offset:12784
    ds_write_addtid_b32 v119 offset:13328
    ds_write_addtid_b32 v120 offset:13600
    ds_write_addtid_b32 v121 offset:13872
    ds_write_addtid_b32 v122 offset:14144
    ds_write_addtid_b32 v123 offset:4624
    ds_write_addtid_b32 v124 offset:4896
    ds_write_addtid_b32 v125 offset:5168
    v_cvt_pk_bf16_f32 v118, v132, v133
    v_pk_mul_f32 v[126:127], v[62:63], v[40:41] op_sel_hi:[0,1]
    v_pk_mul_f32 v[128:129], v[62:63], v[42:43] op_sel_hi:[0,1]
    v_pk_fma_f32 v[126:127], v[62:63], v[40:41], v[126:127] op_sel:[1,1,0] op_sel_hi:[1,0,1] neg_lo:[1,0,0]
    v_pk_fma_f32 v[128:129], v[62:63], v[42:43], v[128:129] op_sel:[1,1,0] op_sel_hi:[1,0,1] neg_lo:[1,0,0]
    v_cvt_pk_bf16_f32 v119, v126, v127
    v_cvt_pk_bf16_f32 v120, v128, v129
    v_pk_mul_f32 v[130:131], v[62:63], v[44:45] op_sel_hi:[0,1]
    v_pk_mul_f32 v[132:133], v[62:63], v[46:47] op_sel_hi:[0,1]
    v_pk_fma_f32 v[130:131], v[62:63], v[44:45], v[130:131] op_sel:[1,1,0] op_sel_hi:[1,0,1] neg_lo:[1,0,0]
    v_pk_fma_f32 v[132:133], v[62:63], v[46:47], v[132:133] op_sel:[1,1,0] op_sel_hi:[1,0,1] neg_lo:[1,0,0]
    v_cvt_pk_bf16_f32 v121, v130, v131
    v_cvt_pk_bf16_f32 v122, v132, v133
    v_pk_mul_f32 v[126:127], v[62:63], v[48:49] op_sel_hi:[0,1]
    v_pk_mul_f32 v[128:129], v[62:63], v[50:51] op_sel_hi:[0,1]
    v_pk_fma_f32 v[126:127], v[62:63], v[48:49], v[126:127] op_sel:[1,1,0] op_sel_hi:[1,0,1] neg_lo:[1,0,0]
    v_pk_fma_f32 v[128:129], v[62:63], v[50:51], v[128:129] op_sel:[1,1,0] op_sel_hi:[1,0,1] neg_lo:[1,0,0]
    v_cvt_pk_bf16_f32 v123, v126, v127
    v_cvt_pk_bf16_f32 v124, v128, v129
    v_pk_mul_f32 v[130:131], v[62:63], v[52:53] op_sel_hi:[0,1]
    v_pk_mul_f32 v[132:133], v[62:63], v[54:55] op_sel_hi:[0,1]
    v_pk_fma_f32 v[130:131], v[62:63], v[52:53], v[130:131] op_sel:[1,1,0] op_sel_hi:[1,0,1] neg_lo:[1,0,0]
    v_pk_fma_f32 v[132:133], v[62:63], v[54:55], v[132:133] op_sel:[1,1,0] op_sel_hi:[1,0,1] neg_lo:[1,0,0]
    v_cvt_pk_bf16_f32 v125, v130, v131
    v_mfma_f32_32x32x16_bf16 v[136:151], v[192:195], v[196:199], v[136:151]
    ds_write_addtid_b32 v118 offset:5440
    ds_write_addtid_b32 v119 offset:5712
    ds_write_addtid_b32 v120 offset:5984
    ds_write_addtid_b32 v121 offset:6256
    ds_write_addtid_b32 v122 offset:6528
    ds_write_addtid_b32 v123 offset:6800
    ds_write_addtid_b32 v124 offset:7072
    ds_write_addtid_b32 v125 offset:7344
    v_cvt_pk_bf16_f32 v118, v132, v133
    v_pk_mul_f32 v[126:127], v[62:63], v[56:57] op_sel_hi:[0,1]
    v_pk_mul_f32 v[128:129], v[62:63], v[58:59] op_sel_hi:[0,1]
    v_pk_fma_f32 v[126:127], v[62:63], v[56:57], v[126:127] op_sel:[1,1,0] op_sel_hi:[1,0,1] neg_lo:[1,0,0]
    v_pk_fma_f32 v[128:129], v[62:63], v[58:59], v[128:129] op_sel:[1,1,0] op_sel_hi:[1,0,1] neg_lo:[1,0,0]
    v_cvt_pk_bf16_f32 v119, v126, v127
    v_cvt_pk_bf16_f32 v120, v128, v129
    v_pk_mul_f32 v[130:131], v[62:63], v[60:61] op_sel_hi:[0,1]
    v_pk_fma_f32 v[130:131], v[62:63], v[60:61], v[130:131] op_sel:[1,1,0] op_sel_hi:[1,0,1] neg_lo:[1,0,0]
    v_cvt_pk_bf16_f32 v121, v130, v131
    v_mfma_f32_32x32x16_bf16 v[136:151], v[200:203], v[204:207], v[136:151]
    ds_write_addtid_b32 v118 offset:7616
    ds_write_addtid_b32 v119 offset:7888
    ds_write_addtid_b32 v120 offset:8160
    ds_write_addtid_b32 v121 offset:8432
    v_mfma_f32_32x32x16_bf16 v[136:151], v[208:211], v[212:215], v[136:151]
    s_waitcnt lgkmcnt(0)
    s_nop 0
    ds_read_b128 v[152:155], v5 offset:8704
    ds_read_b128 v[156:159], v5 offset:0
    ds_read_b128 v[160:163], v5 offset:8736
    ds_read_b128 v[164:167], v5 offset:32
    ds_read_b128 v[168:171], v5 offset:8768
    ds_read_b128 v[172:175], v5 offset:64
    ds_read_b128 v[176:179], v5 offset:8800
    ds_read_b128 v[180:183], v5 offset:96
    ds_read_b128 v[184:187], v5 offset:8832
    ds_read_b128 v[188:191], v5 offset:128
    ds_read_b128 v[192:195], v5 offset:8864
    ds_read_b128 v[196:199], v5 offset:160
    ds_read_b128 v[200:203], v5 offset:8896
    ds_read_b128 v[204:207], v5 offset:192
    ds_read_b128 v[208:211], v5 offset:8928
    ds_read_b128 v[212:215], v5 offset:224
    v_lshlrev_b32 v20, 16, v14
    v_lshlrev_b32 v21, 16, v15
    v_lshlrev_b32 v24, 16, v16
    v_lshlrev_b32 v25, 16, v17
    v_lshlrev_b32 v26, 16, v18
    v_lshlrev_b32 v27, 16, v19
    v_pk_mul_f32 v[20:21], v[20:21], v[6:7] op_sel_hi:[1,0]
    v_pk_mul_f32 v[24:25], v[24:25], v[6:7] op_sel_hi:[1,0]
    v_mul_f32 v20, 0x3fb8aa3b, v20
    v_mul_f32 v21, 0x3e22f983, v21
    v_pk_mul_f32 v[76:77], v[26:27], v[24:25] op_sel_hi:[0,1]
    v_pk_fma_f32 v[76:77], v[26:27], v[24:25], v[76:77] op_sel:[1,1,0] op_sel_hi:[1,0,1] neg_lo:[1,0,0]
    v_mul_f32 v128, 0x42800000, v20
    v_mov_b32 v130, v20
    v_mul_f32 v129, 0x42800000, v21
    v_mov_b32 v131, v21
    v_exp_f32 v128, v128
    v_exp_f32 v130, v130
    v_fract_f32 v129, v129
    v_fract_f32 v131, v131
    v_cos_f32 v46, v129
    v_cos_f32 v64, v131
    v_sin_f32 v47, v129
    v_sin_f32_e64 v65, v131
    v_pk_mul_f32 v[46:47], v[46:47], v[128:129] op_sel_hi:[1,0]
    v_pk_mul_f32 v[64:65], v[64:65], v[130:131] op_sel_hi:[1,0]
    v_pk_mul_f32 v[62:63], v[46:47], v[46:47] op_sel_hi:[0,1]
    v_pk_mul_f32 v[66:67], v[64:65], v[64:65] op_sel_hi:[0,1]
    v_pk_fma_f32 v[62:63], v[46:47], v[46:47], v[62:63] op_sel:[1,1,0] op_sel_hi:[1,0,1] neg_lo:[1,0,0]
    v_pk_fma_f32 v[66:67], v[64:65], v[64:65], v[66:67] op_sel:[1,1,0] op_sel_hi:[1,0,1] neg_lo:[1,0,0]
    v_pk_mul_f32 v[70:71], v[62:63], v[62:63] op_sel_hi:[0,1]
    v_pk_mul_f32 v[68:69], v[66:67], v[66:67] op_sel_hi:[0,1]
    v_pk_fma_f32 v[70:71], v[62:63], v[62:63], v[70:71] op_sel:[1,1,0] op_sel_hi:[1,0,1] neg_lo:[1,0,0]
    v_pk_fma_f32 v[68:69], v[66:67], v[66:67], v[68:69] op_sel:[1,1,0] op_sel_hi:[1,0,1] neg_lo:[1,0,0]
    v_pk_mul_f32 v[72:73], v[70:71], v[70:71] op_sel_hi:[0,1]
    v_pk_mul_f32 v[32:33], v[68:69], v[68:69] op_sel_hi:[0,1]
    v_pk_fma_f32 v[72:73], v[70:71], v[70:71], v[72:73] op_sel:[1,1,0] op_sel_hi:[1,0,1] neg_lo:[1,0,0]
    v_pk_fma_f32 v[32:33], v[68:69], v[68:69], v[32:33] op_sel:[1,1,0] op_sel_hi:[1,0,1] neg_lo:[1,0,0]
    v_pk_mul_f32 v[74:75], v[72:73], v[72:73] op_sel_hi:[0,1]
    v_pk_mul_f32 v[34:35], v[32:33], v[32:33] op_sel_hi:[0,1]
    v_pk_fma_f32 v[74:75], v[72:73], v[72:73], v[74:75] op_sel:[1,1,0] op_sel_hi:[1,0,1] neg_lo:[1,0,0]
    v_pk_fma_f32 v[34:35], v[32:33], v[32:33], v[34:35] op_sel:[1,1,0] op_sel_hi:[1,0,1] neg_lo:[1,0,0]
    v_pk_mul_f32 v[38:39], v[34:35], v[34:35] op_sel_hi:[0,1]
    v_pk_mul_f32 v[36:37], v[34:35], v[32:33] op_sel_hi:[0,1]
    v_pk_fma_f32 v[38:39], v[34:35], v[34:35], v[38:39] op_sel:[1,1,0] op_sel_hi:[1,0,1] neg_lo:[1,0,0]
    v_pk_fma_f32 v[36:37], v[34:35], v[32:33], v[36:37] op_sel:[1,1,0] op_sel_hi:[1,0,1] neg_lo:[1,0,0]
    s_waitcnt lgkmcnt(0)
    s_nop 0
    v_cvt_pk_bf16_f32 v118, v32, v33
    v_cvt_pk_bf16_f32 v119, v34, v35
    v_cvt_pk_bf16_f32 v120, v46, v47
    v_cvt_pk_bf16_f32 v121, v62, v63
    v_cvt_pk_bf16_f32 v122, v38, v39
    v_cvt_pk_bf16_f32 v123, v36, v37
    v_cvt_pk_bf16_f32 v124, v76, -v77
    v_pk_mul_f32 v[40:41], v[38:39], v[32:33] op_sel_hi:[0,1]
    v_pk_mul_f32 v[42:43], v[38:39], v[34:35] op_sel_hi:[0,1]
    v_pk_fma_f32 v[40:41], v[38:39], v[32:33], v[40:41] op_sel:[1,1,0] op_sel_hi:[1,0,1] neg_lo:[1,0,0]
    v_pk_fma_f32 v[42:43], v[38:39], v[34:35], v[42:43] op_sel:[1,1,0] op_sel_hi:[1,0,1] neg_lo:[1,0,0]
    v_cvt_pk_bf16_f32 v125, v40, v41
    v_mfma_f32_32x32x16_bf16 v[136:151], v[152:155], v[156:159], v[136:151]
    ds_write_addtid_b32 v118 offset:272
    ds_write_addtid_b32 v119 offset:544
    ds_write_addtid_b32 v120 offset:2176
    ds_write_addtid_b32 v121 offset:4352
    ds_write_addtid_b32 v122 offset:1088
    ds_write_addtid_b32 v123 offset:816
    ds_write_addtid_b32 v124 offset:8704
    ds_write_addtid_b32 v125 offset:1360
    v_cvt_pk_bf16_f32 v118, v42, v43
    v_pk_mul_f32 v[44:45], v[38:39], v[36:37] op_sel_hi:[0,1]
    v_pk_mul_f32 v[78:79], v[76:77], v[64:65] op_sel_hi:[0,1]
    v_pk_fma_f32 v[44:45], v[38:39], v[36:37], v[44:45] op_sel:[1,1,0] op_sel_hi:[1,0,1] neg_lo:[1,0,0]
    v_pk_fma_f32 v[78:79], v[76:77], v[64:65], v[78:79] op_sel:[1,1,0] op_sel_hi:[1,0,1] neg_lo:[1,0,0]
    v_cvt_pk_bf16_f32 v119, v44, v45
    v_cvt_pk_bf16_f32 v120, v78, -v79
    v_pk_mul_f32 v[80:81], v[76:77], v[66:67] op_sel_hi:[0,1]
    v_pk_mul_f32 v[84:85], v[76:77], v[68:69] op_sel_hi:[0,1]
    v_pk_fma_f32 v[80:81], v[76:77], v[66:67], v[80:81] op_sel:[1,1,0] op_sel_hi:[1,0,1] neg_lo:[1,0,0]
    v_pk_fma_f32 v[84:85], v[76:77], v[68:69], v[84:85] op_sel:[1,1,0] op_sel_hi:[1,0,1] neg_lo:[1,0,0]
    v_cvt_pk_bf16_f32 v121, v80, -v81
    v_cvt_pk_bf16_f32 v122, v84, -v85
    v_pk_mul_f32 v[48:49], v[46:47], v[32:33] op_sel_hi:[0,1]
    v_pk_mul_f32 v[50:51], v[46:47], v[34:35] op_sel_hi:[0,1]
    v_pk_fma_f32 v[48:49], v[46:47], v[32:33], v[48:49] op_sel:[1,1,0] op_sel_hi:[1,0,1] neg_lo:[1,0,0]
    v_pk_fma_f32 v[50:51], v[46:47], v[34:35], v[50:51] op_sel:[1,1,0] op_sel_hi:[1,0,1] neg_lo:[1,0,0]
    v_cvt_pk_bf16_f32 v123, v48, v49
    v_cvt_pk_bf16_f32 v124, v50, v51
    v_pk_mul_f32 v[52:53], v[46:47], v[36:37] op_sel_hi:[0,1]
    v_pk_mul_f32 v[54:55], v[46:47], v[38:39] op_sel_hi:[0,1]
    v_pk_fma_f32 v[52:53], v[46:47], v[36:37], v[52:53] op_sel:[1,1,0] op_sel_hi:[1,0,1] neg_lo:[1,0,0]
    v_pk_fma_f32 v[54:55], v[46:47], v[38:39], v[54:55] op_sel:[1,1,0] op_sel_hi:[1,0,1] neg_lo:[1,0,0]
    v_cvt_pk_bf16_f32 v125, v52, v53
    v_mfma_f32_32x32x16_bf16 v[136:151], v[160:163], v[164:167], v[136:151]
    ds_write_addtid_b32 v118 offset:1632
    ds_write_addtid_b32 v119 offset:1904
    ds_write_addtid_b32 v120 offset:8976
    ds_write_addtid_b32 v121 offset:9248
    ds_write_addtid_b32 v122 offset:9792
    ds_write_addtid_b32 v123 offset:2448
    ds_write_addtid_b32 v124 offset:2720
    ds_write_addtid_b32 v125 offset:2992
    v_cvt_pk_bf16_f32 v118, v54, v55
    v_pk_mul_f32 v[56:57], v[46:47], v[40:41] op_sel_hi:[0,1]
    v_pk_mul_f32 v[58:59], v[46:47], v[42:43] op_sel_hi:[0,1]
    v_pk_fma_f32 v[56:57], v[46:47], v[40:41], v[56:57] op_sel:[1,1,0] op_sel_hi:[1,0,1] neg_lo:[1,0,0]
    v_pk_fma_f32 v[58:59], v[46:47], v[42:43], v[58:59] op_sel:[1,1,0] op_sel_hi:[1,0,1] neg_lo:[1,0,0]
    v_cvt_pk_bf16_f32 v119, v56, v57
    v_cvt_pk_bf16_f32 v120, v58, v59
    v_pk_mul_f32 v[60:61], v[46:47], v[44:45] op_sel_hi:[0,1]
    v_pk_mul_f32 v[82:83], v[78:79], v[66:67] op_sel_hi:[0,1]
    v_pk_fma_f32 v[60:61], v[46:47], v[44:45], v[60:61] op_sel:[1,1,0] op_sel_hi:[1,0,1] neg_lo:[1,0,0]
    v_pk_fma_f32 v[82:83], v[78:79], v[66:67], v[82:83] op_sel:[1,1,0] op_sel_hi:[1,0,1] neg_lo:[1,0,0]
    v_cvt_pk_bf16_f32 v121, v60, v61
    v_cvt_pk_bf16_f32 v122, v82, -v83
    v_pk_mul_f32 v[86:87], v[78:79], v[68:69] op_sel_hi:[0,1]
    v_pk_mul_f32 v[88:89], v[80:81], v[68:69] op_sel_hi:[0,1]
    v_pk_fma_f32 v[86:87], v[78:79], v[68:69], v[86:87] op_sel:[1,1,0] op_sel_hi:[1,0,1] neg_lo:[1,0,0]
    v_pk_fma_f32 v[88:89], v[80:81], v[68:69], v[88:89] op_sel:[1,1,0] op_sel_hi:[1,0,1] neg_lo:[1,0,0]
    v_cvt_pk_bf16_f32 v123, v86, -v87
    v_cvt_pk_bf16_f32 v124, v88, -v89
    v_pk_mul_f32 v[92:93], v[76:77], v[70:71] op_sel_hi:[0,1]
    v_pk_mul_f32 v[100:101], v[76:77], v[72:73] op_sel_hi:[0,1]
    v_pk_fma_f32 v[92:93], v[76:77], v[70:71], v[92:93] op_sel:[1,1,0] op_sel_hi:[1,0,1] neg_lo:[1,0,0]
    v_pk_fma_f32 v[100:101], v[76:77], v[72:73], v[100:101] op_sel:[1,1,0] op_sel_hi:[1,0,1] neg_lo:[1,0,0]
    v_cvt_pk_bf16_f32 v125, v92, -v93
    v_mfma_f32_32x32x16_bf16 v[136:151], v[168:171], v[172:175], v[136:151]
    ds_write_addtid_b32 v118 offset:3264
    ds_write_addtid_b32 v119 offset:3536
    ds_write_addtid_b32 v120 offset:3808
    ds_write_addtid_b32 v121 offset:4080
    ds_write_addtid_b32 v122 offset:9520
    ds_write_addtid_b32 v123 offset:10064
    ds_write_addtid_b32 v124 offset:10336
    ds_write_addtid_b32 v125 offset:10880
    v_cvt_pk_bf16_f32 v118, v100, -v101
    v_pk_mul_f32 v[108:109], v[76:77], v[74:75] op_sel_hi:[0,1]
    v_pk_mul_f32 v[90:91], v[82:83], v[68:69] op_sel_hi:[0,1]
    v_pk_fma_f32 v[108:109], v[76:77], v[74:75], v[108:109] op_sel:[1,1,0] op_sel_hi:[1,0,1] neg_lo:[1,0,0]
    v_pk_fma_f32 v[90:91], v[82:83], v[68:69], v[90:91] op_sel:[1,1,0] op_sel_hi:[1,0,1] neg_lo:[1,0,0]
    v_cvt_pk_bf16_f32 v119, v108, -v109
    v_cvt_pk_bf16_f32 v120, v90, -v91
    v_pk_mul_f32 v[94:95], v[80:81], v[70:71] op_sel_hi:[0,1]
    v_pk_mul_f32 v[96:97], v[84:85], v[70:71] op_sel_hi:[0,1]
    v_pk_fma_f32 v[94:95], v[80:81], v[70:71], v[94:95] op_sel:[1,1,0] op_sel_hi:[1,0,1] neg_lo:[1,0,0]
    v_pk_fma_f32 v[96:97], v[84:85], v[70:71], v[96:97] op_sel:[1,1,0] op_sel_hi:[1,0,1] neg_lo:[1,0,0]
    v_cvt_pk_bf16_f32 v121, v94, -v95
    v_cvt_pk_bf16_f32 v122, v96, -v97
    v_pk_mul_f32 v[98:99], v[88:89], v[70:71] op_sel_hi:[0,1]
    v_pk_mul_f32 v[102:103], v[84:85], v[72:73] op_sel_hi:[0,1]
    v_pk_fma_f32 v[98:99], v[88:89], v[70:71], v[98:99] op_sel:[1,1,0] op_sel_hi:[1,0,1] neg_lo:[1,0,0]
    v_pk_fma_f32 v[102:103], v[84:85], v[72:73], v[102:103] op_sel:[1,1,0] op_sel_hi:[1,0,1] neg_lo:[1,0,0]
    v_cvt_pk_bf16_f32 v123, v98, -v99
    v_cvt_pk_bf16_f32 v124, v102, -v103
    v_pk_mul_f32 v[104:105], v[92:93], v[72:73] op_sel_hi:[0,1]
    v_pk_mul_f32 v[106:107], v[96:97], v[72:73] op_sel_hi:[0,1]
    v_pk_fma_f32 v[104:105], v[92:93], v[72:73], v[104:105] op_sel:[1,1,0] op_sel_hi:[1,0,1] neg_lo:[1,0,0]
    v_pk_fma_f32 v[106:107], v[96:97], v[72:73], v[106:107] op_sel:[1,1,0] op_sel_hi:[1,0,1] neg_lo:[1,0,0]
    v_cvt_pk_bf16_f32 v125, v104, -v105
    v_mfma_f32_32x32x16_bf16 v[136:151], v[176:179], v[180:183], v[136:151]
    ds_write_addtid_b32 v118 offset:11968
    ds_write_addtid_b32 v119 offset:13056
    ds_write_addtid_b32 v120 offset:10608
    ds_write_addtid_b32 v121 offset:11152
    ds_write_addtid_b32 v122 offset:11424
    ds_write_addtid_b32 v123 offset:11696
    ds_write_addtid_b32 v124 offset:12240
    ds_write_addtid_b32 v125 offset:12512
    v_cvt_pk_bf16_f32 v118, v106, -v107
    v_pk_mul_f32 v[110:111], v[92:93], v[74:75] op_sel_hi:[0,1]
    v_pk_mul_f32 v[112:113], v[100:101], v[74:75] op_sel_hi:[0,1]
    v_pk_fma_f32 v[110:111], v[92:93], v[74:75], v[110:111] op_sel:[1,1,0] op_sel_hi:[1,0,1] neg_lo:[1,0,0]
    v_pk_fma_f32 v[112:113], v[100:101], v[74:75], v[112:113] op_sel:[1,1,0] op_sel_hi:[1,0,1] neg_lo:[1,0,0]
    v_cvt_pk_bf16_f32 v119, v110, -v111
    v_cvt_pk_bf16_f32 v120, v112, -v113
    v_pk_mul_f32 v[114:115], v[104:105], v[74:75] op_sel_hi:[0,1]
    v_pk_mul_f32 v[116:117], v[108:109], v[74:75] op_sel_hi:[0,1]
    v_pk_fma_f32 v[114:115], v[104:105], v[74:75], v[114:115] op_sel:[1,1,0] op_sel_hi:[1,0,1] neg_lo:[1,0,0]
    v_pk_fma_f32 v[116:117], v[108:109], v[74:75], v[116:117] op_sel:[1,1,0] op_sel_hi:[1,0,1] neg_lo:[1,0,0]
    v_cvt_pk_bf16_f32 v121, v114, -v115
    v_cvt_pk_bf16_f32 v122, v116, -v117
    v_pk_mul_f32 v[126:127], v[62:63], v[32:33] op_sel_hi:[0,1]
    v_pk_mul_f32 v[128:129], v[62:63], v[34:35] op_sel_hi:[0,1]
    v_pk_fma_f32 v[126:127], v[62:63], v[32:33], v[126:127] op_sel:[1,1,0] op_sel_hi:[1,0,1] neg_lo:[1,0,0]
    v_pk_fma_f32 v[128:129], v[62:63], v[34:35], v[128:129] op_sel:[1,1,0] op_sel_hi:[1,0,1] neg_lo:[1,0,0]
    v_cvt_pk_bf16_f32 v123, v126, v127
    v_cvt_pk_bf16_f32 v124, v128, v129
    v_pk_mul_f32 v[130:131], v[62:63], v[36:37] op_sel_hi:[0,1]
    v_pk_mul_f32 v[132:133], v[62:63], v[38:39] op_sel_hi:[0,1]
    v_pk_fma_f32 v[130:131], v[62:63], v[36:37], v[130:131] op_sel:[1,1,0] op_sel_hi:[1,0,1] neg_lo:[1,0,0]
    v_pk_fma_f32 v[132:133], v[62:63], v[38:39], v[132:133] op_sel:[1,1,0] op_sel_hi:[1,0,1] neg_lo:[1,0,0]
    v_cvt_pk_bf16_f32 v125, v130, v131
    v_mfma_f32_32x32x16_bf16 v[136:151], v[184:187], v[188:191], v[136:151]
    ds_write_addtid_b32 v118 offset:12784
    ds_write_addtid_b32 v119 offset:13328
    ds_write_addtid_b32 v120 offset:13600
    ds_write_addtid_b32 v121 offset:13872
    ds_write_addtid_b32 v122 offset:14144
    ds_write_addtid_b32 v123 offset:4624
    ds_write_addtid_b32 v124 offset:4896
    ds_write_addtid_b32 v125 offset:5168
    v_cvt_pk_bf16_f32 v118, v132, v133
    v_pk_mul_f32 v[126:127], v[62:63], v[40:41] op_sel_hi:[0,1]
    v_pk_mul_f32 v[128:129], v[62:63], v[42:43] op_sel_hi:[0,1]
    v_pk_fma_f32 v[126:127], v[62:63], v[40:41], v[126:127] op_sel:[1,1,0] op_sel_hi:[1,0,1] neg_lo:[1,0,0]
    v_pk_fma_f32 v[128:129], v[62:63], v[42:43], v[128:129] op_sel:[1,1,0] op_sel_hi:[1,0,1] neg_lo:[1,0,0]
    v_cvt_pk_bf16_f32 v119, v126, v127
    v_cvt_pk_bf16_f32 v120, v128, v129
    v_pk_mul_f32 v[130:131], v[62:63], v[44:45] op_sel_hi:[0,1]
    v_pk_mul_f32 v[132:133], v[62:63], v[46:47] op_sel_hi:[0,1]
    v_pk_fma_f32 v[130:131], v[62:63], v[44:45], v[130:131] op_sel:[1,1,0] op_sel_hi:[1,0,1] neg_lo:[1,0,0]
    v_pk_fma_f32 v[132:133], v[62:63], v[46:47], v[132:133] op_sel:[1,1,0] op_sel_hi:[1,0,1] neg_lo:[1,0,0]
    v_cvt_pk_bf16_f32 v121, v130, v131
    v_cvt_pk_bf16_f32 v122, v132, v133
    v_pk_mul_f32 v[126:127], v[62:63], v[48:49] op_sel_hi:[0,1]
    v_pk_mul_f32 v[128:129], v[62:63], v[50:51] op_sel_hi:[0,1]
    v_pk_fma_f32 v[126:127], v[62:63], v[48:49], v[126:127] op_sel:[1,1,0] op_sel_hi:[1,0,1] neg_lo:[1,0,0]
    v_pk_fma_f32 v[128:129], v[62:63], v[50:51], v[128:129] op_sel:[1,1,0] op_sel_hi:[1,0,1] neg_lo:[1,0,0]
    v_cvt_pk_bf16_f32 v123, v126, v127
    v_cvt_pk_bf16_f32 v124, v128, v129
    v_pk_mul_f32 v[130:131], v[62:63], v[52:53] op_sel_hi:[0,1]
    v_pk_mul_f32 v[132:133], v[62:63], v[54:55] op_sel_hi:[0,1]
    v_pk_fma_f32 v[130:131], v[62:63], v[52:53], v[130:131] op_sel:[1,1,0] op_sel_hi:[1,0,1] neg_lo:[1,0,0]
    v_pk_fma_f32 v[132:133], v[62:63], v[54:55], v[132:133] op_sel:[1,1,0] op_sel_hi:[1,0,1] neg_lo:[1,0,0]
    v_cvt_pk_bf16_f32 v125, v130, v131
    v_mfma_f32_32x32x16_bf16 v[136:151], v[192:195], v[196:199], v[136:151]
    ds_write_addtid_b32 v118 offset:5440
    ds_write_addtid_b32 v119 offset:5712
    ds_write_addtid_b32 v120 offset:5984
    ds_write_addtid_b32 v121 offset:6256
    ds_write_addtid_b32 v122 offset:6528
    ds_write_addtid_b32 v123 offset:6800
    ds_write_addtid_b32 v124 offset:7072
    ds_write_addtid_b32 v125 offset:7344
    v_cvt_pk_bf16_f32 v118, v132, v133
    v_pk_mul_f32 v[126:127], v[62:63], v[56:57] op_sel_hi:[0,1]
    v_pk_mul_f32 v[128:129], v[62:63], v[58:59] op_sel_hi:[0,1]
    v_pk_fma_f32 v[126:127], v[62:63], v[56:57], v[126:127] op_sel:[1,1,0] op_sel_hi:[1,0,1] neg_lo:[1,0,0]
    v_pk_fma_f32 v[128:129], v[62:63], v[58:59], v[128:129] op_sel:[1,1,0] op_sel_hi:[1,0,1] neg_lo:[1,0,0]
    v_cvt_pk_bf16_f32 v119, v126, v127
    v_cvt_pk_bf16_f32 v120, v128, v129
    v_pk_mul_f32 v[130:131], v[62:63], v[60:61] op_sel_hi:[0,1]
    v_pk_fma_f32 v[130:131], v[62:63], v[60:61], v[130:131] op_sel:[1,1,0] op_sel_hi:[1,0,1] neg_lo:[1,0,0]
    v_cvt_pk_bf16_f32 v121, v130, v131
    v_mfma_f32_32x32x16_bf16 v[136:151], v[200:203], v[204:207], v[136:151]
    ds_write_addtid_b32 v118 offset:7616
    ds_write_addtid_b32 v119 offset:7888
    ds_write_addtid_b32 v120 offset:8160
    ds_write_addtid_b32 v121 offset:8432
    v_mfma_f32_32x32x16_bf16 v[136:151], v[208:211], v[212:215], v[136:151]
    s_waitcnt lgkmcnt(0)
    s_nop 0
    ds_read_b128 v[152:155], v5 offset:8704
    ds_read_b128 v[156:159], v5 offset:0
    ds_read_b128 v[160:163], v5 offset:8736
    ds_read_b128 v[164:167], v5 offset:32
    ds_read_b128 v[168:171], v5 offset:8768
    ds_read_b128 v[172:175], v5 offset:64
    ds_read_b128 v[176:179], v5 offset:8800
    ds_read_b128 v[180:183], v5 offset:96
    ds_read_b128 v[184:187], v5 offset:8832
    ds_read_b128 v[188:191], v5 offset:128
    ds_read_b128 v[192:195], v5 offset:8864
    ds_read_b128 v[196:199], v5 offset:160
    ds_read_b128 v[200:203], v5 offset:8896
    ds_read_b128 v[204:207], v5 offset:192
    ds_read_b128 v[208:211], v5 offset:8928
    ds_read_b128 v[212:215], v5 offset:224
    s_waitcnt lgkmcnt(14)
    v_mfma_f32_32x32x16_bf16 v[136:151], v[152:155], v[156:159], v[136:151]
    s_waitcnt lgkmcnt(12)
    v_mfma_f32_32x32x16_bf16 v[136:151], v[160:163], v[164:167], v[136:151]
    s_waitcnt lgkmcnt(10)
    v_mfma_f32_32x32x16_bf16 v[136:151], v[168:171], v[172:175], v[136:151]
    s_waitcnt lgkmcnt(8)
    v_mfma_f32_32x32x16_bf16 v[136:151], v[176:179], v[180:183], v[136:151]
    s_waitcnt lgkmcnt(6)
    v_mfma_f32_32x32x16_bf16 v[136:151], v[184:187], v[188:191], v[136:151]
    s_waitcnt lgkmcnt(4)
    v_mfma_f32_32x32x16_bf16 v[136:151], v[192:195], v[196:199], v[136:151]
    s_waitcnt lgkmcnt(2)
    v_mfma_f32_32x32x16_bf16 v[136:151], v[200:203], v[204:207], v[136:151]
    s_waitcnt lgkmcnt(0)
    v_mfma_f32_32x32x16_bf16 v[136:151], v[208:211], v[212:215], v[136:151]
    s_nop 11
    s_nop 0
    v_cvt_pk_bf16_f32 v136, v136, v136
    v_cvt_pk_bf16_f32 v137, v137, v137
    v_cvt_pk_bf16_f32 v138, v138, v138
    v_cvt_pk_bf16_f32 v139, v139, v139
    v_cvt_pk_bf16_f32 v140, v140, v140
    v_cvt_pk_bf16_f32 v141, v141, v141
    v_cvt_pk_bf16_f32 v142, v142, v142
    v_cvt_pk_bf16_f32 v143, v143, v143
    v_cvt_pk_bf16_f32 v144, v144, v144
    v_cvt_pk_bf16_f32 v145, v145, v145
    v_cvt_pk_bf16_f32 v146, v146, v146
    v_cvt_pk_bf16_f32 v147, v147, v147
    ds_write_b128 v216, v[136:139]
    s_mov_b32 exec_hi, 0
    ds_write_b128 v217, v[140:143] offset:1024
    ds_write_b32 v219, v144 offset:2048
    ds_write_b32 v219, v145 offset:2176
    ds_write_b32 v219, v146 offset:2304
    ds_write_b32 v219, v147 offset:2432
    s_not_b64 exec, exec
    ds_write_b64 v218, v[140:141] offset:1536
    ds_write_b64 v218, v[142:143] offset:1792
    ds_write_b32 v219, v144 offset:2560
    s_mov_b64 exec, -1
    v_mov_b32_e64 v20, 0
    s_waitcnt lgkmcnt(0)
    ds_write_b32 v233, v20
    ds_read2_b32 v[32:33], v220 offset0:0 offset1:1
    ds_read_b32 v34, v220 offset:8
    ds_read2_b32 v[36:37], v220 offset0:128 offset1:129
    ds_read_b32 v38, v220 offset:520
    ds_read_b32 v40, v221
    ds_read_b32 v41, v222
    ds_read_b32 v42, v223
    ds_read_b32 v44, v224
    ds_read_b32 v45, v225
    ds_read_b32 v46, v226
    ds_read2_b32 v[48:49], v227 offset0:0 offset1:1
    ds_read2_b32 v[50:51], v227 offset0:32 offset1:33
    ds_read2_b32 v[52:53], v227 offset0:64 offset1:65
    ds_read2_b32 v[54:55], v227 offset0:96 offset1:97
    ds_read2_b32 v[56:57], v230 offset0:0 offset1:1
    ds_read2_b32 v[58:59], v230 offset0:16 offset1:17
    ds_read2_b32 v[60:61], v230 offset0:32 offset1:33
    ds_read2_b32 v[62:63], v230 offset0:48 offset1:49
    ds_read2_b32 v[64:65], v230 offset0:64 offset1:65
    ds_read2_b32 v[66:67], v230 offset0:80 offset1:81
    ds_read2_b32 v[68:69], v230 offset0:96 offset1:97
    ds_read2_b32 v[70:71], v230 offset0:112 offset1:113
    s_mov_b32 s60, 0x05040100
    s_waitcnt lgkmcnt(8)
    s_nop 0
    v_perm_b32 v80, v33, v34, s60
    v_perm_b32 v81, v32, v33, s60
    v_perm_b32 v82, v37, v38, s60
    v_perm_b32 v83, v36, v37, s60
    v_perm_b32 v84, v41, v42, s60
    v_perm_b32 v85, v40, v41, s60
    v_perm_b32 v86, v45, v46, s60
    v_perm_b32 v87, v44, v45, s60
    v_perm_b32 v88, v49, v48, v228
    v_perm_b32 v89, v49, v48, v229
    v_perm_b32 v90, v51, v50, v228
    v_perm_b32 v91, v51, v50, v229
    v_perm_b32 v92, v53, v52, v228
    v_perm_b32 v93, v53, v52, v229
    v_perm_b32 v94, v55, v54, v228
    v_perm_b32 v95, v55, v54, v229
    s_waitcnt lgkmcnt(0)
    s_nop 0
    v_perm_b32 v96, v57, v56, v231
    v_perm_b32 v97, v57, v56, v232
    v_perm_b32 v98, v59, v58, v231
    v_perm_b32 v99, v59, v58, v232
    v_perm_b32 v100, v61, v60, v231
    v_perm_b32 v101, v61, v60, v232
    v_perm_b32 v102, v63, v62, v231
    v_perm_b32 v103, v63, v62, v232
    v_perm_b32 v104, v65, v64, v231
    v_perm_b32 v105, v65, v64, v232
    v_perm_b32 v106, v67, v66, v231
    v_perm_b32 v107, v67, v66, v232
    v_perm_b32 v108, v69, v68, v231
    v_perm_b32 v109, v69, v68, v232
    v_perm_b32 v110, v71, v70, v231
    v_perm_b32 v111, v71, v70, v232
    s_add_u32 m0, s59, 0
    s_nop 0
    ds_write_addtid_b32 v81 offset:3844
    ds_write_addtid_b32 v80 offset:12100
    ds_write_addtid_b32 v81 offset:7980
    ds_write_addtid_b32 v80 offset:16236
    ds_write_addtid_b32 v83 offset:3588
    ds_write_addtid_b32 v82 offset:11844
    ds_write_addtid_b32 v83 offset:7724
    ds_write_addtid_b32 v82 offset:15980
    ds_write_addtid_b32 v85 offset:3332
    ds_write_addtid_b32 v84 offset:11588
    ds_write_addtid_b32 v85 offset:7468
    ds_write_addtid_b32 v84 offset:15724
    ds_write_addtid_b32 v87 offset:3076
    ds_write_addtid_b32 v86 offset:11332
    ds_write_addtid_b32 v87 offset:7212
    ds_write_addtid_b32 v86 offset:15468
    ds_write_addtid_b32 v89 offset:2820
    ds_write_addtid_b32 v88 offset:11076
    ds_write_addtid_b32 v89 offset:6956
    ds_write_addtid_b32 v88 offset:15212
    ds_write_addtid_b32 v91 offset:2564
    ds_write_addtid_b32 v90 offset:10820
    ds_write_addtid_b32 v91 offset:6700
    ds_write_addtid_b32 v90 offset:14956
    ds_write_addtid_b32 v93 offset:2308
    ds_write_addtid_b32 v92 offset:10564
    ds_write_addtid_b32 v93 offset:6444
    ds_write_addtid_b32 v92 offset:14700
    ds_write_addtid_b32 v95 offset:2052
    ds_write_addtid_b32 v94 offset:10308
    ds_write_addtid_b32 v95 offset:6188
    ds_write_addtid_b32 v94 offset:14444
    s_add_u32 m0, s59, 17024
    s_nop 0
    s_nop 0
    ds_write_addtid_b32 v81 offset:36616
    ds_write_addtid_b32 v80 offset:44872
    ds_write_addtid_b32 v81 offset:40752
    ds_write_addtid_b32 v80 offset:49008
    ds_write_addtid_b32 v83 offset:36360
    ds_write_addtid_b32 v82 offset:44616
    ds_write_addtid_b32 v83 offset:40496
    ds_write_addtid_b32 v82 offset:48752
    ds_write_addtid_b32 v85 offset:36104
    ds_write_addtid_b32 v84 offset:44360
    ds_write_addtid_b32 v85 offset:40240
    ds_write_addtid_b32 v84 offset:48496
    ds_write_addtid_b32 v87 offset:35848
    ds_write_addtid_b32 v86 offset:44104
    ds_write_addtid_b32 v87 offset:39984
    ds_write_addtid_b32 v86 offset:48240
    ds_write_addtid_b32 v89 offset:35592
    ds_write_addtid_b32 v88 offset:43848
    ds_write_addtid_b32 v89 offset:39728
    ds_write_addtid_b32 v88 offset:47984
    ds_write_addtid_b32 v91 offset:35336
    ds_write_addtid_b32 v90 offset:43592
    ds_write_addtid_b32 v91 offset:39472
    ds_write_addtid_b32 v90 offset:47728
    ds_write_addtid_b32 v93 offset:35080
    ds_write_addtid_b32 v92 offset:43336
    ds_write_addtid_b32 v93 offset:39216
    ds_write_addtid_b32 v92 offset:47472
    ds_write_addtid_b32 v95 offset:34824
    ds_write_addtid_b32 v94 offset:43080
    ds_write_addtid_b32 v95 offset:38960
    ds_write_addtid_b32 v94 offset:47216
    s_add_u32 m0, s59, 0
    s_nop 0
    ds_write_addtid_b32 v97 offset:1796
    ds_write_addtid_b32 v96 offset:10052
    ds_write_addtid_b32 v97 offset:5932
    ds_write_addtid_b32 v96 offset:14188
    ds_write_addtid_b32 v99 offset:1540
    ds_write_addtid_b32 v98 offset:9796
    ds_write_addtid_b32 v99 offset:5676
    ds_write_addtid_b32 v98 offset:13932
    ds_write_addtid_b32 v101 offset:1284
    ds_write_addtid_b32 v100 offset:9540
    ds_write_addtid_b32 v101 offset:5420
    ds_write_addtid_b32 v100 offset:13676
    ds_write_addtid_b32 v103 offset:1028
    ds_write_addtid_b32 v102 offset:9284
    ds_write_addtid_b32 v103 offset:5164
    ds_write_addtid_b32 v102 offset:13420
    ds_write_addtid_b32 v105 offset:772
    ds_write_addtid_b32 v104 offset:9028
    ds_write_addtid_b32 v105 offset:4908
    ds_write_addtid_b32 v104 offset:13164
    ds_write_addtid_b32 v107 offset:516
    ds_write_addtid_b32 v106 offset:8772
    ds_write_addtid_b32 v107 offset:4652
    ds_write_addtid_b32 v106 offset:12908
    ds_write_addtid_b32 v109 offset:260
    ds_write_addtid_b32 v108 offset:8516
    ds_write_addtid_b32 v109 offset:4396
    ds_write_addtid_b32 v108 offset:12652
    ds_write_addtid_b32 v111 offset:4
    ds_write_addtid_b32 v110 offset:8260
    ds_write_addtid_b32 v111 offset:4140
    ds_write_addtid_b32 v110 offset:12396
    s_add_u32 m0, s59, 17024
    s_nop 0
    s_nop 0
    ds_write_addtid_b32 v97 offset:34568
    ds_write_addtid_b32 v96 offset:42824
    ds_write_addtid_b32 v97 offset:38704
    ds_write_addtid_b32 v96 offset:46960
    ds_write_addtid_b32 v99 offset:34312
    ds_write_addtid_b32 v98 offset:42568
    ds_write_addtid_b32 v99 offset:38448
    ds_write_addtid_b32 v98 offset:46704
    ds_write_addtid_b32 v101 offset:34056
    ds_write_addtid_b32 v100 offset:42312
    ds_write_addtid_b32 v101 offset:38192
    ds_write_addtid_b32 v100 offset:46448
    ds_write_addtid_b32 v103 offset:33800
    ds_write_addtid_b32 v102 offset:42056
    ds_write_addtid_b32 v103 offset:37936
    ds_write_addtid_b32 v102 offset:46192
    ds_write_addtid_b32 v105 offset:33544
    ds_write_addtid_b32 v104 offset:41800
    ds_write_addtid_b32 v105 offset:37680
    ds_write_addtid_b32 v104 offset:45936
    ds_write_addtid_b32 v107 offset:33288
    ds_write_addtid_b32 v106 offset:41544
    ds_write_addtid_b32 v107 offset:37424
    ds_write_addtid_b32 v106 offset:45680
    ds_write_addtid_b32 v109 offset:33032
    ds_write_addtid_b32 v108 offset:41288
    ds_write_addtid_b32 v109 offset:37168
    ds_write_addtid_b32 v108 offset:45424
    ds_write_addtid_b32 v111 offset:32776
    ds_write_addtid_b32 v110 offset:41032
    ds_write_addtid_b32 v111 offset:36912
    ds_write_addtid_b32 v110 offset:45168
    v_mov_b32 v28, 126080
    v_xor_b32 v29, 16, v243
    v_xor_b32 v30, 32, v243
    v_xor_b32_e64 v31, 48, v243
    s_waitcnt lgkmcnt(0)
    s_barrier
    ds_read_b128 v[32:35], v242 offset:12288
    global_load_dwordx4 a[0:3], v2, s[64:65] offset:-4096 sc1
    ds_read_b128 v[44:47], v243
    ds_read_b128 v[52:55], v30
    ds_read_b128 v[60:63], v28
    ds_read_b128 v[64:67], v28 offset:32
    ds_read_b128 v[48:51], v29
    ds_read_b128 v[56:59], v31
    ds_read_b128 v[36:39], v242 offset:12304
    ds_read_b128 v[40:43], v242 offset:12320
    s_waitcnt lgkmcnt(4)
    v_lshlrev_b32 v68, 16, v32
    v_and_b32 v69, 0xffff0000, v32
    v_pk_fma_f32 v[68:69], v[68:69], v[44:45], v[52:53]
    v_pk_fma_f32 v[68:69], v[68:69], v[64:65], v[60:61] op_sel:[0,0,0] op_sel_hi:[1,0,0]
    v_cvt_pk_bf16_f32 v32, v68, v69
    v_lshlrev_b32 v70, 16, v33
    v_and_b32 v71, 0xffff0000, v33
    global_load_dwordx4 a[4:7], v2, s[64:65] offset:-3072 sc1
    v_pk_fma_f32 v[70:71], v[70:71], v[46:47], v[54:55]
    v_pk_fma_f32 v[70:71], v[70:71], v[64:65], v[60:61] op_sel:[0,0,0] op_sel_hi:[1,0,0]
    v_cvt_pk_bf16_f32 v33, v70, v71
    s_waitcnt lgkmcnt(2)
    v_lshlrev_b32 v68, 16, v34
    v_and_b32 v69, 0xffff0000, v34
    v_pk_fma_f32 v[68:69], v[68:69], v[48:49], v[56:57]
    v_pk_fma_f32 v[68:69], v[68:69], v[64:65], v[60:61] op_sel:[0,0,0] op_sel_hi:[1,0,0]
    v_cvt_pk_bf16_f32 v34, v68, v69
    v_lshlrev_b32 v70, 16, v35
    v_and_b32 v71, 0xffff0000, v35
    v_pk_fma_f32 v[70:71], v[70:71], v[50:51], v[58:59]
    v_pk_fma_f32 v[70:71], v[70:71], v[64:65], v[60:61] op_sel:[0,0,0] op_sel_hi:[1,0,0]
    v_cvt_pk_bf16_f32 v35, v70, v71
    s_waitcnt lgkmcnt(1)
    v_lshlrev_b32 v68, 16, v36
    global_load_dwordx4 a[8:11], v2, s[64:65] offset:-2048 sc1
    v_and_b32 v69, 0xffff0000, v36
    v_pk_fma_f32 v[68:69], v[68:69], v[44:45], v[52:53]
    v_pk_fma_f32 v[68:69], v[68:69], v[64:65], v[60:61] op_sel:[0,1,1] op_sel_hi:[1,1,1]
    v_cvt_pk_bf16_f32 v36, v68, v69
    v_lshlrev_b32 v70, 16, v37
    v_and_b32 v71, 0xffff0000, v37
    v_pk_fma_f32 v[70:71], v[70:71], v[46:47], v[54:55]
    v_pk_fma_f32 v[70:71], v[70:71], v[64:65], v[60:61] op_sel:[0,1,1] op_sel_hi:[1,1,1]
    v_cvt_pk_bf16_f32 v37, v70, v71
    v_lshlrev_b32 v68, 16, v38
    v_and_b32 v69, 0xffff0000, v38
    v_pk_fma_f32 v[68:69], v[68:69], v[48:49], v[56:57]
    v_pk_fma_f32 v[68:69], v[68:69], v[64:65], v[60:61] op_sel:[0,1,1] op_sel_hi:[1,1,1]
    v_cvt_pk_bf16_f32 v38, v68, v69
    v_lshlrev_b32 v70, 16, v39
    v_and_b32 v71, 0xffff0000, v39
    v_pk_fma_f32 v[70:71], v[70:71], v[50:51], v[58:59]
    global_load_dwordx4 a[12:15], v2, s[64:65] offset:-1024 sc1
    v_pk_fma_f32 v[70:71], v[70:71], v[64:65], v[60:61] op_sel:[0,1,1] op_sel_hi:[1,1,1]
    v_cvt_pk_bf16_f32 v39, v70, v71
    s_waitcnt lgkmcnt(0)
    v_lshlrev_b32 v68, 16, v40
    v_and_b32 v69, 0xffff0000, v40
    v_pk_fma_f32 v[68:69], v[68:69], v[44:45], v[52:53]
    v_pk_fma_f32 v[68:69], v[68:69], v[66:67], v[62:63] op_sel:[0,0,0] op_sel_hi:[1,0,0]
    v_cvt_pk_bf16_f32 v40, v68, v69
    v_lshlrev_b32 v70, 16, v41
    v_and_b32 v71, 0xffff0000, v41
    v_pk_fma_f32 v[70:71], v[70:71], v[46:47], v[54:55]
    v_pk_fma_f32 v[70:71], v[70:71], v[66:67], v[62:63] op_sel:[0,0,0] op_sel_hi:[1,0,0]
    v_cvt_pk_bf16_f32 v41, v70, v71
    v_lshlrev_b32 v68, 16, v42
    v_and_b32 v69, 0xffff0000, v42
    v_pk_fma_f32 v[68:69], v[68:69], v[48:49], v[56:57]
    global_load_dwordx4 a[16:19], v2, s[64:65] offset:0 sc1
    v_pk_fma_f32 v[68:69], v[68:69], v[66:67], v[62:63] op_sel:[0,0,0] op_sel_hi:[1,0,0]
    v_cvt_pk_bf16_f32 v42, v68, v69
    v_lshlrev_b32 v70, 16, v43
    v_and_b32 v71, 0xffff0000, v43
    v_pk_fma_f32 v[70:71], v[70:71], v[50:51], v[58:59]
    v_pk_fma_f32 v[70:71], v[70:71], v[66:67], v[62:63] op_sel:[0,0,0] op_sel_hi:[1,0,0]
    v_cvt_pk_bf16_f32 v43, v70, v71
    ds_write_b128 v242, v[32:35] offset:0
    ds_write_b128 v242, v[36:39] offset:16
    global_load_dwordx4 a[20:23], v2, s[64:65] offset:1024 sc1
    ds_write_b128 v242, v[40:43] offset:32
    s_waitcnt lgkmcnt(0)
    s_barrier
    ds_read_b128 v[32:35], v234 offset:4032
    ds_read_b128 v[36:39], v237 offset:5952
    ds_read_b128 v[40:43], v237 offset:4416
    ds_read_b128 v[44:47], v237 offset:2880
    ds_read_b128 v[48:51], v234 offset:3520
    ds_read_b128 v[52:55], v237 offset:1344
    ds_read_b128 v[56:59], v234 offset:3008
    ds_read_b128 v[60:63], v234 offset:2496
    ds_read_b128 v[64:67], v234 offset:3968
    ds_read_b128 v[68:71], v237 offset:5760
    ds_read_b128 v[72:75], v237 offset:4224
    ds_read_b128 v[76:79], v237 offset:2688
    s_waitcnt lgkmcnt(8)
    v_mfma_f32_16x16x32_bf16 v[24:27], v[32:35], v[36:39], 0
    ds_read_b128 v[80:83], v234 offset:3456
    v_mfma_f32_16x16x32_bf16 v[20:23], v[32:35], v[40:43], 0
    ds_read_b128 v[84:87], v237 offset:1152
    v_mfma_f32_16x16x32_bf16 v[16:19], v[32:35], v[44:47], 0
    ds_read_b128 v[88:91], v234 offset:2944
    s_waitcnt lgkmcnt(8)
    v_mfma_f32_16x16x32_bf16 v[24:27], v[48:51], v[40:43], v[24:27]
    ds_read_b128 v[92:95], v234 offset:2432
    v_mfma_f32_16x16x32_bf16 v[20:23], v[48:51], v[44:47], v[20:23]
    ds_read_b128 v[96:99], v234 offset:3904
    v_mfma_f32_16x16x32_bf16 v[16:19], v[48:51], v[52:55], v[16:19]
    ds_read_b128 v[100:103], v237 offset:5568
    v_mfma_f32_16x16x32_bf16 v[24:27], v[56:59], v[44:47], v[24:27]
    global_load_dwordx4 a[24:27], v2, s[64:65] offset:2048 sc1
    v_mfma_f32_16x16x32_bf16 v[20:23], v[56:59], v[52:55], v[20:23]
    ds_read_b128 v[104:107], v237 offset:4032
    s_waitcnt lgkmcnt(9)
    v_mfma_f32_16x16x32_bf16 v[24:27], v[60:63], v[52:55], v[24:27]
    ds_read_b128 v[108:111], v237 offset:2496
    v_mfma_f32_16x16x32_bf16 v[24:27], v[64:67], v[68:71], v[24:27]
    ds_read_b128 v[36:39], v234 offset:3392
    s_waitcnt lgkmcnt(8)
    v_mfma_f32_16x16x32_bf16 v[20:23], v[64:67], v[72:75], v[20:23]
    ds_read_b128 v[32:35], v237 offset:960
    v_mfma_f32_16x16x32_bf16 v[16:19], v[64:67], v[76:79], v[16:19]
    ds_read_b128 v[40:43], v234 offset:2880
    v_mfma_f32_16x16x32_bf16 v[24:27], v[80:83], v[72:75], v[24:27]
    ds_read_b128 v[48:51], v234 offset:2368
    v_mfma_f32_16x16x32_bf16 v[20:23], v[80:83], v[76:79], v[20:23]
    ds_read_b128 v[44:47], v234 offset:3840
    s_waitcnt lgkmcnt(9)
    v_mfma_f32_16x16x32_bf16 v[16:19], v[80:83], v[84:87], v[16:19]
    ds_read_b128 v[56:59], v237 offset:5376
    v_mfma_f32_16x16x32_bf16 v[24:27], v[88:91], v[76:79], v[24:27]
    global_load_dwordx4 a[28:31], v2, s[64:65] offset:3072 sc1
    v_mfma_f32_16x16x32_bf16 v[20:23], v[88:91], v[84:87], v[20:23]
    ds_read_b128 v[60:63], v237 offset:3840
    v_mfma_f32_16x16x32_bf16 v[24:27], v[92:95], v[84:87], v[24:27]
    ds_read_b128 v[52:55], v237 offset:2304
    s_waitcnt lgkmcnt(8)
    v_mfma_f32_16x16x32_bf16 v[24:27], v[96:99], v[100:103], v[24:27]
    ds_read_b128 v[68:71], v234 offset:3328
    v_mfma_f32_16x16x32_bf16 v[20:23], v[96:99], v[104:107], v[20:23]
    ds_read_b128 v[64:67], v237 offset:768
    v_mfma_f32_16x16x32_bf16 v[16:19], v[96:99], v[108:111], v[16:19]
    ds_read_b128 v[72:75], v234 offset:2816
    s_waitcnt lgkmcnt(8)
    v_mfma_f32_16x16x32_bf16 v[24:27], v[36:39], v[104:107], v[24:27]
    ds_read_b128 v[80:83], v234 offset:2304
    v_mfma_f32_16x16x32_bf16 v[20:23], v[36:39], v[108:111], v[20:23]
    ds_read_b128 v[76:79], v234 offset:3776
    v_mfma_f32_16x16x32_bf16 v[16:19], v[36:39], v[32:35], v[16:19]
    ds_read_b128 v[88:91], v237 offset:5184
    v_mfma_f32_16x16x32_bf16 v[24:27], v[40:43], v[108:111], v[24:27]
    s_add_u32 s64, s64, 8192
    s_addc_u32 s65, s65, 0
    v_mfma_f32_16x16x32_bf16 v[20:23], v[40:43], v[32:35], v[20:23]
    ds_read_b128 v[92:95], v237 offset:3648
    s_waitcnt lgkmcnt(9)
    v_mfma_f32_16x16x32_bf16 v[24:27], v[48:51], v[32:35], v[24:27]
    ds_read_b128 v[84:87], v237 offset:2112
    v_mfma_f32_16x16x32_bf16 v[24:27], v[44:47], v[56:59], v[24:27]
    ds_read_b128 v[100:103], v234 offset:3264
    s_waitcnt lgkmcnt(8)
    v_mfma_f32_16x16x32_bf16 v[20:23], v[44:47], v[60:63], v[20:23]
    ds_read_b128 v[96:99], v237 offset:576
    v_mfma_f32_16x16x32_bf16 v[16:19], v[44:47], v[52:55], v[16:19]
    ds_read_b128 v[104:107], v234 offset:2752
    v_mfma_f32_16x16x32_bf16 v[24:27], v[68:71], v[60:63], v[24:27]
    ds_read_b128 v[36:39], v234 offset:2240
    v_mfma_f32_16x16x32_bf16 v[20:23], v[68:71], v[52:55], v[20:23]
    ds_read_b128 v[108:111], v234 offset:3712
    s_waitcnt lgkmcnt(9)
    v_mfma_f32_16x16x32_bf16 v[16:19], v[68:71], v[64:67], v[16:19]
    ds_read_b128 v[40:43], v237 offset:4992
    v_mfma_f32_16x16x32_bf16 v[24:27], v[72:75], v[52:55], v[24:27]
    global_load_dwordx4 a[32:35], v2, s[64:65] offset:-4096 sc1
    v_mfma_f32_16x16x32_bf16 v[20:23], v[72:75], v[64:67], v[20:23]
    ds_read_b128 v[48:51], v237 offset:3456
    v_mfma_f32_16x16x32_bf16 v[24:27], v[80:83], v[64:67], v[24:27]
    ds_read_b128 v[32:35], v237 offset:1920
    s_waitcnt lgkmcnt(8)
    v_mfma_f32_16x16x32_bf16 v[24:27], v[76:79], v[88:91], v[24:27]
    ds_read_b128 v[56:59], v234 offset:3200
    v_mfma_f32_16x16x32_bf16 v[20:23], v[76:79], v[92:95], v[20:23]
    ds_read_b128 v[44:47], v237 offset:384
    v_mfma_f32_16x16x32_bf16 v[16:19], v[76:79], v[84:87], v[16:19]
    ds_read_b128 v[60:63], v234 offset:2688
    s_waitcnt lgkmcnt(8)
    v_mfma_f32_16x16x32_bf16 v[24:27], v[100:103], v[92:95], v[24:27]
    ds_read_b128 v[68:71], v234 offset:2176
    v_mfma_f32_16x16x32_bf16 v[20:23], v[100:103], v[84:87], v[20:23]
    ds_read_b128 v[52:55], v234 offset:3648
    v_mfma_f32_16x16x32_bf16 v[16:19], v[100:103], v[96:99], v[16:19]
    ds_read_b128 v[72:75], v237 offset:4800
    v_mfma_f32_16x16x32_bf16 v[24:27], v[104:107], v[84:87], v[24:27]
    global_load_dwordx4 a[36:39], v2, s[64:65] offset:-3072 sc1
    v_mfma_f32_16x16x32_bf16 v[20:23], v[104:107], v[96:99], v[20:23]
    ds_read_b128 v[80:83], v237 offset:3264
    s_waitcnt lgkmcnt(9)
    v_mfma_f32_16x16x32_bf16 v[24:27], v[36:39], v[96:99], v[24:27]
    ds_read_b128 v[64:67], v237 offset:1728
    v_mfma_f32_16x16x32_bf16 v[24:27], v[108:111], v[40:43], v[24:27]
    ds_read_b128 v[88:91], v234 offset:3136
    s_waitcnt lgkmcnt(8)
    v_mfma_f32_16x16x32_bf16 v[20:23], v[108:111], v[48:51], v[20:23]
    ds_read_b128 v[76:79], v237 offset:192
    v_mfma_f32_16x16x32_bf16 v[16:19], v[108:111], v[32:35], v[16:19]
    ds_read_b128 v[92:95], v234 offset:2624
    v_mfma_f32_16x16x32_bf16 v[24:27], v[56:59], v[48:51], v[24:27]
    ds_read_b128 v[100:103], v234 offset:2112
    v_mfma_f32_16x16x32_bf16 v[20:23], v[56:59], v[32:35], v[20:23]
    ds_read_b128 v[84:87], v234 offset:3584
    s_barrier
    s_waitcnt lgkmcnt(9)
    v_mfma_f32_16x16x32_bf16 v[16:19], v[56:59], v[44:47], v[16:19]
    ds_read_b128 v[104:107], v237 offset:4608
    v_mfma_f32_16x16x32_bf16 v[24:27], v[60:63], v[32:35], v[24:27]
    global_load_dwordx4 a[40:43], v2, s[64:65] offset:-2048 sc1
    v_mfma_f32_16x16x32_bf16 v[20:23], v[60:63], v[44:47], v[20:23]
    ds_read_b128 v[36:39], v237 offset:3072
    v_mfma_f32_16x16x32_bf16 v[24:27], v[68:71], v[44:47], v[24:27]
    ds_read_b128 v[96:99], v237 offset:1536
    s_waitcnt lgkmcnt(8)
    v_mfma_f32_16x16x32_bf16 v[24:27], v[52:55], v[72:75], v[24:27]
    ds_read_b128 v[40:43], v234 offset:3072
    v_mfma_f32_16x16x32_bf16 v[20:23], v[52:55], v[80:83], v[20:23]
    ds_read_b128 v[108:111], v237 offset:0
    v_mfma_f32_16x16x32_bf16 v[16:19], v[52:55], v[64:67], v[16:19]
    ds_read_b128 v[48:51], v234 offset:2560
    s_waitcnt lgkmcnt(8)
    v_mfma_f32_16x16x32_bf16 v[24:27], v[88:91], v[80:83], v[24:27]
    ds_read_b128 v[56:59], v234 offset:2048
    v_mfma_f32_16x16x32_bf16 v[20:23], v[88:91], v[64:67], v[20:23]
    global_load_dwordx4 a[44:47], v2, s[64:65] offset:-1024 sc1
    v_mfma_f32_16x16x32_bf16 v[16:19], v[88:91], v[76:79], v[16:19]
    global_load_dwordx4 a[48:51], v2, s[64:65] offset:0 sc1
    v_mfma_f32_16x16x32_bf16 v[24:27], v[92:95], v[64:67], v[24:27]
    global_load_dwordx4 a[52:55], v2, s[64:65] offset:1024 sc1
    v_mfma_f32_16x16x32_bf16 v[20:23], v[92:95], v[76:79], v[20:23]
    global_load_dwordx4 a[56:59], v2, s[64:65] offset:2048 sc1
    s_waitcnt lgkmcnt(6)
    v_mfma_f32_16x16x32_bf16 v[24:27], v[100:103], v[76:79], v[24:27]
    global_load_dwordx4 a[60:63], v2, s[64:65] offset:3072 sc1
    ds_read2_b32 v[112:113], v251 offset0:16 offset1:32
    ds_read_b32 v114, v251 offset:96
    ds_read_b64 v[140:141], v238 offset:1536
    ds_read_b64 v[142:143], v238 offset:13824
    ds_read_b64 v[144:145], v238 offset:3072
    ds_read_b64 v[146:147], v238 offset:15360
    ds_read_b64 v[148:149], v238 offset:4608
    ds_read_b64 v[150:151], v238 offset:16896
    v_mfma_f32_16x16x32_bf16 v[24:27], v[84:87], v[104:107], v[24:27]
    s_waitcnt lgkmcnt(11)
    v_mfma_f32_16x16x32_bf16 v[20:23], v[84:87], v[36:39], v[20:23]
    s_add_u32 s64, s64, 8192
    s_addc_u32 s65, s65, 0
    v_mfma_f32_16x16x32_bf16 v[16:19], v[84:87], v[96:99], v[16:19]
    global_load_dwordx4 a[64:67], v2, s[64:65] offset:-4096 sc1
    v_mfma_f32_16x16x32_bf16 v[24:27], v[40:43], v[36:39], v[24:27]
    v_mfma_f32_16x16x32_bf16 v[20:23], v[40:43], v[96:99], v[20:23]
    s_waitcnt lgkmcnt(8)
    v_mfma_f32_16x16x32_bf16 v[16:19], v[40:43], v[108:111], v[16:19]
    global_load_dwordx4 a[68:71], v2, s[64:65] offset:-3072 sc1
    v_mfma_f32_16x16x32_bf16 v[24:27], v[48:51], v[96:99], v[24:27]
    v_mfma_f32_16x16x32_bf16 v[20:23], v[48:51], v[108:111], v[20:23]
    v_mfma_f32_16x16x32_bf16 v[24:27], v[56:59], v[108:111], v[24:27]
    s_waitcnt lgkmcnt(4)
    v_lshlrev_b32 v48, 16, v140
    v_and_b32 v49, 0xffff0000, v140
    v_lshlrev_b32 v50, 16, v142
    v_and_b32 v51, 0xffff0000, v142
    v_lshlrev_b32 v52, 16, v141
    v_and_b32 v53, 0xffff0000, v141
    v_lshlrev_b32 v54, 16, v143
    v_and_b32 v55, 0xffff0000, v143
    v_pk_fma_f32 v[48:49], v[48:49], v[112:113], v[50:51] op_sel:[0,1,0] op_sel_hi:[1,1,1]
    global_load_dwordx4 a[72:75], v2, s[64:65] offset:-2048 sc1
    v_pk_fma_f32 v[52:53], v[52:53], v[112:113], v[54:55] op_sel:[0,1,0] op_sel_hi:[1,1,1]
    v_pk_fma_f32 v[48:49], v[16:17], v[112:113], v[48:49] op_sel_hi:[1,0,1]
    v_pk_fma_f32 v[52:53], v[18:19], v[112:113], v[52:53] op_sel_hi:[1,0,1]
    v_pk_mul_f32 v[50:51], v[48:49], v[114:115] op_sel_hi:[1,0]
    v_pk_mul_f32 v[54:55], v[52:53], v[114:115] op_sel_hi:[1,0]
    v_cvt_pk_bf16_f32 v56, v48, v49
    v_cvt_pk_bf16_f32 v57, v52, v53
    v_cvt_pk_bf16_f32 v58, v50, v51
    v_cvt_pk_bf16_f32 v59, v54, v55
    s_add_u32 s6, s48, 327680
    s_addc_u32 s7, s49, 0
    v_permlane16_swap_b32 v56, v58
    v_permlane16_swap_b32 v57, v59
    global_store_dwordx4 v239, v[56:59], s[6:7] sc1
    s_waitcnt lgkmcnt(2)
    v_lshlrev_b32 v64, 16, v144
    v_and_b32 v65, 0xffff0000, v144
    v_lshlrev_b32 v66, 16, v146
    v_and_b32 v67, 0xffff0000, v146
    v_lshlrev_b32 v68, 16, v145
    v_and_b32 v69, 0xffff0000, v145
    v_lshlrev_b32 v70, 16, v147
    v_and_b32 v71, 0xffff0000, v147
    v_pk_fma_f32 v[64:65], v[64:65], v[112:113], v[66:67] op_sel:[0,1,0] op_sel_hi:[1,1,1]
    v_pk_fma_f32 v[68:69], v[68:69], v[112:113], v[70:71] op_sel:[0,1,0] op_sel_hi:[1,1,1]
    v_pk_fma_f32 v[64:65], v[20:21], v[112:113], v[64:65] op_sel_hi:[1,0,1]
    v_pk_fma_f32 v[68:69], v[22:23], v[112:113], v[68:69] op_sel_hi:[1,0,1]
    v_pk_mul_f32 v[66:67], v[64:65], v[114:115] op_sel_hi:[1,0]
    v_pk_mul_f32 v[70:71], v[68:69], v[114:115] op_sel_hi:[1,0]
    v_cvt_pk_bf16_f32 v72, v64, v65
    v_cvt_pk_bf16_f32 v73, v68, v69
    v_cvt_pk_bf16_f32 v74, v66, v67
    v_cvt_pk_bf16_f32 v75, v70, v71
    s_add_u32 s6, s48, 655360
    s_addc_u32 s7, s49, 0
    v_permlane16_swap_b32 v72, v74
    global_load_dwordx4 a[76:79], v2, s[64:65] offset:-1024 sc1
    v_permlane16_swap_b32 v73, v75
    global_store_dwordx4 v239, v[72:75], s[6:7] sc1
    s_waitcnt lgkmcnt(0)
    v_lshlrev_b32 v80, 16, v148
    v_and_b32 v81, 0xffff0000, v148
    v_lshlrev_b32 v82, 16, v150
    v_and_b32 v83, 0xffff0000, v150
    v_lshlrev_b32 v84, 16, v149
    v_and_b32 v85, 0xffff0000, v149
    v_lshlrev_b32 v86, 16, v151
    v_and_b32 v87, 0xffff0000, v151
    v_pk_fma_f32 v[80:81], v[80:81], v[112:113], v[82:83] op_sel:[0,1,0] op_sel_hi:[1,1,1]
    v_pk_fma_f32 v[84:85], v[84:85], v[112:113], v[86:87] op_sel:[0,1,0] op_sel_hi:[1,1,1]
    v_pk_fma_f32 v[80:81], v[24:25], v[112:113], v[80:81] op_sel_hi:[1,0,1]
    v_pk_fma_f32 v[84:85], v[26:27], v[112:113], v[84:85] op_sel_hi:[1,0,1]
    v_pk_mul_f32 v[82:83], v[80:81], v[114:115] op_sel_hi:[1,0]
    v_pk_mul_f32 v[86:87], v[84:85], v[114:115] op_sel_hi:[1,0]
    v_cvt_pk_bf16_f32 v88, v80, v81
    v_cvt_pk_bf16_f32 v89, v84, v85
    v_cvt_pk_bf16_f32 v90, v82, v83
    v_cvt_pk_bf16_f32 v91, v86, v87
    s_add_u32 s6, s48, 983040
    s_addc_u32 s7, s49, 0
    v_permlane16_swap_b32 v88, v90
    v_permlane16_swap_b32 v89, v91
    s_nop 0
    global_store_dwordx4 v239, v[88:91], s[6:7] sc1
    ds_read_b128 v[32:35], v234 offset:4032
    ds_read_b128 v[36:39], v237 offset:12096
    ds_read_b128 v[40:43], v237 offset:10560
    ds_read_b128 v[44:47], v237 offset:9024
    ds_read_b128 v[48:51], v234 offset:3520
    ds_read_b128 v[52:55], v237 offset:7488
    ds_read_b128 v[56:59], v234 offset:3008
    ds_read_b128 v[60:63], v237 offset:5952
    ds_read_b128 v[64:67], v234 offset:2496
    ds_read_b128 v[68:71], v237 offset:4416
    ds_read_b128 v[72:75], v234 offset:1984
    ds_read_b128 v[76:79], v237 offset:2880
    s_waitcnt lgkmcnt(8)
    v_mfma_f32_16x16x32_bf16 v[24:27], v[32:35], v[36:39], 0
    ds_read_b128 v[80:83], v234 offset:1472
    v_mfma_f32_16x16x32_bf16 v[20:23], v[32:35], v[40:43], 0
    ds_read_b128 v[84:87], v237 offset:1344
    v_mfma_f32_16x16x32_bf16 v[16:19], v[32:35], v[44:47], 0
    ds_read_b128 v[88:91], v234 offset:960
    v_min_u32 v13, 213, v0
    s_waitcnt lgkmcnt(8)
    v_mfma_f32_16x16x32_bf16 v[24:27], v[48:51], v[40:43], v[24:27]
    ds_read_b128 v[92:95], v234 offset:448
    v_mfma_f32_16x16x32_bf16 v[20:23], v[48:51], v[44:47], v[20:23]
    ds_read_b128 v[96:99], v234 offset:3968
    v_lshlrev_b32 v13, 5, v13
    v_mfma_f32_16x16x32_bf16 v[16:19], v[48:51], v[52:55], v[16:19]
    ds_read_b128 v[100:103], v237 offset:11904
    v_mfma_f32_16x16x32_bf16 v[24:27], v[56:59], v[44:47], v[24:27]
    v_add_u32 v13, 102400, v13
    v_mfma_f32_16x16x32_bf16 v[20:23], v[56:59], v[52:55], v[20:23]
    ds_read_b128 v[104:107], v237 offset:10368
    s_waitcnt lgkmcnt(9)
    v_mfma_f32_16x16x32_bf16 v[16:19], v[56:59], v[60:63], v[16:19]
    ds_read_b128 v[108:111], v237 offset:8832
    v_lshrrev_b32 v12, 2, v1
    v_mfma_f32_16x16x32_bf16 v[24:27], v[64:67], v[52:55], v[24:27]
    global_load_dwordx4 a[80:83], v2, s[64:65] offset:0 sc1
    v_mfma_f32_16x16x32_bf16 v[20:23], v[64:67], v[60:63], v[20:23]
    ds_read_b128 v[36:39], v234 offset:3456
    v_lshlrev_b32 v12, 6, v12
    v_mfma_f32_16x16x32_bf16 v[16:19], v[64:67], v[68:71], v[16:19]
    ds_read_b128 v[32:35], v237 offset:7296
    s_waitcnt lgkmcnt(9)
    v_mfma_f32_16x16x32_bf16 v[24:27], v[72:75], v[60:63], v[24:27]
    v_bfe_u32 v4, v1, 4, 1
    v_mfma_f32_16x16x32_bf16 v[20:23], v[72:75], v[68:71], v[20:23]
    ds_read_b128 v[40:43], v234 offset:2944
    v_mfma_f32_16x16x32_bf16 v[16:19], v[72:75], v[76:79], v[16:19]
    ds_read_b128 v[48:51], v237 offset:5760
    v_lshl_add_u32 v12, v4, 5, v12
    v_mfma_f32_16x16x32_bf16 v[24:27], v[80:83], v[68:71], v[24:27]
    global_load_dwordx4 a[84:87], v2, s[64:65] offset:1024 sc1
    v_mfma_f32_16x16x32_bf16 v[20:23], v[80:83], v[76:79], v[20:23]
    ds_read_b128 v[44:47], v234 offset:2432
    v_and_b32 v4, 3, v1
    s_waitcnt lgkmcnt(9)
    v_mfma_f32_16x16x32_bf16 v[16:19], v[80:83], v[84:87], v[16:19]
    ds_read_b128 v[56:59], v237 offset:4224
    v_mfma_f32_16x16x32_bf16 v[24:27], v[88:91], v[76:79], v[24:27]
    v_lshl_add_u32 v12, v4, 3, v12
    v_mfma_f32_16x16x32_bf16 v[20:23], v[88:91], v[84:87], v[20:23]
    ds_read_b128 v[52:55], v234 offset:1920
    v_mfma_f32_16x16x32_bf16 v[24:27], v[92:95], v[84:87], v[24:27]
    ds_read_b128 v[64:67], v237 offset:2688
    v_add_u32 v8, 45056, v12
    s_waitcnt lgkmcnt(8)
    v_mfma_f32_16x16x32_bf16 v[24:27], v[96:99], v[100:103], v[24:27]
    ds_read_b128 v[60:63], v234 offset:1408
    v_mfma_f32_16x16x32_bf16 v[20:23], v[96:99], v[104:107], v[20:23]
    ds_read_b128 v[72:75], v237 offset:1152
    v_xor_b32 v9, 32, v8
    v_mfma_f32_16x16x32_bf16 v[16:19], v[96:99], v[108:111], v[16:19]
    ds_read_b128 v[68:71], v234 offset:896
    s_waitcnt lgkmcnt(8)
    v_mfma_f32_16x16x32_bf16 v[24:27], v[36:39], v[104:107], v[24:27]
    ds_read_b128 v[80:83], v234 offset:384
    s_and_b32 s6, s3, 1
    s_lshl_b32 s6, s6, 5
    v_xor_b32 v10, s6, v12
    v_mfma_f32_16x16x32_bf16 v[20:23], v[36:39], v[108:111], v[20:23]
    ds_read_b128 v[76:79], v234 offset:3904
    v_mfma_f32_16x16x32_bf16 v[16:19], v[36:39], v[32:35], v[16:19]
    ds_read_b128 v[88:91], v237 offset:11712
    v_add_u32 v10, 113664, v10
    v_mfma_f32_16x16x32_bf16 v[24:27], v[40:43], v[108:111], v[24:27]
    global_load_dwordx4 a[88:91], v2, s[64:65] offset:2048 sc1
    v_mfma_f32_16x16x32_bf16 v[20:23], v[40:43], v[32:35], v[20:23]
    ds_read_b128 v[92:95], v237 offset:10176
    v_lshrrev_b32 v4, 4, v1
    s_waitcnt lgkmcnt(9)
    v_mfma_f32_16x16x32_bf16 v[16:19], v[40:43], v[48:51], v[16:19]
    ds_read_b128 v[84:87], v237 offset:8640
    v_mfma_f32_16x16x32_bf16 v[24:27], v[44:47], v[32:35], v[24:27]
    s_lshl_b32 s6, s61, 12
    s_add_u32 s6, s6, 266240
    s_lshl_b32 s7, s3, 10
    s_add_u32 s6, s6, s7
    v_add_u32 v11, s6, v2
    v_mfma_f32_16x16x32_bf16 v[20:23], v[44:47], v[48:51], v[20:23]
    ds_read_b128 v[100:103], v234 offset:3392
    v_mfma_f32_16x16x32_bf16 v[16:19], v[44:47], v[56:59], v[16:19]
    ds_read_b128 v[96:99], v237 offset:7104
    v_and_b32 v5, 31, v1
    s_waitcnt lgkmcnt(9)
    v_mfma_f32_16x16x32_bf16 v[24:27], v[52:55], v[48:51], v[24:27]
    global_load_dwordx4 a[92:95], v2, s[64:65] offset:3072 sc1
    v_mfma_f32_16x16x32_bf16 v[20:23], v[52:55], v[56:59], v[20:23]
    ds_read_b128 v[104:107], v234 offset:2880
    v_lshlrev_b32 v5, 3, v5
    v_mfma_f32_16x16x32_bf16 v[16:19], v[52:55], v[64:67], v[16:19]
    ds_read_b128 v[36:39], v237 offset:5568
    v_mfma_f32_16x16x32_bf16 v[24:27], v[60:63], v[56:59], v[24:27]
    s_lshl_b32 s6, s3, 8
    s_add_u32 s6, s6, 123904
    v_add_u32 v128, s6, v5
    v_mfma_f32_16x16x32_bf16 v[20:23], v[60:63], v[64:67], v[20:23]
    ds_read_b128 v[108:111], v234 offset:2368
    s_waitcnt lgkmcnt(9)
    v_mfma_f32_16x16x32_bf16 v[16:19], v[60:63], v[72:75], v[16:19]
    ds_read_b128 v[40:43], v237 offset:4032
    v_lshrrev_b32 v6, 5, v1
    v_mfma_f32_16x16x32_bf16 v[24:27], v[68:71], v[64:67], v[24:27]
    s_add_u32 s64, s64, 8192
    s_addc_u32 s65, s65, 0
    v_mfma_f32_16x16x32_bf16 v[20:23], v[68:71], v[72:75], v[20:23]
    ds_read_b128 v[32:35], v234 offset:1856
    v_lshl_add_u32 v129, v6, 9, v5
    v_mfma_f32_16x16x32_bf16 v[24:27], v[80:83], v[72:75], v[24:27]
    ds_read_b128 v[44:47], v237 offset:2496
    s_waitcnt lgkmcnt(8)
    v_mfma_f32_16x16x32_bf16 v[24:27], v[76:79], v[88:91], v[24:27]
    ds_read_b128 v[48:51], v234 offset:1344
    v_add_u32 v129, 123904, v129
    v_mfma_f32_16x16x32_bf16 v[20:23], v[76:79], v[92:95], v[20:23]
    ds_read_b128 v[52:55], v237 offset:960
    v_mfma_f32_16x16x32_bf16 v[16:19], v[76:79], v[84:87], v[16:19]
    ds_read_b128 v[56:59], v234 offset:832
    s_mul_i32 s6, s62, 320
    s_add_u32 s6, s6, 240128
    v_lshl_add_u32 v6, v4, 4, s6
    s_waitcnt lgkmcnt(8)
    v_mfma_f32_16x16x32_bf16 v[24:27], v[100:103], v[92:95], v[24:27]
    ds_read_b128 v[60:63], v234 offset:320
    v_mfma_f32_16x16x32_bf16 v[20:23], v[100:103], v[84:87], v[20:23]
    ds_read_b128 v[64:67], v234 offset:3840
    v_bfe_u32 v5, v1, 3, 1
    v_mfma_f32_16x16x32_bf16 v[16:19], v[100:103], v[96:99], v[16:19]
    ds_read_b128 v[68:71], v237 offset:11520
    v_mfma_f32_16x16x32_bf16 v[24:27], v[104:107], v[84:87], v[24:27]
    v_mul_u32_u24 v5, 1280, v5
    v_mfma_f32_16x16x32_bf16 v[20:23], v[104:107], v[96:99], v[20:23]
    ds_read_b128 v[80:83], v237 offset:9984
    s_waitcnt lgkmcnt(9)
    v_mfma_f32_16x16x32_bf16 v[16:19], v[104:107], v[36:39], v[16:19]
    ds_read_b128 v[72:75], v237 offset:8448
    v_sub_u32 v5, 128256, v5
    v_mfma_f32_16x16x32_bf16 v[24:27], v[108:111], v[96:99], v[24:27]
    global_load_dwordx4 a[96:99], v2, s[64:65] offset:-4096 sc1
    v_mfma_f32_16x16x32_bf16 v[20:23], v[108:111], v[36:39], v[20:23]
    ds_read_b128 v[88:91], v234 offset:3328
    v_lshl_add_u32 v5, v4, 3, v5
    v_mfma_f32_16x16x32_bf16 v[16:19], v[108:111], v[40:43], v[16:19]
    ds_read_b128 v[76:79], v237 offset:6912
    s_waitcnt lgkmcnt(9)
    v_mfma_f32_16x16x32_bf16 v[24:27], v[32:35], v[36:39], v[24:27]
    v_and_b32 v15, 1, v1
    v_mfma_f32_16x16x32_bf16 v[20:23], v[32:35], v[40:43], v[20:23]
    ds_read_b128 v[92:95], v234 offset:2816
    v_mfma_f32_16x16x32_bf16 v[16:19], v[32:35], v[44:47], v[16:19]
    ds_read_b128 v[100:103], v237 offset:5376
    s_lshl_b32 s6, s61, 3
    s_lshl_b32 s7, s3, 1
    s_add_u32 s6, s6, s7
    v_add_u32 v15, s6, v15
    v_mfma_f32_16x16x32_bf16 v[24:27], v[48:51], v[40:43], v[24:27]
    global_load_dwordx4 a[100:103], v2, s[64:65] offset:-3072 sc1
    v_mfma_f32_16x16x32_bf16 v[20:23], v[48:51], v[44:47], v[20:23]
    ds_read_b128 v[84:87], v234 offset:2304
    v_lshlrev_b32 v15, 7, v15
    s_waitcnt lgkmcnt(9)
    v_mfma_f32_16x16x32_bf16 v[16:19], v[48:51], v[52:55], v[16:19]
    ds_read_b128 v[104:107], v237 offset:3840
    v_mfma_f32_16x16x32_bf16 v[24:27], v[56:59], v[44:47], v[24:27]
    v_add_u32 v15, 135168, v15
    v_mfma_f32_16x16x32_bf16 v[20:23], v[56:59], v[52:55], v[20:23]
    ds_read_b128 v[96:99], v234 offset:1792
    v_mfma_f32_16x16x32_bf16 v[24:27], v[60:63], v[52:55], v[24:27]
    ds_read_b128 v[108:111], v237 offset:2304
    s_waitcnt lgkmcnt(8)
    v_mfma_f32_16x16x32_bf16 v[24:27], v[64:67], v[68:71], v[24:27]
    ds_read_b128 v[36:39], v234 offset:1280
    s_waitcnt vmcnt(6)
    s_barrier
    v_mfma_f32_16x16x32_bf16 v[20:23], v[64:67], v[80:83], v[20:23]
    ds_read_b128 v[32:35], v237 offset:768
    v_mfma_f32_16x16x32_bf16 v[16:19], v[64:67], v[72:75], v[16:19]
    ds_read_b128 v[40:43], v234 offset:768
    s_waitcnt lgkmcnt(8)
    v_mfma_f32_16x16x32_bf16 v[24:27], v[88:91], v[80:83], v[24:27]
    ds_read_b128 v[48:51], v234 offset:256
    v_mfma_f32_16x16x32_bf16 v[20:23], v[88:91], v[72:75], v[20:23]
    ds_read_b128 v[44:47], v234 offset:3776
    v_mfma_f32_16x16x32_bf16 v[16:19], v[88:91], v[76:79], v[16:19]
    ds_read_b128 v[56:59], v237 offset:11328
    v_mfma_f32_16x16x32_bf16 v[24:27], v[92:95], v[72:75], v[24:27]
    global_load_dwordx4 a[104:107], v2, s[64:65] offset:-2048 sc1
    v_mfma_f32_16x16x32_bf16 v[20:23], v[92:95], v[76:79], v[20:23]
    ds_read_b128 v[60:63], v237 offset:9792
    s_waitcnt lgkmcnt(9)
    v_mfma_f32_16x16x32_bf16 v[16:19], v[92:95], v[100:103], v[16:19]
    ds_read_b128 v[52:55], v237 offset:8256
    v_mfma_f32_16x16x32_bf16 v[24:27], v[84:87], v[76:79], v[24:27]
    global_load_dwordx4 a[108:111], v2, s[64:65] offset:-1024 sc1
    v_mfma_f32_16x16x32_bf16 v[20:23], v[84:87], v[100:103], v[20:23]
    ds_read_b128 v[68:71], v234 offset:3264
    v_mfma_f32_16x16x32_bf16 v[16:19], v[84:87], v[104:107], v[16:19]
    ds_read_b128 v[64:67], v237 offset:6720
    s_waitcnt lgkmcnt(9)
    v_mfma_f32_16x16x32_bf16 v[24:27], v[96:99], v[100:103], v[24:27]
    global_load_dwordx4 a[112:115], v2, s[64:65] offset:0 sc1
    v_mfma_f32_16x16x32_bf16 v[20:23], v[96:99], v[104:107], v[20:23]
    ds_read_b128 v[80:83], v234 offset:2752
    v_mfma_f32_16x16x32_bf16 v[16:19], v[96:99], v[108:111], v[16:19]
    ds_read_b128 v[88:91], v237 offset:5184
    v_mfma_f32_16x16x32_bf16 v[24:27], v[36:39], v[104:107], v[24:27]
    global_load_dwordx4 a[116:119], v2, s[64:65] offset:1024 sc1
    v_mfma_f32_16x16x32_bf16 v[20:23], v[36:39], v[108:111], v[20:23]
    ds_read_b128 v[72:75], v234 offset:2240
    s_waitcnt lgkmcnt(9)
    v_mfma_f32_16x16x32_bf16 v[16:19], v[36:39], v[32:35], v[16:19]
    ds_read_b128 v[92:95], v237 offset:3648
    v_mfma_f32_16x16x32_bf16 v[24:27], v[40:43], v[108:111], v[24:27]
    global_load_dwordx4 a[120:123], v2, s[64:65] offset:2048 sc1
    v_mfma_f32_16x16x32_bf16 v[20:23], v[40:43], v[32:35], v[20:23]
    ds_read_b128 v[76:79], v234 offset:1728
    v_mfma_f32_16x16x32_bf16 v[24:27], v[48:51], v[32:35], v[24:27]
    ds_read_b128 v[84:87], v237 offset:2112
    s_waitcnt lgkmcnt(8)
    v_mfma_f32_16x16x32_bf16 v[24:27], v[44:47], v[56:59], v[24:27]
    ds_read_b128 v[100:103], v234 offset:1216
    v_mfma_f32_16x16x32_bf16 v[20:23], v[44:47], v[60:63], v[20:23]
    ds_read_b128 v[96:99], v237 offset:576
    v_mfma_f32_16x16x32_bf16 v[16:19], v[44:47], v[52:55], v[16:19]
    ds_read_b128 v[104:107], v234 offset:704
    s_waitcnt lgkmcnt(8)
    v_mfma_f32_16x16x32_bf16 v[24:27], v[68:71], v[60:63], v[24:27]
    ds_read_b128 v[36:39], v234 offset:192
    v_mfma_f32_16x16x32_bf16 v[20:23], v[68:71], v[52:55], v[20:23]
    ds_read_b128 v[108:111], v234 offset:3712
    v_mfma_f32_16x16x32_bf16 v[16:19], v[68:71], v[64:67], v[16:19]
    ds_read_b128 v[40:43], v237 offset:11136
    v_mfma_f32_16x16x32_bf16 v[24:27], v[80:83], v[52:55], v[24:27]
    global_load_dwordx4 a[124:127], v2, s[64:65] offset:3072 sc1
    v_mfma_f32_16x16x32_bf16 v[20:23], v[80:83], v[64:67], v[20:23]
    ds_read_b128 v[48:51], v237 offset:9600
    s_waitcnt lgkmcnt(9)
    v_mfma_f32_16x16x32_bf16 v[16:19], v[80:83], v[88:91], v[16:19]
    ds_read_b128 v[32:35], v237 offset:8064
    v_mfma_f32_16x16x32_bf16 v[24:27], v[72:75], v[64:67], v[24:27]
    s_add_u32 s64, s64, 8192
    s_addc_u32 s65, s65, 0
    v_mfma_f32_16x16x32_bf16 v[20:23], v[72:75], v[88:91], v[20:23]
    ds_read_b128 v[56:59], v234 offset:3200
    global_load_dword v125, v250, s[48:49] sc1
    v_mfma_f32_16x16x32_bf16 v[16:19], v[72:75], v[92:95], v[16:19]
    ds_read_b128 v[44:47], v237 offset:6528
    s_waitcnt lgkmcnt(9)
    v_mfma_f32_16x16x32_bf16 v[24:27], v[76:79], v[88:91], v[24:27]
    global_load_dwordx4 a[128:131], v2, s[64:65] offset:-4096 sc1
    v_mfma_f32_16x16x32_bf16 v[20:23], v[76:79], v[92:95], v[20:23]
    ds_read_b128 v[60:63], v234 offset:2688
    v_mfma_f32_16x16x32_bf16 v[16:19], v[76:79], v[84:87], v[16:19]
    ds_read_b128 v[68:71], v237 offset:4992
    v_mfma_f32_16x16x32_bf16 v[24:27], v[100:103], v[92:95], v[24:27]
    global_load_dwordx4 a[132:135], v2, s[64:65] offset:-3072 sc1
    v_mfma_f32_16x16x32_bf16 v[20:23], v[100:103], v[84:87], v[20:23]
    ds_read_b128 v[52:55], v234 offset:2176
    s_waitcnt lgkmcnt(9)
    v_mfma_f32_16x16x32_bf16 v[16:19], v[100:103], v[96:99], v[16:19]
    ds_read_b128 v[80:83], v237 offset:3456
    v_mfma_f32_16x16x32_bf16 v[24:27], v[104:107], v[84:87], v[24:27]
    global_load_dwordx4 a[136:139], v2, s[64:65] offset:-2048 sc1
    v_mfma_f32_16x16x32_bf16 v[20:23], v[104:107], v[96:99], v[20:23]
    ds_read_b128 v[64:67], v234 offset:1664
    v_mfma_f32_16x16x32_bf16 v[24:27], v[36:39], v[96:99], v[24:27]
    ds_read_b128 v[72:75], v237 offset:1920
    s_waitcnt lgkmcnt(8)
    v_mfma_f32_16x16x32_bf16 v[24:27], v[108:111], v[40:43], v[24:27]
    ds_read_b128 v[88:91], v234 offset:1152
    v_mfma_f32_16x16x32_bf16 v[20:23], v[108:111], v[48:51], v[20:23]
    ds_read_b128 v[76:79], v237 offset:384
    v_mfma_f32_16x16x32_bf16 v[16:19], v[108:111], v[32:35], v[16:19]
    ds_read_b128 v[92:95], v234 offset:640
    s_waitcnt lgkmcnt(8)
    v_mfma_f32_16x16x32_bf16 v[24:27], v[56:59], v[48:51], v[24:27]
    ds_read_b128 v[100:103], v234 offset:128
    v_mfma_f32_16x16x32_bf16 v[20:23], v[56:59], v[32:35], v[20:23]
    ds_read_b128 v[84:87], v234 offset:3648
    v_mfma_f32_16x16x32_bf16 v[16:19], v[56:59], v[44:47], v[16:19]
    ds_read_b128 v[104:107], v237 offset:10944
    v_mfma_f32_16x16x32_bf16 v[24:27], v[60:63], v[32:35], v[24:27]
    global_load_dwordx4 a[140:143], v2, s[64:65] offset:-1024 sc1
    v_mfma_f32_16x16x32_bf16 v[20:23], v[60:63], v[44:47], v[20:23]
    ds_read_b128 v[36:39], v237 offset:9408
    s_waitcnt lgkmcnt(9)
    v_mfma_f32_16x16x32_bf16 v[16:19], v[60:63], v[68:71], v[16:19]
    ds_read_b128 v[96:99], v237 offset:7872
    v_mfma_f32_16x16x32_bf16 v[24:27], v[52:55], v[44:47], v[24:27]
    global_load_dwordx4 a[144:147], v2, s[64:65] offset:0 sc1
    v_mfma_f32_16x16x32_bf16 v[20:23], v[52:55], v[68:71], v[20:23]
    ds_read_b128 v[40:43], v234 offset:3136
    v_mfma_f32_16x16x32_bf16 v[16:19], v[52:55], v[80:83], v[16:19]
    ds_read_b128 v[108:111], v237 offset:6336
    s_waitcnt lgkmcnt(9)
    v_mfma_f32_16x16x32_bf16 v[24:27], v[64:67], v[68:71], v[24:27]
    global_load_dwordx4 a[148:151], v2, s[64:65] offset:1024 sc1
    v_mfma_f32_16x16x32_bf16 v[20:23], v[64:67], v[80:83], v[20:23]
    ds_read_b128 v[48:51], v234 offset:2624
    v_mfma_f32_16x16x32_bf16 v[16:19], v[64:67], v[72:75], v[16:19]
    ds_read_b128 v[56:59], v237 offset:4800
    v_mfma_f32_16x16x32_bf16 v[24:27], v[88:91], v[80:83], v[24:27]
    global_load_dwordx4 a[152:155], v2, s[64:65] offset:2048 sc1
    v_mfma_f32_16x16x32_bf16 v[20:23], v[88:91], v[72:75], v[20:23]
    ds_read_b128 v[32:35], v234 offset:2112
    s_waitcnt lgkmcnt(9)
    v_mfma_f32_16x16x32_bf16 v[16:19], v[88:91], v[76:79], v[16:19]
    ds_read_b128 v[60:63], v237 offset:3264
    v_mfma_f32_16x16x32_bf16 v[24:27], v[92:95], v[72:75], v[24:27]
    global_load_dwordx4 a[156:159], v2, s[64:65] offset:3072 sc1
    v_mfma_f32_16x16x32_bf16 v[20:23], v[92:95], v[76:79], v[20:23]
    ds_read_b128 v[44:47], v234 offset:1600
    v_mfma_f32_16x16x32_bf16 v[24:27], v[100:103], v[76:79], v[24:27]
    ds_read_b128 v[52:55], v237 offset:1728
    s_waitcnt lgkmcnt(8)
    v_mfma_f32_16x16x32_bf16 v[24:27], v[84:87], v[104:107], v[24:27]
    ds_read_b128 v[68:71], v234 offset:1088
    s_waitcnt vmcnt(8)
    v_cmp_ne_u32 vcc, s50, v125
    s_nop 0
    s_cbranch_vccnz L_cfr_3
L_cfd_2:
    v_mfma_f32_16x16x32_bf16 v[20:23], v[84:87], v[36:39], v[20:23]
    ds_read_b128 v[64:67], v237 offset:192
    v_mfma_f32_16x16x32_bf16 v[16:19], v[84:87], v[96:99], v[16:19]
    ds_read_b128 v[80:83], v234 offset:576
    s_waitcnt lgkmcnt(8)
    v_mfma_f32_16x16x32_bf16 v[24:27], v[40:43], v[36:39], v[24:27]
    ds_read_b128 v[88:91], v234 offset:64
    v_mfma_f32_16x16x32_bf16 v[20:23], v[40:43], v[96:99], v[20:23]
    ds_read_b128 v[72:75], v234 offset:3584
    v_mfma_f32_16x16x32_bf16 v[16:19], v[40:43], v[108:111], v[16:19]
    ds_read_b128 v[92:95], v237 offset:10752
    v_mfma_f32_16x16x32_bf16 v[24:27], v[48:51], v[96:99], v[24:27]
    s_add_u32 s64, s64, 8192
    s_addc_u32 s65, s65, 0
    v_mfma_f32_16x16x32_bf16 v[20:23], v[48:51], v[108:111], v[20:23]
    ds_read_b128 v[100:103], v237 offset:9216
    s_waitcnt lgkmcnt(9)
    v_mfma_f32_16x16x32_bf16 v[16:19], v[48:51], v[56:59], v[16:19]
    ds_read_b128 v[76:79], v237 offset:7680
    v_mfma_f32_16x16x32_bf16 v[24:27], v[32:35], v[108:111], v[24:27]
    global_load_dwordx4 a[160:163], v2, s[64:65] offset:-4096 sc1
    v_mfma_f32_16x16x32_bf16 v[20:23], v[32:35], v[56:59], v[20:23]
    ds_read_b128 v[104:107], v234 offset:3072
    v_mfma_f32_16x16x32_bf16 v[16:19], v[32:35], v[60:63], v[16:19]
    ds_read_b128 v[84:87], v237 offset:6144
    s_waitcnt lgkmcnt(9)
    v_mfma_f32_16x16x32_bf16 v[24:27], v[44:47], v[56:59], v[24:27]
    global_load_dwordx4 a[164:167], v2, s[64:65] offset:-3072 sc1
    v_mfma_f32_16x16x32_bf16 v[20:23], v[44:47], v[60:63], v[20:23]
    ds_read_b128 v[36:39], v234 offset:2560
    v_mfma_f32_16x16x32_bf16 v[16:19], v[44:47], v[52:55], v[16:19]
    ds_read_b128 v[40:43], v237 offset:4608
    v_mfma_f32_16x16x32_bf16 v[24:27], v[68:71], v[60:63], v[24:27]
    global_load_dwordx4 a[168:171], v2, s[64:65] offset:-2048 sc1
    v_mfma_f32_16x16x32_bf16 v[20:23], v[68:71], v[52:55], v[20:23]
    ds_read_b128 v[96:99], v234 offset:2048
    s_waitcnt lgkmcnt(9)
    v_mfma_f32_16x16x32_bf16 v[16:19], v[68:71], v[64:67], v[16:19]
    ds_read_b128 v[48:51], v237 offset:3072
    v_mfma_f32_16x16x32_bf16 v[24:27], v[80:83], v[52:55], v[24:27]
    global_load_dwordx4 a[172:175], v2, s[64:65] offset:-1024 sc1
    v_mfma_f32_16x16x32_bf16 v[20:23], v[80:83], v[64:67], v[20:23]
    ds_read_b128 v[108:111], v234 offset:1536
    v_mfma_f32_16x16x32_bf16 v[24:27], v[88:91], v[64:67], v[24:27]
    ds_read_b128 v[32:35], v237 offset:1536
    s_waitcnt lgkmcnt(8)
    v_mfma_f32_16x16x32_bf16 v[24:27], v[72:75], v[92:95], v[24:27]
    ds_read_b128 v[56:59], v234 offset:1024
    global_load_dword v124, v245, s[48:49] sc1
    v_mfma_f32_16x16x32_bf16 v[20:23], v[72:75], v[100:103], v[20:23]
    ds_read_b128 v[44:47], v237 offset:0
    v_mfma_f32_16x16x32_bf16 v[16:19], v[72:75], v[76:79], v[16:19]
    ds_read_b128 v[60:63], v234 offset:512
    s_waitcnt lgkmcnt(8)
    v_mfma_f32_16x16x32_bf16 v[24:27], v[104:107], v[100:103], v[24:27]
    ds_read_b128 v[68:71], v234 offset:0
    ds_read_b64 v[140:141], v238 offset:7680
    ds_read_b64 v[142:143], v238 offset:19968
    ds_read_b64 v[144:145], v238 offset:9216
    ds_read_b64 v[146:147], v238 offset:21504
    ds_read_b64 v[148:149], v238 offset:10752
    ds_read_b64 v[150:151], v238 offset:23040
    v_mfma_f32_16x16x32_bf16 v[20:23], v[104:107], v[76:79], v[20:23]
    global_load_dwordx4 a[176:179], v2, s[64:65] offset:0 sc1
    v_mfma_f32_16x16x32_bf16 v[16:19], v[104:107], v[84:87], v[16:19]
    global_load_dwordx4 a[180:183], v2, s[64:65] offset:1024 sc1
    v_mfma_f32_16x16x32_bf16 v[24:27], v[36:39], v[76:79], v[24:27]
    v_mfma_f32_16x16x32_bf16 v[20:23], v[36:39], v[84:87], v[20:23]
    global_load_dwordx4 a[184:187], v2, s[64:65] offset:2048 sc1
    s_waitcnt lgkmcnt(12)
    v_mfma_f32_16x16x32_bf16 v[16:19], v[36:39], v[40:43], v[16:19]
    v_mfma_f32_16x16x32_bf16 v[24:27], v[96:99], v[84:87], v[24:27]
    v_mfma_f32_16x16x32_bf16 v[20:23], v[96:99], v[40:43], v[20:23]
    v_mfma_f32_16x16x32_bf16 v[16:19], v[96:99], v[48:51], v[16:19]
    global_load_dwordx4 a[188:191], v2, s[64:65] offset:3072 sc1
    s_waitcnt lgkmcnt(9)
    v_mfma_f32_16x16x32_bf16 v[24:27], v[108:111], v[40:43], v[24:27]
    v_mfma_f32_16x16x32_bf16 v[20:23], v[108:111], v[48:51], v[20:23]
    v_mfma_f32_16x16x32_bf16 v[16:19], v[108:111], v[32:35], v[16:19]
    v_mfma_f32_16x16x32_bf16 v[24:27], v[56:59], v[48:51], v[24:27]
    v_mfma_f32_16x16x32_bf16 v[20:23], v[56:59], v[32:35], v[20:23]
    s_add_u32 s64, s64, 8192
    s_addc_u32 s65, s65, 0
    s_waitcnt lgkmcnt(6)
    v_mfma_f32_16x16x32_bf16 v[16:19], v[56:59], v[44:47], v[16:19]
    global_load_dwordx4 a[192:195], v2, s[64:65] offset:-4096 sc1
    v_mfma_f32_16x16x32_bf16 v[24:27], v[60:63], v[32:35], v[24:27]
    v_mfma_f32_16x16x32_bf16 v[20:23], v[60:63], v[44:47], v[20:23]
    v_mfma_f32_16x16x32_bf16 v[24:27], v[68:71], v[44:47], v[24:27]
    global_load_dwordx4 a[196:199], v2, s[64:65] offset:-3072 sc1
    global_load_dwordx4 a[200:203], v2, s[64:65] offset:-2048 sc1
    s_waitcnt lgkmcnt(4)
    v_lshlrev_b32 v48, 16, v140
    v_and_b32 v49, 0xffff0000, v140
    v_lshlrev_b32 v50, 16, v142
    v_and_b32 v51, 0xffff0000, v142
    v_lshlrev_b32 v52, 16, v141
    v_and_b32 v53, 0xffff0000, v141
    v_lshlrev_b32_e64 v54, 16, v143
    v_and_b32 v55, 0xffff0000, v143
    v_pk_fma_f32 v[48:49], v[48:49], v[112:113], v[50:51] op_sel:[0,1,0] op_sel_hi:[1,1,1]
    v_pk_fma_f32 v[52:53], v[52:53], v[112:113], v[54:55] op_sel:[0,1,0] op_sel_hi:[1,1,1]
    v_pk_fma_f32 v[48:49], v[16:17], v[112:113], v[48:49] op_sel_hi:[1,0,1]
    v_pk_fma_f32 v[52:53], v[18:19], v[112:113], v[52:53] op_sel_hi:[1,0,1]
    v_pk_mul_f32 v[50:51], v[48:49], v[114:115] op_sel_hi:[1,0]
    v_pk_mul_f32 v[54:55], v[52:53], v[114:115] op_sel_hi:[1,0]
    v_cvt_pk_bf16_f32 v56, v48, v49
    v_cvt_pk_bf16_f32 v57, v52, v53
    v_cvt_pk_bf16_f32 v58, v50, v51
    v_cvt_pk_bf16_f32 v59, v54, v55
    s_add_u32 s6, s48, 1638400
    s_addc_u32 s7, s49, 0
    v_permlane16_swap_b32 v56, v58
    v_permlane16_swap_b32 v57, v59
    global_store_dwordx4 v239, v[56:59], s[6:7] sc1
    s_waitcnt lgkmcnt(2)
    v_lshlrev_b32 v64, 16, v144
    v_and_b32 v65, 0xffff0000, v144
    v_lshlrev_b32 v66, 16, v146
    v_and_b32 v67, 0xffff0000, v146
    v_lshlrev_b32 v68, 16, v145
    v_and_b32 v69, 0xffff0000, v145
    v_lshlrev_b32 v70, 16, v147
    v_and_b32 v71, 0xffff0000, v147
    v_pk_fma_f32 v[64:65], v[64:65], v[112:113], v[66:67] op_sel:[0,1,0] op_sel_hi:[1,1,1]
    v_pk_fma_f32 v[68:69], v[68:69], v[112:113], v[70:71] op_sel:[0,1,0] op_sel_hi:[1,1,1]
    v_pk_fma_f32 v[64:65], v[20:21], v[112:113], v[64:65] op_sel_hi:[1,0,1]
    v_pk_fma_f32 v[68:69], v[22:23], v[112:113], v[68:69] op_sel_hi:[1,0,1]
    v_pk_mul_f32 v[66:67], v[64:65], v[114:115] op_sel_hi:[1,0]
    v_pk_mul_f32 v[70:71], v[68:69], v[114:115] op_sel_hi:[1,0]
    v_cvt_pk_bf16_f32 v72, v64, v65
    v_cvt_pk_bf16_f32 v73, v68, v69
    v_cvt_pk_bf16_f32 v74, v66, v67
    v_cvt_pk_bf16_f32 v75, v70, v71
    s_add_u32 s6, s48, 1966080
    s_addc_u32 s7, s49, 0
    v_permlane16_swap_b32 v72, v74
    v_permlane16_swap_b32 v73, v75
    global_store_dwordx4 v239, v[72:75], s[6:7] sc1
    s_waitcnt lgkmcnt(0)
    v_lshlrev_b32 v80, 16, v148
    v_and_b32 v81, 0xffff0000, v148
    v_lshlrev_b32 v82, 16, v150
    v_and_b32 v83, 0xffff0000, v150
    v_lshlrev_b32 v84, 16, v149
    v_and_b32 v85, 0xffff0000, v149
    v_lshlrev_b32 v86, 16, v151
    v_and_b32 v87, 0xffff0000, v151
    v_pk_fma_f32 v[80:81], v[80:81], v[112:113], v[82:83] op_sel:[0,1,0] op_sel_hi:[1,1,1]
    v_pk_fma_f32 v[84:85], v[84:85], v[112:113], v[86:87] op_sel:[0,1,0] op_sel_hi:[1,1,1]
    v_pk_fma_f32 v[80:81], v[24:25], v[112:113], v[80:81] op_sel_hi:[1,0,1]
    v_pk_fma_f32 v[84:85], v[26:27], v[112:113], v[84:85] op_sel_hi:[1,0,1]
    v_pk_mul_f32 v[82:83], v[80:81], v[114:115] op_sel_hi:[1,0]
    v_pk_mul_f32 v[86:87], v[84:85], v[114:115] op_sel_hi:[1,0]
    v_cvt_pk_bf16_f32 v88, v80, v81
    v_cvt_pk_bf16_f32 v89, v84, v85
    v_cvt_pk_bf16_f32 v90, v82, v83
    v_cvt_pk_bf16_f32 v91, v86, v87
    s_add_u32 s6, s48, 2293760
    s_addc_u32 s7, s49, 0
    v_permlane16_swap_b32 v88, v90
    v_permlane16_swap_b32 v89, v91
    global_store_dwordx4 v239, v[88:91], s[6:7] sc1
    s_waitcnt vmcnt(10)
    v_cmp_ne_u32 vcc, s50, v124
    s_nop 0
    s_cbranch_vccnz L_cfr_6
L_cfd_5:
    s_branch L_POST
L_W3_P1:
    ds_read_b64_tr_b16 v[96:97], v62 offset:0
    ds_read_b64_tr_b16 v[98:99], v62 offset:5120
    ds_read_b64_tr_b16 v[100:101], v62 offset:128
    ds_read_b64_tr_b16 v[102:103], v62 offset:5248
    ds_read_b64_tr_b16 v[104:105], v62 offset:256
    ds_read_b64_tr_b16 v[106:107], v62 offset:5376
    ds_read_b64_tr_b16 v[108:109], v62 offset:384
    ds_read_b64_tr_b16 v[110:111], v62 offset:5504
    ds_read_b64_tr_b16 v[112:113], v62 offset:512
    ds_read_b64_tr_b16 v[114:115], v62 offset:5632
    s_waitcnt lgkmcnt(8)
    global_store_dwordx4 v63, v[96:99], s[48:49] sc1
    v_add_u32 v63, 264192, v63
    s_waitcnt lgkmcnt(6)
    global_store_dwordx4 v63, v[100:103], s[48:49] sc1
    v_add_u32 v63, 264192, v63
    s_waitcnt lgkmcnt(4)
    global_store_dwordx4 v63, v[104:107], s[48:49] sc1
    v_add_u32 v63, 264192, v63
    s_waitcnt lgkmcnt(2)
    global_store_dwordx4 v63, v[108:111], s[48:49] sc1
    v_add_u32 v63, 264192, v63
    s_waitcnt lgkmcnt(0)
    s_nop 0
    global_store_dwordx4 v63, v[112:115], s[48:49] sc1
    v_add_u32 v63, 264192, v63
    ds_read_b64_tr_b16 v[116:117], v62 offset:640
    ds_read_b64_tr_b16 v[118:119], v62 offset:5760
    ds_read_b64_tr_b16 v[120:121], v62 offset:768
    ds_read_b64_tr_b16 v[122:123], v62 offset:5888
    ds_read_b64_tr_b16 v[124:125], v62 offset:896
    ds_read_b64_tr_b16 v[126:127], v62 offset:6016
    ds_read_b64_tr_b16 v[128:129], v62 offset:1024
    ds_read_b64_tr_b16 v[130:131], v62 offset:6144
    ds_read_b64_tr_b16 v[132:133], v62 offset:1152
    ds_read_b64_tr_b16 v[134:135], v62 offset:6272
    s_waitcnt lgkmcnt(8)
    global_store_dwordx4 v63, v[116:119], s[48:49] sc1
    v_add_u32 v63, 264192, v63
    s_waitcnt lgkmcnt(6)
    global_store_dwordx4 v63, v[120:123], s[48:49] sc1
    v_add_u32 v63, 264192, v63
    s_waitcnt lgkmcnt(4)
    global_store_dwordx4 v63, v[124:127], s[48:49] sc1
    v_add_u32 v63, 264192, v63
    s_waitcnt lgkmcnt(2)
    global_store_dwordx4 v63, v[128:131], s[48:49] sc1
    v_add_u32 v63, 264192, v63
    s_waitcnt lgkmcnt(0)
    global_store_dwordx4 v63, v[132:135], s[48:49] sc1
    v_mov_b32 v38, 0
    v_mov_b32 v39, 0
    v_mov_b32 v40, 0x3f803f80
    s_waitcnt lgkmcnt(0)
    v_dot2c_f32_bf16 v38, v28, v40
    v_dot2c_f32_bf16 v39, v28, v28
    v_dot2c_f32_bf16 v38, v29, v40
    v_dot2c_f32_bf16 v39, v29, v29
    v_dot2c_f32_bf16 v38, v30, v40
    v_dot2c_f32_bf16 v39, v30, v30
    v_dot2c_f32_bf16 v38, v31, v40
    v_dot2c_f32_bf16 v39, v31, v31
    v_dot2c_f32_bf16 v38, v32, v40
    v_dot2c_f32_bf16 v39, v32, v32
    v_dot2c_f32_bf16 v38, v33, v40
    v_dot2c_f32_bf16 v39, v33, v33
    v_dot2c_f32_bf16 v38, v34, v40
    v_dot2c_f32_bf16 v39, v34, v34
    v_dot2c_f32_bf16 v38, v35, v40
    v_dot2c_f32_bf16 v39, v35, v35
    v_dot2c_f32_bf16 v38, v36, v40
    v_dot2c_f32_bf16 v39, v36, v36
    v_dot2c_f32_bf16 v38, v37, v40
    v_dot2c_f32_bf16 v39, v37, v37
    s_nop 2
    v_permlane16_swap_b32 v38, v39
    v_add_f32 v38, v38, v39
    s_nop 1
    v_add_f32_dpp v38, v38, v38 quad_perm:[1,0,3,2] row_mask:0xf bank_mask:0xf
    s_nop 1
    v_add_f32_dpp v38, v38, v38 quad_perm:[2,3,0,1] row_mask:0xf bank_mask:0xf
    s_nop 1
    v_add_f32_dpp v38, v38, v38 row_half_mirror row_mask:0xf bank_mask:0xf
    s_nop 1
    v_add_f32_dpp v38, v38, v38 row_mirror row_mask:0xf bank_mask:0xf
    v_mov_b32 v39, v38
    s_nop 1
    v_permlane16_swap_b32 v38, v39
    v_mul_f32 v38, 0x3acccccd, v38
    v_mul_f32 v39, 0x3acccccd, v39
    v_fma_f32 v39, -v38, v38, v39
    v_max_f32 v39, 0, v39
    v_cvt_pk_bf16_f32 v41, v38, v39
    v_and_b32 v39, 0xffff0000, v41
    v_lshlrev_b32 v38, 16, v41
    v_add_f32 v39, 0x3727c5ac, v39
    v_cvt_pk_bf16_f32 v39, v39, v39
    v_lshlrev_b32 v39, 16, v39
    v_sqrt_f32 v39, v39
    s_nop 0
    v_cvt_pk_bf16_f32 v39, v39, v39
    v_lshlrev_b32 v39, 16, v39
    v_rcp_f32 v39, v39
    s_nop 0
    v_mul_f32 v38, -v38, v39
    ds_write2_b32 v60, v39, v38 offset0:0 offset1:8
    s_lshr_b32 s6, s2, 2
    v_xor_b32 v4, s6, v1
    v_and_b32 v4, 3, v4
    s_lshl_b32 s6, s2, 6
    s_add_u32 s6, s6, 540672
    v_lshl_add_u32 v4, v4, 4, s6
    v_and_b32 v5, 3, v1
    v_lshlrev_b32 v5, 4, v5
    v_add_u32 v5, 125952, v5
    s_mov_b32 s90, 0
    v_mov_b32 v42, 126016
L_ls_7:
    ds_read_b32 v43, v42
    s_add_u32 s90, s90, 1
    s_waitcnt lgkmcnt(0)
    v_cmp_ne_u32 vcc, 3, v43
    s_nop 0
    s_cbranch_vccz L_lsd_8
    s_cmp_gt_u32 s90, 1048576
    s_cbranch_scc0 L_ls_7
L_lsd_8:
    ds_read_b128 v[44:47], v5
    s_waitcnt lgkmcnt(0)
    s_mov_b64 exec, 15
    global_store_dwordx4 v4, v[44:47], s[48:49] sc1
    s_mov_b64 exec, -1
    s_cmp_ge_u32 s2, 240
    s_cbranch_scc1 L_W3_NOMOD
    s_waitcnt vmcnt(11)
    ds_read_b64_tr_b16 v[136:137], v58 offset:0
    ds_read_b64_tr_b16 v[138:139], v58 offset:4096
    ds_read_b64_tr_b16 v[140:141], v58 offset:32
    ds_read_b64_tr_b16 v[142:143], v58 offset:4128
    ds_read_b64_tr_b16 v[144:145], v58 offset:64
    ds_read_b64_tr_b16 v[146:147], v58 offset:4160
    ds_read_b64_tr_b16 v[148:149], v58 offset:96
    ds_read_b64_tr_b16 v[150:151], v58 offset:4192
    s_waitcnt lgkmcnt(6)
    global_store_dwordx4 v50, v[136:139], s[48:49] sc1
    s_waitcnt lgkmcnt(4)
    global_store_dwordx4 v51, v[140:143], s[48:49] sc1
    s_waitcnt lgkmcnt(2)
    global_store_dwordx4 v52, v[144:147], s[48:49] sc1
    s_waitcnt lgkmcnt(0)
    global_store_dwordx4 v53, v[148:151], s[48:49] sc1
    ds_read_b64_tr_b16 v[152:153], v58 offset:128
    ds_read_b64_tr_b16 v[154:155], v58 offset:4224
    ds_read_b64_tr_b16 v[156:157], v58 offset:160
    ds_read_b64_tr_b16 v[158:159], v58 offset:4256
    ds_read_b64_tr_b16 v[160:161], v58 offset:192
    ds_read_b64_tr_b16 v[162:163], v58 offset:4288
    ds_read_b64_tr_b16 v[164:165], v58 offset:224
    ds_read_b64_tr_b16 v[166:167], v58 offset:4320
    s_waitcnt lgkmcnt(6)
    global_store_dwordx4 v54, v[152:155], s[48:49] sc1
    s_waitcnt lgkmcnt(4)
    global_store_dwordx4 v55, v[156:159], s[48:49] sc1
    s_waitcnt lgkmcnt(2)
    global_store_dwordx4 v56, v[160:163], s[48:49] sc1
    s_waitcnt lgkmcnt(0)
    global_store_dwordx4 v57, v[164:167], s[48:49] sc1
    global_load_dwordx4 v[96:99], v215, s[42:43]
    v_add_u32 v215, 7680, v215
    global_load_dwordx4 v[100:103], v215, s[42:43]
    v_add_u32 v215, 7680, v215
    global_load_dwordx4 v[104:107], v215, s[42:43]
    v_add_u32 v215, 7680, v215
    global_load_dwordx4 v[108:111], v215, s[42:43]
    v_add_u32 v215, 7680, v215
    global_load_dwordx4 v[112:115], v215, s[42:43]
    v_add_u32 v215, 7680, v215
    global_load_dwordx4 v[116:119], v215, s[42:43]
    v_add_u32 v215, 7680, v215
    global_load_dwordx4 v[120:123], v215, s[42:43]
    v_add_u32 v215, 7680, v215
    global_load_dwordx4 v[124:127], v215, s[42:43]
    v_add_u32 v215, 7680, v215
    global_load_dwordx4 v[128:131], v215, s[42:43]
    v_add_u32 v215, 7680, v215
    global_load_dwordx4 v[132:135], v215, s[42:43]
    v_add_u32 v215, 7680, v215
    global_load_dwordx4 v[136:139], v215, s[42:43]
    v_add_u32 v215, 7680, v215
    global_load_dwordx4 v[140:143], v215, s[42:43]
    v_add_u32 v215, 7680, v215
    global_load_dwordx4 v[144:147], v215, s[42:43]
    v_add_u32 v215, 7680, v215
    global_load_dwordx4 v[148:151], v215, s[42:43]
    v_add_u32 v215, 7680, v215
    global_load_dwordx4 v[152:155], v215, s[42:43]
    v_add_u32 v215, 7680, v215
    global_load_dwordx4 v[156:159], v215, s[42:43]
    v_add_u32 v215, 7680, v215
    global_load_dwordx4 v[160:163], v215, s[42:43]
    v_add_u32 v215, 7680, v215
    global_load_dwordx4 v[164:167], v215, s[42:43]
    v_add_u32 v215, 7680, v215
    global_load_dwordx4 v[168:171], v215, s[42:43]
    v_add_u32 v215, 7680, v215
    global_load_dwordx4 v[172:175], v215, s[42:43]
    v_lshlrev_b32 v8, 16, v8
    v_lshlrev_b32 v9, 16, v9
    v_lshlrev_b32 v10, 16, v10
    v_mul_f32 v12, 0xbfb8aa3b, v8
    v_mul_f32 v13, 0xbfb8aa3b, v9
    v_mul_f32 v14, 0xbfb8aa3b, v10
    v_exp_f32 v12, v12
    v_exp_f32 v13, v13
    v_exp_f32 v14, v14
    v_add_f32 v12, 1.0, v12
    v_add_f32 v13, 1.0, v13
    v_add_f32 v14, 1.0, v14
    v_rcp_f32 v12, v12
    v_rcp_f32 v13, v13
    v_rcp_f32 v14, v14
    v_mul_f32 v12, v12, v8
    v_mul_f32 v13, v13, v9
    v_mul_f32 v14, v14, v10
    v_cvt_pk_bf16_f32 v12, v12, 0
    v_cvt_pk_bf16_f32 v13, v13, 0
    v_cvt_pk_bf16_f32 v14, v14, 0
    v_lshlrev_b32 v4, 2, v1
    v_add_u32 v4, 143360, v4
    v_lshrrev_b32 v5, 3, v1
    v_mul_u32_u24 v5, 80, v5
    v_add_u32 v5, 143360, v5
    ds_write_b32 v4, v12
    ds_write_b32 v4, v13 offset:256
    s_mov_b32 exec_hi, 0
    ds_write_b32 v4, v14 offset:512
    s_mov_b64 exec, -1
    s_waitcnt lgkmcnt(0)
    ds_read_b128 v[176:179], v5 offset:0
    ds_read_b128 v[180:183], v5 offset:16
    ds_read_b128 v[184:187], v5 offset:32
    ds_read_b128 v[188:191], v5 offset:48
    ds_read_b128 v[192:195], v5 offset:64
    v_mov_b32 v196, 0
    v_mov_b32 v197, 0
    v_mov_b32 v198, 0
    v_mov_b32 v199, 0
    v_mov_b32 v200, 0
    v_mov_b32 v201, 0
    v_mov_b32 v202, 0
    v_mov_b32 v203, 0
    s_waitcnt lgkmcnt(0)
    v_lshlrev_b32 v64, 16, v176
    v_lshlrev_b32 v65, 16, v177
    v_lshlrev_b32 v66, 16, v178
    v_lshlrev_b32 v67, 16, v179
    v_lshlrev_b32 v68, 16, v180
    v_lshlrev_b32 v69, 16, v181
    v_lshlrev_b32 v70, 16, v182
    v_lshlrev_b32 v71, 16, v183
    v_lshlrev_b32 v72, 16, v184
    v_lshlrev_b32 v73, 16, v185
    v_lshlrev_b32 v74, 16, v186
    v_lshlrev_b32 v75, 16, v187
    v_lshlrev_b32 v76, 16, v188
    v_lshlrev_b32 v77, 16, v189
    v_lshlrev_b32 v78, 16, v190
    v_lshlrev_b32 v79, 16, v191
    v_lshlrev_b32 v80, 16, v192
    v_lshlrev_b32 v81, 16, v193
    v_lshlrev_b32 v82, 16, v194
    v_lshlrev_b32 v83, 16, v195
    s_waitcnt vmcnt(20)
    s_lshl_b32 s88, s2, 6
    s_add_u32 s88, s88, 4096
    v_lshl_add_u32 v48, v1, 2, s88
    v_mov_b32 v49, s50
    s_mov_b64 exec, 0xffff
    global_store_dword v48, v49, s[48:49] sc1
    s_mov_b64 exec, -1
    v_mov_b32 v48, 126020
    v_mov_b32 v49, 1
    ds_write_b32 v48, v49
    v_and_b32 v20, 7, v1
    v_and_b32 v21, 1, v20
    v_lshrrev_b32 v22, 2, v20
    v_lshl_add_u32 v21, v21, 1, v22
    v_mul_u32_u24 v21, 4128, v21
    v_bfe_u32 v22, v20, 1, 1
    v_mul_u32_u24 v22, 49792, v22
    v_add_u32 v21, v21, v22
    v_lshrrev_b32 v22, 4, v1
    v_bfe_u32 v23, v1, 3, 1
    v_sub_u32 v23, v22, v23
    v_lshl_add_u32 v21, v23, 4, v21
    v_and_b32 v23, 15, v1
    v_lshl_add_u32 v24, v23, 1, v22
    v_mul_u32_u24 v24, 48, v24
    v_lshrrev_b32 v25, 1, v22
    v_lshl_add_u32 v26, v23, 1, v25
    v_mul_u32_u24 v26, 48, v26
    v_and_b32 v27, 1, v22
    v_lshl_add_u32 v26, v27, 3, v26
    v_lshrrev_b32 v28, 1, v23
    v_mul_u32_u24 v28, 40960, v28
    v_lshl_add_u32 v28, v25, 4, v28
    v_mul_u32_u24 v27, 2621440, v27
    v_add_u32 v28, v28, v27
    v_and_b32 v23, 1, v23
    v_lshl_add_u32 v28, v23, 5, v28
    v_add_u32 v234, 32, v21
    v_add_u32 v235, 16560, v21
    v_add_u32 v236, 33088, v21
    v_add_u32 v237, 99936, v24
    v_add_u32 v238, 101376, v26
    s_add_u32 s6, s51, 0
    s_lshl_b32 s7, s6, 6
    s_add_u32 s8, s7, 12582912
    s_cmp_ge_u32 s6, 640
    s_cselect_b32 s7, s8, s7
    s_add_u32 s7, s7, 10485760
    s_lshl_b32 s6, s6, 3
    s_and_b32 s6, s6, 32
    v_xor_b32 v239, s6, v28
    v_add_u32 v239, s7, v239
    s_add_u32 s6, s51, 1
    s_lshl_b32 s7, s6, 6
    s_add_u32 s8, s7, 12582912
    s_cmp_ge_u32 s6, 640
    s_cselect_b32 s7, s8, s7
    s_add_u32 s7, s7, 10485760
    s_lshl_b32 s6, s6, 3
    s_and_b32 s6, s6, 32
    v_xor_b32 v240, s6, v28
    v_add_u32 v240, s7, v240
    s_add_u32 s6, s51, 2
    s_lshl_b32 s7, s6, 6
    s_add_u32 s8, s7, 12582912
    s_cmp_ge_u32 s6, 640
    s_cselect_b32 s7, s8, s7
    s_add_u32 s7, s7, 10485760
    s_lshl_b32 s6, s6, 3
    s_and_b32 s6, s6, 32
    v_xor_b32 v241, s6, v28
    v_add_u32 v241, s7, v241
    v_mul_u32_u24 v242, 48, v0
    v_add_u32 v242, 101376, v242
    v_bfe_u32 v21, v0, 2, 2
    v_lshlrev_b32 v21, 4, v21
    v_lshl_add_u32 v21, v0, 6, v21
    v_add_u32 v243, 135168, v21
    v_min_u32 v244, 59, v1
    v_lshlrev_b32 v244, 4, v244
    v_add_u32 v244, 36864, v244
    s_lshl_b32 s6, s3, 2
    s_add_u32 s6, s6, 126080
    v_mov_b32 v251, 126080
    v_min_u32 v250, 41, v1
    v_lshlrev_b32 v250, 5, v250
    v_add_u32 v250, 207552, v250
    v_min_u32 v245, 213, v0
    v_lshlrev_b32 v245, 5, v245
    v_add_u32 v245, 69632, v245
    v_add_u32 v20, 0, v1
    v_mul_u32_u24 v21, 0x5556, v20
    v_lshrrev_b32 v21, 16, v21
    v_mul_u32_u24 v22, 3, v21
    v_sub_u32 v22, v20, v22
    v_add_u32 v22, s51, v22
    v_min_u32 v22, 639, v22
    v_lshrrev_b32 v23, 2, v22
    v_mul_u32_u24 v23, 16512, v23
    v_lshl_add_u32 v23, v21, 6, v23
    v_and_b32 v22, 3, v22
    v_lshl_add_u32 v247, v22, 4, v23
    v_add_u32 v20, 64, v1
    v_mul_u32_u24 v21, 0x5556, v20
    v_lshrrev_b32 v21, 16, v21
    v_mul_u32_u24 v22, 3, v21
    v_sub_u32 v22, v20, v22
    v_add_u32 v22, s51, v22
    v_min_u32 v22, 639, v22
    v_lshrrev_b32 v23, 2, v22
    v_mul_u32_u24 v23, 16512, v23
    v_lshl_add_u32 v23, v21, 6, v23
    v_and_b32 v22, 3, v22
    v_lshl_add_u32 v248, v22, 4, v23
    v_add_u32 v20, 128, v1
    v_mul_u32_u24 v21, 0x5556, v20
    v_lshrrev_b32 v21, 16, v21
    v_mul_u32_u24 v22, 3, v21
    v_sub_u32 v22, v20, v22
    v_add_u32 v22, s51, v22
    v_min_u32 v22, 639, v22
    v_lshrrev_b32 v23, 2, v22
    v_mul_u32_u24 v23, 16512, v23
    v_lshl_add_u32 v23, v21, 6, v23
    v_and_b32 v22, 3, v22
    v_lshl_add_u32 v249, v22, 4, v23
    v_bfe_u32 v20, v1, 2, 3
    v_mul_u32_u24 v21, 0x5556, v20
    v_lshrrev_b32 v21, 16, v21
    v_mul_u32_u24 v21, 3, v21
    v_sub_u32 v21, v20, v21
    v_add_u32 v21, s51, v21
    v_min_u32 v21, 639, v21
    v_lshlrev_b32 v209, 1, v21
    v_and_b32 v22, 3, v1
    v_mul_u32_u24 v22, 3840, v22
    v_add_u32 v21, v21, v22
    v_lshrrev_b32 v22, 5, v1
    v_mul_u32_u24 v22, 640, v22
    v_add_u32 v21, v21, v22
    v_add3_u32 v22, v21, v22, 0
    v_lshlrev_b32 v207, 3, v21
    v_add_u32 v207, 851968, v207
    v_lshlrev_b32 v208, 3, v22
    v_add_u32 v208, 862208, v208
    v_lshrrev_b32 v214, 2, v1
    v_lshlrev_b32 v214, 2, v214
    v_add_u32 v214, 126080, v214
    v_add_u32 v210, 0, v1
    v_min_u32 v210, 255, v210
    v_lshlrev_b32 v210, 6, v210
    v_add_u32 v210, 4096, v210
    v_add_u32 v211, 64, v1
    v_min_u32 v211, 255, v211
    v_lshlrev_b32 v211, 6, v211
    v_add_u32 v211, 4096, v211
    v_add_u32 v212, 128, v1
    v_min_u32 v212, 255, v212
    v_lshlrev_b32 v212, 6, v212
    v_add_u32 v212, 4096, v212
    v_add_u32 v213, 192, v1
    v_min_u32 v213, 255, v213
    v_lshlrev_b32 v213, 6, v213
    v_add_u32 v213, 4096, v213
    v_bfe_u32 v4, v1, 3, 1
    v_cmp_eq_u32 vcc, 1, v4
    s_waitcnt vmcnt(20)
    v_dot2c_f32_bf16 v196, v96, v176
    v_dot2c_f32_bf16 v197, v96, v64
    v_dot2c_f32_bf16 v198, v97, v176
    v_dot2c_f32_bf16 v199, v97, v64
    v_dot2c_f32_bf16 v200, v98, v176
    v_dot2c_f32_bf16 v201, v98, v64
    v_dot2c_f32_bf16 v202, v99, v176
    v_dot2c_f32_bf16 v203, v99, v64
    s_waitcnt vmcnt(19)
    v_dot2c_f32_bf16 v196, v100, v177
    v_dot2c_f32_bf16 v197, v100, v65
    v_dot2c_f32_bf16 v198, v101, v177
    v_dot2c_f32_bf16 v199, v101, v65
    v_dot2c_f32_bf16 v200, v102, v177
    v_dot2c_f32_bf16 v201, v102, v65
    v_dot2c_f32_bf16 v202, v103, v177
    v_dot2c_f32_bf16 v203, v103, v65
    s_waitcnt vmcnt(18)
    v_dot2c_f32_bf16 v196, v104, v178
    v_dot2c_f32_bf16 v197, v104, v66
    v_dot2c_f32_bf16 v198, v105, v178
    v_dot2c_f32_bf16 v199, v105, v66
    v_dot2c_f32_bf16 v200, v106, v178
    v_dot2c_f32_bf16 v201, v106, v66
    v_dot2c_f32_bf16 v202, v107, v178
    v_dot2c_f32_bf16 v203, v107, v66
    s_waitcnt vmcnt(17)
    v_dot2c_f32_bf16 v196, v108, v179
    v_dot2c_f32_bf16 v197, v108, v67
    v_dot2c_f32_bf16 v198, v109, v179
    v_dot2c_f32_bf16 v199, v109, v67
    v_dot2c_f32_bf16 v200, v110, v179
    v_dot2c_f32_bf16 v201, v110, v67
    v_dot2c_f32_bf16 v202, v111, v179
    v_dot2c_f32_bf16 v203, v111, v67
    s_waitcnt vmcnt(16)
    v_dot2c_f32_bf16 v196, v112, v180
    v_dot2c_f32_bf16 v197, v112, v68
    v_dot2c_f32_bf16 v198, v113, v180
    v_dot2c_f32_bf16 v199, v113, v68
    v_dot2c_f32_bf16 v200, v114, v180
    v_dot2c_f32_bf16 v201, v114, v68
    v_dot2c_f32_bf16 v202, v115, v180
    v_dot2c_f32_bf16 v203, v115, v68
    s_waitcnt vmcnt(15)
    v_dot2c_f32_bf16 v196, v116, v181
    v_dot2c_f32_bf16 v197, v116, v69
    v_dot2c_f32_bf16 v198, v117, v181
    v_dot2c_f32_bf16 v199, v117, v69
    v_dot2c_f32_bf16 v200, v118, v181
    v_dot2c_f32_bf16 v201, v118, v69
    v_dot2c_f32_bf16 v202, v119, v181
    v_dot2c_f32_bf16 v203, v119, v69
    s_waitcnt vmcnt(14)
    v_dot2c_f32_bf16 v196, v120, v182
    v_dot2c_f32_bf16 v197, v120, v70
    v_dot2c_f32_bf16 v198, v121, v182
    v_dot2c_f32_bf16 v199, v121, v70
    v_dot2c_f32_bf16 v200, v122, v182
    v_dot2c_f32_bf16 v201, v122, v70
    v_dot2c_f32_bf16 v202, v123, v182
    v_dot2c_f32_bf16 v203, v123, v70
    s_waitcnt vmcnt(13)
    v_dot2c_f32_bf16 v196, v124, v183
    v_dot2c_f32_bf16 v197, v124, v71
    v_dot2c_f32_bf16 v198, v125, v183
    v_dot2c_f32_bf16 v199, v125, v71
    v_dot2c_f32_bf16 v200, v126, v183
    v_dot2c_f32_bf16 v201, v126, v71
    v_dot2c_f32_bf16 v202, v127, v183
    v_dot2c_f32_bf16 v203, v127, v71
    s_waitcnt vmcnt(12)
    v_dot2c_f32_bf16 v196, v128, v184
    v_dot2c_f32_bf16 v197, v128, v72
    v_dot2c_f32_bf16 v198, v129, v184
    v_dot2c_f32_bf16 v199, v129, v72
    v_dot2c_f32_bf16 v200, v130, v184
    v_dot2c_f32_bf16 v201, v130, v72
    v_dot2c_f32_bf16 v202, v131, v184
    v_dot2c_f32_bf16 v203, v131, v72
    s_waitcnt vmcnt(11)
    v_dot2c_f32_bf16 v196, v132, v185
    v_dot2c_f32_bf16 v197, v132, v73
    v_dot2c_f32_bf16 v198, v133, v185
    v_dot2c_f32_bf16 v199, v133, v73
    v_dot2c_f32_bf16 v200, v134, v185
    v_dot2c_f32_bf16 v201, v134, v73
    v_dot2c_f32_bf16 v202, v135, v185
    v_dot2c_f32_bf16 v203, v135, v73
    s_waitcnt vmcnt(10)
    v_dot2c_f32_bf16 v196, v136, v186
    v_dot2c_f32_bf16 v197, v136, v74
    v_dot2c_f32_bf16 v198, v137, v186
    v_dot2c_f32_bf16 v199, v137, v74
    v_dot2c_f32_bf16 v200, v138, v186
    v_dot2c_f32_bf16 v201, v138, v74
    v_dot2c_f32_bf16 v202, v139, v186
    v_dot2c_f32_bf16 v203, v139, v74
    s_waitcnt vmcnt(9)
    v_dot2c_f32_bf16 v196, v140, v187
    v_dot2c_f32_bf16 v197, v140, v75
    v_dot2c_f32_bf16 v198, v141, v187
    v_dot2c_f32_bf16 v199, v141, v75
    v_dot2c_f32_bf16 v200, v142, v187
    v_dot2c_f32_bf16 v201, v142, v75
    v_dot2c_f32_bf16 v202, v143, v187
    v_dot2c_f32_bf16 v203, v143, v75
    s_waitcnt vmcnt(8)
    v_dot2c_f32_bf16 v196, v144, v188
    v_dot2c_f32_bf16 v197, v144, v76
    v_dot2c_f32_bf16 v198, v145, v188
    v_dot2c_f32_bf16 v199, v145, v76
    v_dot2c_f32_bf16 v200, v146, v188
    v_dot2c_f32_bf16 v201, v146, v76
    v_dot2c_f32_bf16 v202, v147, v188
    v_dot2c_f32_bf16 v203, v147, v76
    s_waitcnt vmcnt(7)
    v_dot2c_f32_bf16 v196, v148, v189
    v_dot2c_f32_bf16 v197, v148, v77
    v_dot2c_f32_bf16 v198, v149, v189
    v_dot2c_f32_bf16 v199, v149, v77
    v_dot2c_f32_bf16 v200, v150, v189
    v_dot2c_f32_bf16 v201, v150, v77
    v_dot2c_f32_bf16 v202, v151, v189
    v_dot2c_f32_bf16 v203, v151, v77
    s_waitcnt vmcnt(6)
    v_dot2c_f32_bf16 v196, v152, v190
    v_dot2c_f32_bf16 v197, v152, v78
    v_dot2c_f32_bf16 v198, v153, v190
    v_dot2c_f32_bf16 v199, v153, v78
    v_dot2c_f32_bf16 v200, v154, v190
    v_dot2c_f32_bf16 v201, v154, v78
    v_dot2c_f32_bf16 v202, v155, v190
    v_dot2c_f32_bf16 v203, v155, v78
    s_waitcnt vmcnt(5)
    v_dot2c_f32_bf16 v196, v156, v191
    v_dot2c_f32_bf16 v197, v156, v79
    v_dot2c_f32_bf16 v198, v157, v191
    v_dot2c_f32_bf16 v199, v157, v79
    v_dot2c_f32_bf16 v200, v158, v191
    v_dot2c_f32_bf16 v201, v158, v79
    v_dot2c_f32_bf16 v202, v159, v191
    v_dot2c_f32_bf16 v203, v159, v79
    s_waitcnt vmcnt(4)
    v_dot2c_f32_bf16 v196, v160, v192
    v_dot2c_f32_bf16 v197, v160, v80
    v_dot2c_f32_bf16 v198, v161, v192
    v_dot2c_f32_bf16 v199, v161, v80
    v_dot2c_f32_bf16 v200, v162, v192
    v_dot2c_f32_bf16 v201, v162, v80
    v_dot2c_f32_bf16 v202, v163, v192
    v_dot2c_f32_bf16 v203, v163, v80
    s_waitcnt vmcnt(3)
    v_dot2c_f32_bf16 v196, v164, v193
    v_dot2c_f32_bf16 v197, v164, v81
    v_dot2c_f32_bf16 v198, v165, v193
    v_dot2c_f32_bf16 v199, v165, v81
    v_dot2c_f32_bf16 v200, v166, v193
    v_dot2c_f32_bf16 v201, v166, v81
    v_dot2c_f32_bf16 v202, v167, v193
    v_dot2c_f32_bf16 v203, v167, v81
    s_waitcnt vmcnt(2)
    v_dot2c_f32_bf16 v196, v168, v194
    v_dot2c_f32_bf16 v197, v168, v82
    v_dot2c_f32_bf16 v198, v169, v194
    v_dot2c_f32_bf16 v199, v169, v82
    v_dot2c_f32_bf16 v200, v170, v194
    v_dot2c_f32_bf16 v201, v170, v82
    v_dot2c_f32_bf16 v202, v171, v194
    v_dot2c_f32_bf16 v203, v171, v82
    s_waitcnt vmcnt(1)
    v_dot2c_f32_bf16 v196, v172, v195
    v_dot2c_f32_bf16 v197, v172, v83
    v_dot2c_f32_bf16 v198, v173, v195
    v_dot2c_f32_bf16 v199, v173, v83
    v_dot2c_f32_bf16 v200, v174, v195
    v_dot2c_f32_bf16 v201, v174, v83
    v_dot2c_f32_bf16 v202, v175, v195
    v_dot2c_f32_bf16 v203, v175, v83
    s_nop 2
    v_permlane32_swap_b32 v196, v200
    v_permlane32_swap_b32 v197, v201
    v_permlane32_swap_b32 v198, v202
    v_permlane32_swap_b32 v199, v203
    v_add_f32 v196, v196, v200
    v_add_f32 v197, v197, v201
    v_add_f32 v198, v198, v202
    v_add_f32 v199, v199, v203
    s_nop 0
    v_permlane16_swap_b32 v196, v198
    v_permlane16_swap_b32 v197, v199
    v_add_f32 v196, v196, v198
    v_add_f32 v197, v197, v199
    s_nop 0
    v_add_f32_dpp v196, v196, v196 row_ror:8 row_mask:0xf bank_mask:0xf
    v_add_f32_dpp v197, v197, v197 row_ror:8 row_mask:0xf bank_mask:0xf
    v_cndmask_b32 v196, v196, v197, vcc
    v_mov_b32 v197, s50
    global_store_dwordx2 v246, v[196:197], s[48:49] sc1
    s_branch L_W3_P1D
L_W3_NOMOD:
    s_waitcnt vmcnt(0)
    s_lshl_b32 s88, s2, 6
    s_add_u32 s88, s88, 4096
    v_lshl_add_u32 v48, v1, 2, s88
    v_mov_b32 v49, s50
    s_mov_b64 exec, 0xffff
    global_store_dword v48, v49, s[48:49] sc1
    s_mov_b64 exec, -1
    v_mov_b32 v48, 126020
    v_mov_b32 v49, 1
    ds_write_b32 v48, v49
L_W3_P1D:
    s_cmp_ge_u32 s2, 214
    s_cbranch_scc1 L_SIDE_R
    s_sleep 3
    s_mov_b32 s90, 0
L_poll_9:
    global_load_dword v40, v210, s[48:49] offset:0 sc1
    global_load_dword v41, v211, s[48:49] offset:0 sc1
    global_load_dword v42, v212, s[48:49] offset:0 sc1
    global_load_dword v43, v213, s[48:49] offset:0 sc1
    s_add_u32 s90, s90, 1
    s_waitcnt vmcnt(0)
    v_cmp_ne_u32 vcc, s50, v40
    v_cmp_ne_u32 s[88:89], s50, v41
    s_nop 0
    s_or_b64 vcc, vcc, s[88:89]
    v_cmp_ne_u32 s[88:89], s50, v42
    s_nop 0
    s_or_b64 vcc, vcc, s[88:89]
    v_cmp_ne_u32 s[88:89], s50, v43
    s_nop 0
    s_or_b64 vcc, vcc, s[88:89]
    s_nop 0
    s_cbranch_vccz L_polld_10
    s_cmp_gt_u32 s90, 65536
    s_cbranch_scc1 L_polld_10
    s_sleep 2
    s_branch L_poll_9
L_polld_10:
    global_load_dwordx2 v[128:129], v207, s[48:49] sc1
    s_add_u32 s6, s48, 1048576
    s_addc_u32 s7, s49, 0
    s_mov_b32 m0, 113664
    s_nop 0
    global_load_lds_dwordx4 v247, s[6:7] sc1
    s_mov_b32 m0, 114688
    s_nop 0
    global_load_lds_dwordx4 v248, s[6:7] sc1
    s_mov_b32 m0, 115712
    s_nop 0
    global_load_lds_dwordx4 v249, s[6:7] sc1
    s_add_u32 s6, s6, 4096
    s_addc_u32 s7, s7, 0
    s_mov_b32 m0, 116736
    s_nop 0
    global_load_lds_dwordx4 v247, s[6:7] sc1
    s_mov_b32 m0, 117760
    s_nop 0
    global_load_lds_dwordx4 v248, s[6:7] sc1
    s_mov_b32 m0, 118784
    s_nop 0
    global_load_lds_dwordx4 v249, s[6:7] sc1
    s_add_u32 s6, s6, 4096
    s_addc_u32 s7, s7, 0
    s_mov_b32 m0, 119808
    s_nop 0
    global_load_lds_dwordx4 v247, s[6:7] sc1
    s_mov_b32 m0, 120832
    s_nop 0
    global_load_lds_dwordx4 v248, s[6:7] sc1
    s_mov_b32 m0, 121856
    s_nop 0
    global_load_lds_dwordx4 v249, s[6:7] sc1
    s_add_u32 s6, s6, 4096
    s_addc_u32 s7, s7, 0
    s_mov_b32 m0, 122880
    s_nop 0
    global_load_lds_dwordx4 v247, s[6:7] sc1
    s_mov_b32 m0, 123904
    s_nop 0
    global_load_lds_dwordx4 v248, s[6:7] sc1
    s_mov_b32 m0, 124928
    s_nop 0
    global_load_lds_dwordx4 v249, s[6:7] sc1
    s_add_u32 s6, s48, 540672
    s_addc_u32 s7, s49, 0
    s_mov_b32 m0, 135168
    s_nop 0
    global_load_lds_dwordx4 v2, s[6:7] offset:0 sc1
    global_load_lds_dwordx4 v2, s[6:7] offset:1024 sc1
    global_load_lds_dwordx4 v2, s[6:7] offset:2048 sc1
    global_load_lds_dwordx4 v2, s[6:7] offset:3072 sc1
    s_add_u32 s6, s6, 4096
    s_addc_u32 s7, s7, 0
    s_mov_b32 m0, 139264
    s_nop 0
    global_load_lds_dwordx4 v2, s[6:7] offset:0 sc1
    global_load_lds_dwordx4 v2, s[6:7] offset:1024 sc1
    global_load_lds_dwordx4 v2, s[6:7] offset:2048 sc1
    global_load_lds_dwordx4 v2, s[6:7] offset:3072 sc1
    s_add_u32 s6, s6, 4096
    s_addc_u32 s7, s7, 0
    s_mov_b32 m0, 143360
    s_nop 0
    global_load_lds_dwordx4 v2, s[6:7] offset:0 sc1
    global_load_lds_dwordx4 v2, s[6:7] offset:1024 sc1
    global_load_lds_dwordx4 v2, s[6:7] offset:2048 sc1
    global_load_lds_dwordx4 v2, s[6:7] offset:3072 sc1
    s_add_u32 s6, s6, 4096
    s_addc_u32 s7, s7, 0
    s_mov_b32 m0, 147456
    s_nop 0
    global_load_lds_dwordx4 v2, s[6:7] offset:0 sc1
    global_load_lds_dwordx4 v2, s[6:7] offset:1024 sc1
    global_load_lds_dwordx4 v2, s[6:7] offset:2048 sc1
    global_load_lds_dwordx4 v2, s[6:7] offset:3072 sc1
    v_mov_b32 v46, 126024
    v_mov_b32 v47, 1
    ds_write_b32 v46, v47
    global_load_dwordx4 a[0:3], v2, s[64:65] offset:-4096 sc1
    global_load_dwordx4 a[4:7], v2, s[64:65] offset:-3072 sc1
    global_load_dwordx4 a[8:11], v2, s[64:65] offset:-2048 sc1
    global_load_dwordx4 a[12:15], v2, s[64:65] offset:-1024 sc1
    s_waitcnt vmcnt(32)
    v_cmp_ne_u32 vcc, s50, v129
    s_nop 0
    s_cbranch_vccnz L_cfr_13
L_cfd_12:
    v_add_f32_dpp v128, v128, v128 quad_perm:[1,0,3,2] row_mask:0xf bank_mask:0xf
    v_cmp_lt_u32 vcc, 31, v1
    s_nop 0
    v_add_f32_dpp v128, v128, v128 quad_perm:[2,3,0,1] row_mask:0xf bank_mask:0xf
    v_cvt_pk_bf16_f32 v128, v128, v128
    v_lshlrev_b32 v128, 16, v128
    v_add_f32 v129, 1.0, v128
    v_cvt_pk_bf16_f32 v129, v129, v129
    v_lshlrev_b32 v129, 16, v129
    v_cndmask_b32 v128, v128, v129, vcc
    ds_write_b32 v214, v128
    s_waitcnt vmcnt(4)
    v_mov_b32 v28, 126080
    v_xor_b32 v29, 16, v243
    v_xor_b32 v30, 32, v243
    v_xor_b32_e64 v31, 48, v243
    s_waitcnt lgkmcnt(0)
    s_barrier
    ds_read_b128 v[32:35], v242 offset:12288
    ds_read_b128 v[44:47], v243
    ds_read_b128 v[52:55], v30
    ds_read_b128 v[60:63], v28
    ds_read_b128 v[64:67], v28 offset:32
    ds_read_b128 v[48:51], v29
    ds_read_b128 v[56:59], v31
    ds_read_b128 v[36:39], v242 offset:12304
    ds_read_b128 v[40:43], v242 offset:12320
    s_waitcnt lgkmcnt(4)
    v_lshlrev_b32 v68, 16, v32
    v_and_b32 v69, 0xffff0000, v32
    v_pk_fma_f32 v[68:69], v[68:69], v[44:45], v[52:53]
    v_pk_fma_f32 v[68:69], v[68:69], v[64:65], v[60:61] op_sel:[0,0,0] op_sel_hi:[1,0,0]
    v_cvt_pk_bf16_f32 v32, v68, v69
    v_lshlrev_b32 v70, 16, v33
    v_and_b32 v71, 0xffff0000, v33
    v_pk_fma_f32 v[70:71], v[70:71], v[46:47], v[54:55]
    v_pk_fma_f32 v[70:71], v[70:71], v[64:65], v[60:61] op_sel:[0,0,0] op_sel_hi:[1,0,0]
    v_cvt_pk_bf16_f32 v33, v70, v71
    s_waitcnt lgkmcnt(2)
    v_lshlrev_b32 v68, 16, v34
    v_and_b32 v69, 0xffff0000, v34
    v_pk_fma_f32 v[68:69], v[68:69], v[48:49], v[56:57]
    v_pk_fma_f32 v[68:69], v[68:69], v[64:65], v[60:61] op_sel:[0,0,0] op_sel_hi:[1,0,0]
    v_cvt_pk_bf16_f32 v34, v68, v69
    v_lshlrev_b32 v70, 16, v35
    v_and_b32 v71, 0xffff0000, v35
    v_pk_fma_f32 v[70:71], v[70:71], v[50:51], v[58:59]
    v_pk_fma_f32 v[70:71], v[70:71], v[64:65], v[60:61] op_sel:[0,0,0] op_sel_hi:[1,0,0]
    v_cvt_pk_bf16_f32 v35, v70, v71
    s_waitcnt lgkmcnt(1)
    v_lshlrev_b32 v68, 16, v36
    v_and_b32 v69, 0xffff0000, v36
    v_pk_fma_f32 v[68:69], v[68:69], v[44:45], v[52:53]
    v_pk_fma_f32 v[68:69], v[68:69], v[64:65], v[60:61] op_sel:[0,1,1] op_sel_hi:[1,1,1]
    v_cvt_pk_bf16_f32 v36, v68, v69
    v_lshlrev_b32 v70, 16, v37
    v_and_b32 v71, 0xffff0000, v37
    v_pk_fma_f32 v[70:71], v[70:71], v[46:47], v[54:55]
    v_pk_fma_f32 v[70:71], v[70:71], v[64:65], v[60:61] op_sel:[0,1,1] op_sel_hi:[1,1,1]
    v_cvt_pk_bf16_f32 v37, v70, v71
    v_lshlrev_b32 v68, 16, v38
    v_and_b32 v69, 0xffff0000, v38
    v_pk_fma_f32 v[68:69], v[68:69], v[48:49], v[56:57]
    v_pk_fma_f32 v[68:69], v[68:69], v[64:65], v[60:61] op_sel:[0,1,1] op_sel_hi:[1,1,1]
    v_cvt_pk_bf16_f32 v38, v68, v69
    v_lshlrev_b32 v70, 16, v39
    v_and_b32 v71, 0xffff0000, v39
    v_pk_fma_f32 v[70:71], v[70:71], v[50:51], v[58:59]
    v_pk_fma_f32 v[70:71], v[70:71], v[64:65], v[60:61] op_sel:[0,1,1] op_sel_hi:[1,1,1]
    v_cvt_pk_bf16_f32 v39, v70, v71
    s_waitcnt lgkmcnt(0)
    v_lshlrev_b32 v68, 16, v40
    v_and_b32 v69, 0xffff0000, v40
    global_load_dwordx4 a[16:19], v2, s[64:65] offset:0 sc1
    v_pk_fma_f32 v[68:69], v[68:69], v[44:45], v[52:53]
    v_pk_fma_f32 v[68:69], v[68:69], v[66:67], v[62:63] op_sel:[0,0,0] op_sel_hi:[1,0,0]
    v_cvt_pk_bf16_f32 v40, v68, v69
    v_lshlrev_b32 v70, 16, v41
    v_and_b32 v71, 0xffff0000, v41
    v_pk_fma_f32 v[70:71], v[70:71], v[46:47], v[54:55]
    v_pk_fma_f32 v[70:71], v[70:71], v[66:67], v[62:63] op_sel:[0,0,0] op_sel_hi:[1,0,0]
    v_cvt_pk_bf16_f32 v41, v70, v71
    v_lshlrev_b32 v68, 16, v42
    v_and_b32 v69, 0xffff0000, v42
    v_pk_fma_f32 v[68:69], v[68:69], v[48:49], v[56:57]
    v_pk_fma_f32 v[68:69], v[68:69], v[66:67], v[62:63] op_sel:[0,0,0] op_sel_hi:[1,0,0]
    v_cvt_pk_bf16_f32 v42, v68, v69
    v_lshlrev_b32 v70, 16, v43
    v_and_b32 v71, 0xffff0000, v43
    global_load_dwordx4 a[20:23], v2, s[64:65] offset:1024 sc1
    v_pk_fma_f32 v[70:71], v[70:71], v[50:51], v[58:59]
    v_pk_fma_f32 v[70:71], v[70:71], v[66:67], v[62:63] op_sel:[0,0,0] op_sel_hi:[1,0,0]
    v_cvt_pk_bf16_f32 v43, v70, v71
    ds_write_b128 v242, v[32:35] offset:0
    ds_write_b128 v242, v[36:39] offset:16
    ds_write_b128 v242, v[40:43] offset:32
    global_load_dwordx4 a[24:27], v2, s[64:65] offset:2048 sc1
    s_waitcnt lgkmcnt(0)
    s_barrier
    global_load_ushort v132, v209, s[32:33]
    global_load_dwordx2 v[130:131], v208, s[48:49] sc1
    ds_read_b128 v[32:35], v234 offset:4032
    ds_read_b128 v[36:39], v237 offset:1344
    ds_read_b128 v[40:43], v235 offset:4032
    ds_read_b128 v[44:47], v237 offset:1360
    ds_read_b128 v[48:51], v236 offset:4032
    ds_read_b128 v[52:55], v237 offset:1376
    ds_read_b128 v[56:59], v234 offset:3968
    ds_read_b128 v[60:63], v237 offset:1152
    ds_read_b128 v[64:67], v235 offset:3968
    ds_read_b128 v[68:71], v237 offset:1168
    ds_read_b128 v[72:75], v236 offset:3968
    ds_read_b128 v[76:79], v237 offset:1184
    ds_read_b128 v[80:83], v234 offset:3904
    ds_read_b128 v[84:87], v237 offset:960
    s_waitcnt lgkmcnt(9)
    v_mfma_f32_16x16x32_bf16 v[16:19], v[32:35], v[36:39], 0
    s_nop 0
    global_load_dwordx4 a[28:31], v2, s[64:65] offset:3072 sc1
    ds_read_b128 v[88:91], v235 offset:3904
    ds_read_b128 v[92:95], v237 offset:976
    v_mfma_f32_16x16x32_bf16 v[20:23], v[40:43], v[44:47], 0
    ds_read_b128 v[96:99], v236 offset:3904
    ds_read_b128 v[100:103], v237 offset:992
    s_waitcnt lgkmcnt(9)
    v_mfma_f32_16x16x32_bf16 v[24:27], v[48:51], v[52:55], 0
    ds_read_b128 v[104:107], v234 offset:3840
    ds_read_b128 v[108:111], v237 offset:768
    v_mfma_f32_16x16x32_bf16 v[16:19], v[56:59], v[60:63], v[16:19]
    s_add_u32 s64, s64, 8192
    s_addc_u32 s65, s65, 0
    global_load_dwordx4 a[32:35], v2, s[64:65] offset:-4096 sc1
    ds_read_b128 v[32:35], v235 offset:3840
    ds_read_b128 v[36:39], v237 offset:784
    s_waitcnt lgkmcnt(9)
    v_mfma_f32_16x16x32_bf16 v[20:23], v[64:67], v[68:71], v[20:23]
    ds_read_b128 v[40:43], v236 offset:3840
    ds_read_b128 v[44:47], v237 offset:800
    v_mfma_f32_16x16x32_bf16 v[24:27], v[72:75], v[76:79], v[24:27]
    ds_read_b128 v[48:51], v234 offset:3776
    ds_read_b128 v[52:55], v237 offset:576
    s_waitcnt lgkmcnt(9)
    v_mfma_f32_16x16x32_bf16 v[16:19], v[80:83], v[84:87], v[16:19]
    ds_read_b128 v[56:59], v235 offset:3776
    global_load_dwordx4 a[36:39], v2, s[64:65] offset:-3072 sc1
    ds_read_b128 v[60:63], v237 offset:592
    v_mfma_f32_16x16x32_bf16 v[20:23], v[88:91], v[92:95], v[20:23]
    ds_read_b128 v[64:67], v236 offset:3776
    ds_read_b128 v[68:71], v237 offset:608
    s_waitcnt lgkmcnt(9)
    v_mfma_f32_16x16x32_bf16 v[24:27], v[96:99], v[100:103], v[24:27]
    ds_read_b128 v[72:75], v234 offset:3712
    ds_read_b128 v[76:79], v237 offset:384
    v_mfma_f32_16x16x32_bf16 v[16:19], v[104:107], v[108:111], v[16:19]
    ds_read_b128 v[80:83], v235 offset:3712
    ds_read_b128 v[84:87], v237 offset:400
    s_waitcnt lgkmcnt(9)
    v_mfma_f32_16x16x32_bf16 v[20:23], v[32:35], v[36:39], v[20:23]
    global_load_dwordx4 a[40:43], v2, s[64:65] offset:-2048 sc1
    ds_read_b128 v[88:91], v236 offset:3712
    ds_read_b128 v[92:95], v237 offset:416
    v_mfma_f32_16x16x32_bf16 v[24:27], v[40:43], v[44:47], v[24:27]
    ds_read_b128 v[96:99], v234 offset:3648
    ds_read_b128 v[100:103], v237 offset:192
    s_waitcnt lgkmcnt(9)
    v_mfma_f32_16x16x32_bf16 v[16:19], v[48:51], v[52:55], v[16:19]
    s_nop 0
    ds_read_b128 v[104:107], v235 offset:3648
    ds_read_b128 v[108:111], v237 offset:208
    v_mfma_f32_16x16x32_bf16 v[20:23], v[56:59], v[60:63], v[20:23]
    global_load_dwordx4 a[44:47], v2, s[64:65] offset:-1024 sc1
    ds_read_b128 v[32:35], v236 offset:3648
    ds_read_b128 v[36:39], v237 offset:224
    s_waitcnt lgkmcnt(9)
    v_mfma_f32_16x16x32_bf16 v[24:27], v[64:67], v[68:71], v[24:27]
    ds_read_b128 v[40:43], v234 offset:3584
    ds_read_b128 v[44:47], v237 offset:0
    v_mfma_f32_16x16x32_bf16 v[16:19], v[72:75], v[76:79], v[16:19]
    ds_read_b128 v[48:51], v235 offset:3584
    ds_read_b128 v[52:55], v237 offset:16
    s_waitcnt lgkmcnt(9)
    v_mfma_f32_16x16x32_bf16 v[20:23], v[80:83], v[84:87], v[20:23]
    ds_read_b128 v[56:59], v236 offset:3584
    global_load_dwordx4 a[48:51], v2, s[64:65] offset:0 sc1
    ds_read_b128 v[60:63], v237 offset:32
    v_mfma_f32_16x16x32_bf16 v[24:27], v[88:91], v[92:95], v[24:27]
    s_waitcnt lgkmcnt(7)
    v_mfma_f32_16x16x32_bf16 v[16:19], v[96:99], v[100:103], v[16:19]
    v_mfma_f32_16x16x32_bf16 v[20:23], v[104:107], v[108:111], v[20:23]
    s_waitcnt lgkmcnt(3)
    v_mfma_f32_16x16x32_bf16 v[24:27], v[32:35], v[36:39], v[24:27]
    global_load_dwordx4 a[52:55], v2, s[64:65] offset:1024 sc1
    v_mfma_f32_16x16x32_bf16 v[16:19], v[40:43], v[44:47], v[16:19]
    s_waitcnt lgkmcnt(0)
    v_mfma_f32_16x16x32_bf16 v[20:23], v[48:51], v[52:55], v[20:23]
    v_mfma_f32_16x16x32_bf16 v[24:27], v[56:59], v[60:63], v[24:27]
    s_waitcnt vmcnt(7)
    v_cmp_ne_u32 vcc, s50, v131
    s_nop 0
    s_cbranch_vccnz L_cfr_16
L_cfd_15:
    v_add_f32_dpp v130, v130, v130 quad_perm:[1,0,3,2] row_mask:0xf bank_mask:0xf
    global_load_dwordx4 a[56:59], v2, s[64:65] offset:2048 sc1
    v_cmp_lt_u32 vcc, 31, v1
    v_add_f32_dpp v130, v130, v130 quad_perm:[2,3,0,1] row_mask:0xf bank_mask:0xf
    v_cvt_pk_bf16_f32 v130, v130, v130
    v_lshlrev_b32 v130, 16, v130
    v_add_f32 v131, 1.0, v130
    v_cvt_pk_bf16_f32 v131, v131, v131
    v_lshlrev_b32 v131, 16, v131
    v_cndmask_b32 v130, v130, v131, vcc
    v_lshlrev_b32 v132, 16, v132
    v_mul_f32_e64 v132, v132, v130
    ds_write_b32 v214, v130 offset:64
    s_mov_b32 exec_hi, 0
    ds_write_b32 v214, v132 offset:128
    s_mov_b64 exec, -1
    s_waitcnt lgkmcnt(0)
    global_load_dwordx4 a[60:63], v2, s[64:65] offset:3072 sc1
    s_add_u32 s64, s64, 8192
    s_addc_u32 s65, s65, 0
    global_load_dwordx4 a[64:67], v2, s[64:65] offset:-4096 sc1
    global_load_dwordx4 a[68:71], v2, s[64:65] offset:-3072 sc1
    global_load_dwordx4 a[72:75], v2, s[64:65] offset:-2048 sc1
    s_barrier
    ds_read2_b32 v[112:113], v251 offset0:16 offset1:32
    ds_read_b32 v114, v251 offset:96
    ds_read2_b32 v[116:117], v251 offset0:17 offset1:33
    ds_read_b32 v118, v251 offset:100
    ds_read2_b32 v[120:121], v251 offset0:18 offset1:34
    ds_read_b32 v122, v251 offset:104
    ds_read_b64 v[140:141], v238 offset:0
    ds_read_b64 v[142:143], v238 offset:12288
    ds_read_b64 v[144:145], v238 offset:16
    ds_read_b64 v[146:147], v238 offset:12304
    ds_read_b64 v[148:149], v238 offset:32
    ds_read_b64 v[150:151], v238 offset:12320
    s_waitcnt lgkmcnt(4)
    v_lshlrev_b32 v48, 16, v140
    v_and_b32 v49, 0xffff0000, v140
    v_lshlrev_b32 v50, 16, v142
    v_and_b32 v51, 0xffff0000, v142
    v_lshlrev_b32 v52, 16, v141
    v_and_b32 v53, 0xffff0000, v141
    v_lshlrev_b32_e64 v54, 16, v143
    v_and_b32 v55, 0xffff0000, v143
    v_pk_fma_f32 v[48:49], v[48:49], v[112:113], v[50:51] op_sel:[0,1,0] op_sel_hi:[1,1,1]
    v_pk_fma_f32 v[52:53], v[52:53], v[112:113], v[54:55] op_sel:[0,1,0] op_sel_hi:[1,1,1]
    v_pk_fma_f32 v[48:49], v[16:17], v[112:113], v[48:49] op_sel_hi:[1,0,1]
    v_pk_fma_f32 v[52:53], v[18:19], v[112:113], v[52:53] op_sel_hi:[1,0,1]
    v_pk_mul_f32 v[50:51], v[48:49], v[114:115] op_sel_hi:[1,0]
    v_pk_mul_f32 v[54:55], v[52:53], v[114:115] op_sel_hi:[1,0]
    v_cvt_pk_bf16_f32 v56, v48, v49
    v_cvt_pk_bf16_f32 v57, v52, v53
    v_cvt_pk_bf16_f32 v58, v50, v51
    v_cvt_pk_bf16_f32 v59, v54, v55
    s_add_u32 s6, s48, 0
    s_addc_u32 s7, s49, 0
    v_permlane16_swap_b32 v56, v58
    v_permlane16_swap_b32 v57, v59
    global_store_dwordx4 v239, v[56:59], s[6:7] sc1
    s_waitcnt lgkmcnt(2)
    v_lshlrev_b32 v64, 16, v144
    v_and_b32 v65, 0xffff0000, v144
    v_lshlrev_b32 v66, 16, v146
    v_and_b32 v67, 0xffff0000, v146
    v_lshlrev_b32 v68, 16, v145
    v_and_b32 v69, 0xffff0000, v145
    v_lshlrev_b32_e64 v70, 16, v147
    v_and_b32 v71, 0xffff0000, v147
    v_pk_fma_f32 v[64:65], v[64:65], v[116:117], v[66:67] op_sel:[0,1,0] op_sel_hi:[1,1,1]
    v_pk_fma_f32 v[68:69], v[68:69], v[116:117], v[70:71] op_sel:[0,1,0] op_sel_hi:[1,1,1]
    v_pk_fma_f32 v[64:65], v[20:21], v[116:117], v[64:65] op_sel_hi:[1,0,1]
    v_pk_fma_f32 v[68:69], v[22:23], v[116:117], v[68:69] op_sel_hi:[1,0,1]
    v_pk_mul_f32 v[66:67], v[64:65], v[118:119] op_sel_hi:[1,0]
    v_pk_mul_f32 v[70:71], v[68:69], v[118:119] op_sel_hi:[1,0]
    v_cvt_pk_bf16_f32 v72, v64, v65
    v_cvt_pk_bf16_f32 v73, v68, v69
    v_cvt_pk_bf16_f32 v74, v66, v67
    v_cvt_pk_bf16_f32 v75, v70, v71
    s_add_u32 s6, s48, 0
    s_addc_u32 s7, s49, 0
    v_permlane16_swap_b32 v72, v74
    v_permlane16_swap_b32 v73, v75
    global_store_dwordx4 v240, v[72:75], s[6:7] sc1
    s_waitcnt lgkmcnt(0)
    v_lshlrev_b32 v80, 16, v148
    v_and_b32 v81, 0xffff0000, v148
    v_lshlrev_b32 v82, 16, v150
    v_and_b32 v83, 0xffff0000, v150
    v_lshlrev_b32 v84, 16, v149
    v_and_b32 v85, 0xffff0000, v149
    v_lshlrev_b32_e64 v86, 16, v151
    v_and_b32 v87, 0xffff0000, v151
    v_pk_fma_f32 v[80:81], v[80:81], v[120:121], v[82:83] op_sel:[0,1,0] op_sel_hi:[1,1,1]
    v_pk_fma_f32 v[84:85], v[84:85], v[120:121], v[86:87] op_sel:[0,1,0] op_sel_hi:[1,1,1]
    v_pk_fma_f32 v[80:81], v[24:25], v[120:121], v[80:81] op_sel_hi:[1,0,1]
    v_pk_fma_f32 v[84:85], v[26:27], v[120:121], v[84:85] op_sel_hi:[1,0,1]
    v_pk_mul_f32 v[82:83], v[80:81], v[122:123] op_sel_hi:[1,0]
    v_pk_mul_f32 v[86:87], v[84:85], v[122:123] op_sel_hi:[1,0]
    v_cvt_pk_bf16_f32 v88, v80, v81
    v_cvt_pk_bf16_f32 v89, v84, v85
    v_cvt_pk_bf16_f32 v90, v82, v83
    v_cvt_pk_bf16_f32 v91, v86, v87
    s_add_u32 s6, s48, 0
    s_addc_u32 s7, s49, 0
    v_permlane16_swap_b32 v88, v90
    global_load_dwordx4 a[76:79], v2, s[64:65] offset:-1024 sc1
    v_permlane16_swap_b32 v89, v91
    global_store_dwordx4 v241, v[88:91], s[6:7] sc1
    ds_read_b128 v[32:35], v234 offset:4032
    ds_read_b128 v[36:39], v237 offset:7488
    ds_read_b128 v[40:43], v235 offset:4032
    ds_read_b128 v[44:47], v237 offset:7504
    ds_read_b128 v[48:51], v236 offset:4032
    ds_read_b128 v[52:55], v237 offset:7520
    ds_read_b128 v[56:59], v234 offset:3520
    ds_read_b128 v[60:63], v237 offset:5952
    ds_read_b128 v[64:67], v235 offset:3520
    ds_read_b128 v[68:71], v237 offset:5968
    ds_read_b128 v[72:75], v236 offset:3520
    ds_read_b128 v[76:79], v237 offset:5984
    ds_read_b128 v[80:83], v234 offset:3008
    ds_read_b128 v[84:87], v237 offset:4416
    s_waitcnt lgkmcnt(9)
    v_mfma_f32_16x16x32_bf16 v[16:19], v[32:35], v[36:39], 0
    ds_read_b128 v[88:91], v235 offset:3008
    ds_read_b128 v[92:95], v237 offset:4432
    v_and_b32 v29, 7, v1
    v_lshlrev_b32 v29, 5, v29
    v_add_u32 v29, 233472, v29
    v_mfma_f32_16x16x32_bf16 v[20:23], v[40:43], v[44:47], 0
    ds_read_b128 v[96:99], v236 offset:3008
    ds_read_b128 v[100:103], v237 offset:4448
    s_waitcnt lgkmcnt(9)
    v_mfma_f32_16x16x32_bf16 v[24:27], v[48:51], v[52:55], 0
    global_load_dwordx4 a[80:83], v2, s[64:65] offset:0 sc1
    ds_read_b128 v[104:107], v234 offset:2496
    ds_read_b128 v[108:111], v237 offset:2880
    v_min_u32 v13, 213, v0
    v_mfma_f32_16x16x32_bf16 v[16:19], v[56:59], v[60:63], v[16:19]
    ds_read_b128 v[32:35], v235 offset:2496
    ds_read_b128 v[36:39], v237 offset:2896
    v_lshlrev_b32 v13, 5, v13
    s_waitcnt lgkmcnt(9)
    v_mfma_f32_16x16x32_bf16 v[20:23], v[64:67], v[68:71], v[20:23]
    ds_read_b128 v[40:43], v236 offset:2496
    ds_read_b128 v[44:47], v237 offset:2912
    global_load_dwordx4 a[84:87], v2, s[64:65] offset:1024 sc1
    v_add_u32 v13, 102400, v13
    v_mfma_f32_16x16x32_bf16 v[24:27], v[72:75], v[76:79], v[24:27]
    ds_read_b128 v[48:51], v234 offset:1984
    ds_read_b128 v[52:55], v237 offset:1344
    s_waitcnt lgkmcnt(9)
    v_mfma_f32_16x16x32_bf16 v[16:19], v[80:83], v[84:87], v[16:19]
    ds_read_b128 v[56:59], v235 offset:1984
    ds_read_b128 v[60:63], v237 offset:1360
    v_lshrrev_b32 v12, 2, v1
    v_mfma_f32_16x16x32_bf16 v[20:23], v[88:91], v[92:95], v[20:23]
    ds_read_b128 v[64:67], v236 offset:1984
    ds_read_b128 v[68:71], v237 offset:1376
    global_load_dwordx4 a[88:91], v2, s[64:65] offset:2048 sc1
    v_lshlrev_b32 v12, 6, v12
    s_waitcnt lgkmcnt(9)
    v_mfma_f32_16x16x32_bf16 v[24:27], v[96:99], v[100:103], v[24:27]
    ds_read_b128 v[72:75], v234 offset:3968
    ds_read_b128 v[76:79], v237 offset:7296
    v_mfma_f32_16x16x32_bf16 v[16:19], v[104:107], v[108:111], v[16:19]
    ds_read_b128 v[80:83], v235 offset:3968
    ds_read_b128 v[84:87], v237 offset:7312
    v_bfe_u32 v4, v1, 4, 1
    s_waitcnt lgkmcnt(9)
    v_mfma_f32_16x16x32_bf16 v[20:23], v[32:35], v[36:39], v[20:23]
    s_nop 0
    ds_read_b128 v[88:91], v236 offset:3968
    global_load_dwordx4 a[92:95], v2, s[64:65] offset:3072 sc1
    ds_read_b128 v[92:95], v237 offset:7328
    v_lshl_add_u32 v12, v4, 5, v12
    v_mfma_f32_16x16x32_bf16 v[24:27], v[40:43], v[44:47], v[24:27]
    ds_read_b128 v[96:99], v234 offset:3456
    ds_read_b128 v[100:103], v237 offset:5760
    v_and_b32 v4, 3, v1
    s_waitcnt lgkmcnt(9)
    v_mfma_f32_16x16x32_bf16 v[16:19], v[48:51], v[52:55], v[16:19]
    ds_read_b128 v[104:107], v235 offset:3456
    ds_read_b128 v[108:111], v237 offset:5776
    v_mfma_f32_16x16x32_bf16 v[20:23], v[56:59], v[60:63], v[20:23]
    ds_read_b128 v[32:35], v236 offset:3456
    s_add_u32 s64, s64, 8192
    s_addc_u32 s65, s65, 0
    global_load_dwordx4 a[96:99], v2, s[64:65] offset:-4096 sc1
    ds_read_b128 v[36:39], v237 offset:5792
    v_lshl_add_u32 v12, v4, 3, v12
    s_waitcnt lgkmcnt(9)
    v_mfma_f32_16x16x32_bf16 v[24:27], v[64:67], v[68:71], v[24:27]
    ds_read_b128 v[40:43], v234 offset:2944
    ds_read_b128 v[44:47], v237 offset:4224
    v_add_u32 v8, 45056, v12
    v_mfma_f32_16x16x32_bf16 v[16:19], v[72:75], v[76:79], v[16:19]
    ds_read_b128 v[48:51], v235 offset:2944
    ds_read_b128 v[52:55], v237 offset:4240
    s_waitcnt lgkmcnt(9)
    v_mfma_f32_16x16x32_bf16 v[20:23], v[80:83], v[84:87], v[20:23]
    global_load_dwordx4 a[100:103], v2, s[64:65] offset:-3072 sc1
    ds_read_b128 v[56:59], v236 offset:2944
    ds_read_b128 v[60:63], v237 offset:4256
    v_xor_b32 v9, 32, v8
    v_mfma_f32_16x16x32_bf16 v[24:27], v[88:91], v[92:95], v[24:27]
    ds_read_b128 v[64:67], v234 offset:2432
    ds_read_b128 v[68:71], v237 offset:2688
    s_and_b32 s6, s3, 1
    s_lshl_b32 s6, s6, 5
    v_xor_b32 v10, s6, v12
    s_waitcnt lgkmcnt(9)
    v_mfma_f32_16x16x32_bf16 v[16:19], v[96:99], v[100:103], v[16:19]
    ds_read_b128 v[72:75], v235 offset:2432
    ds_read_b128 v[76:79], v237 offset:2704
    global_load_dwordx4 a[104:107], v2, s[64:65] offset:-2048 sc1
    v_add_u32 v10, 113664, v10
    v_mfma_f32_16x16x32_bf16 v[20:23], v[104:107], v[108:111], v[20:23]
    ds_read_b128 v[80:83], v236 offset:2432
    ds_read_b128 v[84:87], v237 offset:2720
    s_waitcnt lgkmcnt(9)
    v_mfma_f32_16x16x32_bf16 v[24:27], v[32:35], v[36:39], v[24:27]
    ds_read_b128 v[88:91], v234 offset:1920
    ds_read_b128 v[92:95], v237 offset:1152
    v_lshrrev_b32 v4, 4, v1
    v_mfma_f32_16x16x32_bf16 v[16:19], v[40:43], v[44:47], v[16:19]
    ds_read_b128 v[96:99], v235 offset:1920
    ds_read_b128 v[100:103], v237 offset:1168
    global_load_dwordx4 a[108:111], v2, s[64:65] offset:-1024 sc1
    s_lshl_b32 s6, s61, 12
    s_add_u32 s6, s6, 266240
    s_lshl_b32 s7, s3, 10
    s_add_u32 s6, s6, s7
    v_add_u32 v11, s6, v2
    s_waitcnt lgkmcnt(9)
    v_mfma_f32_16x16x32_bf16 v[20:23], v[48:51], v[52:55], v[20:23]
    ds_read_b128 v[104:107], v236 offset:1920
    ds_read_b128 v[108:111], v237 offset:1184
    v_mfma_f32_16x16x32_bf16 v[24:27], v[56:59], v[60:63], v[24:27]
    ds_read_b128 v[32:35], v234 offset:3904
    ds_read_b128 v[36:39], v237 offset:7104
    v_and_b32 v5, 31, v1
    global_load_dwordx4 a[112:115], v2, s[64:65] offset:0 sc1
    s_waitcnt lgkmcnt(9)
    v_mfma_f32_16x16x32_bf16 v[16:19], v[64:67], v[68:71], v[16:19]
    ds_read_b128 v[40:43], v235 offset:3904
    ds_read_b128 v[44:47], v237 offset:7120
    v_lshlrev_b32 v5, 3, v5
    v_mfma_f32_16x16x32_bf16 v[20:23], v[72:75], v[76:79], v[20:23]
    ds_read_b128 v[48:51], v236 offset:3904
    ds_read_b128 v[52:55], v237 offset:7136
    s_lshl_b32 s6, s3, 8
    s_add_u32 s6, s6, 123904
    v_add_u32_e64 v128, s6, v5
    s_waitcnt lgkmcnt(9)
    v_mfma_f32_16x16x32_bf16 v[24:27], v[80:83], v[84:87], v[24:27]
    global_load_dwordx4 a[116:119], v2, s[64:65] offset:1024 sc1
    ds_read_b128 v[56:59], v234 offset:3392
    ds_read_b128 v[60:63], v237 offset:5568
    v_mfma_f32_16x16x32_bf16 v[16:19], v[88:91], v[92:95], v[16:19]
    ds_read_b128 v[64:67], v235 offset:3392
    ds_read_b128 v[68:71], v237 offset:5584
    v_lshrrev_b32 v6, 5, v1
    s_waitcnt lgkmcnt(9)
    v_mfma_f32_16x16x32_bf16 v[20:23], v[96:99], v[100:103], v[20:23]
    ds_read_b128 v[72:75], v236 offset:3392
    ds_read_b128 v[76:79], v237 offset:5600
    v_lshl_add_u32 v129, v6, 9, v5
    v_mfma_f32_16x16x32_bf16 v[24:27], v[104:107], v[108:111], v[24:27]
    global_load_dwordx4 a[120:123], v2, s[64:65] offset:2048 sc1
    ds_read_b128 v[80:83], v234 offset:2880
    ds_read_b128 v[84:87], v237 offset:4032
    s_waitcnt lgkmcnt(9)
    s_nop 0
    v_mfma_f32_16x16x32_bf16 v[16:19], v[32:35], v[36:39], v[16:19]
    ds_read_b128 v[88:91], v235 offset:2880
    ds_read_b128 v[92:95], v237 offset:4048
    v_add_u32 v129, 123904, v129
    v_mfma_f32_16x16x32_bf16 v[20:23], v[40:43], v[44:47], v[20:23]
    ds_read_b128 v[96:99], v236 offset:2880
    ds_read_b128 v[100:103], v237 offset:4064
    s_mul_i32 s6, s62, 320
    s_add_u32 s6, s6, 240128
    v_lshl_add_u32 v6, v4, 4, s6
    global_load_dwordx4 a[124:127], v2, s[64:65] offset:3072 sc1
    s_waitcnt lgkmcnt(9)
    v_mfma_f32_16x16x32_bf16 v[24:27], v[48:51], v[52:55], v[24:27]
    s_nop 0
    ds_read_b128 v[104:107], v234 offset:2368
    ds_read_b128 v[108:111], v237 offset:2496
    v_bfe_u32 v5, v1, 3, 1
    v_mfma_f32_16x16x32_bf16 v[16:19], v[56:59], v[60:63], v[16:19]
    ds_read_b128 v[32:35], v235 offset:2368
    ds_read_b128 v[36:39], v237 offset:2512
    s_waitcnt lgkmcnt(9)
    v_mfma_f32_16x16x32_bf16 v[20:23], v[64:67], v[68:71], v[20:23]
    ds_read_b128 v[40:43], v236 offset:2368
    s_add_u32 s64, s64, 8192
    s_addc_u32 s65, s65, 0
    global_load_dwordx4 a[128:131], v2, s[64:65] offset:-4096 sc1
    ds_read_b128 v[44:47], v237 offset:2528
    v_mul_u32_u24 v5, 1280, v5
    v_mfma_f32_16x16x32_bf16 v[24:27], v[72:75], v[76:79], v[24:27]
    ds_read_b128 v[48:51], v234 offset:1856
    ds_read_b128 v[52:55], v237 offset:960
    v_sub_u32 v5, 128256, v5
    s_waitcnt lgkmcnt(9)
    v_mfma_f32_16x16x32_bf16 v[16:19], v[80:83], v[84:87], v[16:19]
    s_nop 0
    ds_read_b128 v[56:59], v235 offset:1856
    ds_read_b128 v[60:63], v237 offset:976
    v_mfma_f32_16x16x32_bf16 v[20:23], v[88:91], v[92:95], v[20:23]
    ds_read_b128 v[64:67], v236 offset:1856
    global_load_dwordx4 a[132:135], v2, s[64:65] offset:-3072 sc1
    ds_read_b128 v[68:71], v237 offset:992
    v_lshl_add_u32 v5, v4, 3, v5
    s_waitcnt lgkmcnt(9)
    v_mfma_f32_16x16x32_bf16 v[24:27], v[96:99], v[100:103], v[24:27]
    ds_read_b128 v[72:75], v234 offset:3840
    ds_read_b128 v[76:79], v237 offset:6912
    v_and_b32 v15, 1, v1
    v_mfma_f32_16x16x32_bf16 v[16:19], v[104:107], v[108:111], v[16:19]
    ds_read_b128 v[80:83], v235 offset:3840
    ds_read_b128 v[84:87], v237 offset:6928
    s_lshl_b32 s6, s61, 3
    s_lshl_b32 s7, s3, 1
    s_add_u32 s6, s6, s7
    v_add_u32 v15, s6, v15
    global_load_dwordx4 a[136:139], v2, s[64:65] offset:-2048 sc1
    s_waitcnt lgkmcnt(9)
    v_mfma_f32_16x16x32_bf16 v[20:23], v[32:35], v[36:39], v[20:23]
    ds_read_b128 v[88:91], v236 offset:3840
    ds_read_b128 v[92:95], v237 offset:6944
    v_mfma_f32_16x16x32_bf16 v[24:27], v[40:43], v[44:47], v[24:27]
    ds_read_b128 v[96:99], v234 offset:3328
    ds_read_b128 v[100:103], v237 offset:5376
    v_lshlrev_b32_e64 v15, 7, v15
    s_waitcnt lgkmcnt(9)
    v_mfma_f32_16x16x32_bf16 v[16:19], v[48:51], v[52:55], v[16:19]
    global_load_dwordx4 a[140:143], v2, s[64:65] offset:-1024 sc1
    ds_read_b128 v[104:107], v235 offset:3328
    ds_read_b128 v[108:111], v237 offset:5392
    v_add_u32 v15, 135168, v15
    v_mfma_f32_16x16x32_bf16 v[20:23], v[56:59], v[60:63], v[20:23]
    ds_read_b128 v[32:35], v236 offset:3328
    ds_read_b128 v[36:39], v237 offset:5408
    s_waitcnt lgkmcnt(9)
    v_mfma_f32_16x16x32_bf16 v[24:27], v[64:67], v[68:71], v[24:27]
    s_nop 0
    ds_read_b128 v[40:43], v234 offset:2816
    ds_read_b128 v[44:47], v237 offset:3840
    v_mfma_f32_16x16x32_bf16 v[16:19], v[72:75], v[76:79], v[16:19]
    ds_read_b128 v[48:51], v235 offset:2816
    global_load_dwordx4 a[144:147], v2, s[64:65] offset:0 sc1
    ds_read_b128 v[52:55], v237 offset:3856
    s_waitcnt vmcnt(17)
    s_barrier
    s_lshl_b32 s88, s2, 5
    s_add_u32 s88, s88, 69632
    v_lshl_add_u32 v126, v1, 2, s88
    v_mov_b32 v127, s50
    s_mov_b64 exec, 0xff
    global_store_dword v126, v127, s[48:49] sc1
    s_mov_b64 exec, -1
    s_waitcnt lgkmcnt(9)
    v_mfma_f32_16x16x32_bf16 v[20:23], v[80:83], v[84:87], v[20:23]
    global_load_dwordx4 a[148:151], v2, s[64:65] offset:1024 sc1
    ds_read_b128 v[56:59], v236 offset:2816
    ds_read_b128 v[60:63], v237 offset:3872
    v_mfma_f32_16x16x32_bf16 v[24:27], v[88:91], v[92:95], v[24:27]
    ds_read_b128 v[64:67], v234 offset:2304
    ds_read_b128 v[68:71], v237 offset:2304
    s_waitcnt lgkmcnt(9)
    v_mfma_f32_16x16x32_bf16 v[16:19], v[96:99], v[100:103], v[16:19]
    s_nop 0
    ds_read_b128 v[72:75], v235 offset:2304
    ds_read_b128 v[76:79], v237 offset:2320
    v_mfma_f32_16x16x32_bf16 v[20:23], v[104:107], v[108:111], v[20:23]
    ds_read_b128 v[80:83], v236 offset:2304
    ds_read_b128 v[84:87], v237 offset:2336
    global_load_dwordx4 a[152:155], v2, s[64:65] offset:2048 sc1
    s_waitcnt lgkmcnt(9)
    v_mfma_f32_16x16x32_bf16 v[24:27], v[32:35], v[36:39], v[24:27]
    ds_read_b128 v[88:91], v234 offset:1792
    ds_read_b128 v[92:95], v237 offset:768
    v_mfma_f32_16x16x32_bf16 v[16:19], v[40:43], v[44:47], v[16:19]
    ds_read_b128 v[96:99], v235 offset:1792
    ds_read_b128 v[100:103], v237 offset:784
    s_waitcnt lgkmcnt(9)
    v_mfma_f32_16x16x32_bf16 v[20:23], v[48:51], v[52:55], v[20:23]
    ds_read_b128 v[104:107], v236 offset:1792
    ds_read_b128 v[108:111], v237 offset:800
    v_mfma_f32_16x16x32_bf16 v[24:27], v[56:59], v[60:63], v[24:27]
    global_load_dwordx4 a[156:159], v2, s[64:65] offset:3072 sc1
    ds_read_b128 v[32:35], v234 offset:3776
    ds_read_b128 v[36:39], v237 offset:6720
    s_waitcnt lgkmcnt(9)
    v_mfma_f32_16x16x32_bf16 v[16:19], v[64:67], v[68:71], v[16:19]
    ds_read_b128 v[40:43], v235 offset:3776
    ds_read_b128 v[44:47], v237 offset:6736
    v_mfma_f32_16x16x32_bf16 v[20:23], v[72:75], v[76:79], v[20:23]
    ds_read_b128 v[48:51], v236 offset:3776
    ds_read_b128 v[52:55], v237 offset:6752
    s_waitcnt lgkmcnt(9)
    v_mfma_f32_16x16x32_bf16 v[24:27], v[80:83], v[84:87], v[24:27]
    s_add_u32 s64, s64, 8192
    s_addc_u32 s65, s65, 0
    s_nop 0
    global_load_dwordx4 a[160:163], v2, s[64:65] offset:-4096 sc1
    ds_read_b128 v[56:59], v234 offset:3264
    ds_read_b128 v[60:63], v237 offset:5184
    v_mfma_f32_16x16x32_bf16 v[16:19], v[88:91], v[92:95], v[16:19]
    ds_read_b128 v[64:67], v235 offset:3264
    ds_read_b128 v[68:71], v237 offset:5200
    s_waitcnt lgkmcnt(9)
    v_mfma_f32_16x16x32_bf16 v[20:23], v[96:99], v[100:103], v[20:23]
    s_nop 0
    ds_read_b128 v[72:75], v236 offset:3264
    ds_read_b128 v[76:79], v237 offset:5216
    v_mfma_f32_16x16x32_bf16 v[24:27], v[104:107], v[108:111], v[24:27]
    ds_read_b128 v[80:83], v234 offset:2752
    ds_read_b128 v[84:87], v237 offset:3648
    global_load_dwordx4 a[164:167], v2, s[64:65] offset:-3072 sc1
    s_waitcnt lgkmcnt(9)
    v_mfma_f32_16x16x32_bf16 v[16:19], v[32:35], v[36:39], v[16:19]
    ds_read_b128 v[88:91], v235 offset:2752
    ds_read_b128 v[92:95], v237 offset:3664
    v_mfma_f32_16x16x32_bf16 v[20:23], v[40:43], v[44:47], v[20:23]
    ds_read_b128 v[96:99], v236 offset:2752
    ds_read_b128 v[100:103], v237 offset:3680
    s_waitcnt lgkmcnt(9)
    v_mfma_f32_16x16x32_bf16 v[24:27], v[48:51], v[52:55], v[24:27]
    ds_read_b128 v[104:107], v234 offset:2240
    ds_read_b128 v[108:111], v237 offset:2112
    v_mfma_f32_16x16x32_bf16 v[16:19], v[56:59], v[60:63], v[16:19]
    global_load_dwordx4 a[168:171], v2, s[64:65] offset:-2048 sc1
    ds_read_b128 v[32:35], v235 offset:2240
    ds_read_b128 v[36:39], v237 offset:2128
    s_waitcnt lgkmcnt(9)
    v_mfma_f32_16x16x32_bf16 v[20:23], v[64:67], v[68:71], v[20:23]
    ds_read_b128 v[40:43], v236 offset:2240
    ds_read_b128 v[44:47], v237 offset:2144
    v_mfma_f32_16x16x32_bf16 v[24:27], v[72:75], v[76:79], v[24:27]
    ds_read_b128 v[48:51], v234 offset:1728
    ds_read_b128 v[52:55], v237 offset:576
    s_waitcnt lgkmcnt(9)
    v_mfma_f32_16x16x32_bf16 v[16:19], v[80:83], v[84:87], v[16:19]
    global_load_dwordx4 a[172:175], v2, s[64:65] offset:-1024 sc1
    ds_read_b128 v[56:59], v235 offset:1728
    ds_read_b128 v[60:63], v237 offset:592
    v_mfma_f32_16x16x32_bf16 v[20:23], v[88:91], v[92:95], v[20:23]
    ds_read_b128 v[64:67], v236 offset:1728
    ds_read_b128 v[68:71], v237 offset:608
    global_load_dword v125, v250, s[48:49] sc1
    global_load_dword v28, v29, s[48:49] sc1
    s_waitcnt lgkmcnt(9)
    v_mfma_f32_16x16x32_bf16 v[24:27], v[96:99], v[100:103], v[24:27]
    ds_read_b128 v[72:75], v234 offset:3712
    ds_read_b128 v[76:79], v237 offset:6528
    v_mfma_f32_16x16x32_bf16 v[16:19], v[104:107], v[108:111], v[16:19]
    ds_read_b128 v[80:83], v235 offset:3712
    ds_read_b128 v[84:87], v237 offset:6544
    s_waitcnt lgkmcnt(9)
    v_mfma_f32_16x16x32_bf16 v[20:23], v[32:35], v[36:39], v[20:23]
    ds_read_b128 v[88:91], v236 offset:3712
    ds_read_b128 v[92:95], v237 offset:6560
    v_mfma_f32_16x16x32_bf16 v[24:27], v[40:43], v[44:47], v[24:27]
    ds_read_b128 v[96:99], v234 offset:3200
    ds_read_b128 v[100:103], v237 offset:4992
    s_waitcnt lgkmcnt(9)
    v_mfma_f32_16x16x32_bf16 v[16:19], v[48:51], v[52:55], v[16:19]
    s_nop 0
    ds_read_b128 v[104:107], v235 offset:3200
    global_load_dwordx4 a[176:179], v2, s[64:65] offset:0 sc1
    ds_read_b128 v[108:111], v237 offset:5008
    v_mfma_f32_16x16x32_bf16 v[20:23], v[56:59], v[60:63], v[20:23]
    ds_read_b128 v[32:35], v236 offset:3200
    ds_read_b128 v[36:39], v237 offset:5024
    s_waitcnt lgkmcnt(9)
    v_mfma_f32_16x16x32_bf16 v[24:27], v[64:67], v[68:71], v[24:27]
    ds_read_b128 v[40:43], v234 offset:2688
    ds_read_b128 v[44:47], v237 offset:3456
    v_mfma_f32_16x16x32_bf16 v[16:19], v[72:75], v[76:79], v[16:19]
    ds_read_b128 v[48:51], v235 offset:2688
    ds_read_b128 v[52:55], v237 offset:3472
    s_waitcnt lgkmcnt(9)
    v_mfma_f32_16x16x32_bf16 v[20:23], v[80:83], v[84:87], v[20:23]
    global_load_dwordx4 a[180:183], v2, s[64:65] offset:1024 sc1
    ds_read_b128 v[56:59], v236 offset:2688
    ds_read_b128 v[60:63], v237 offset:3488
    v_mfma_f32_16x16x32_bf16 v[24:27], v[88:91], v[92:95], v[24:27]
    ds_read_b128 v[64:67], v234 offset:2176
    ds_read_b128 v[68:71], v237 offset:1920
    s_waitcnt lgkmcnt(9)
    v_mfma_f32_16x16x32_bf16 v[16:19], v[96:99], v[100:103], v[16:19]
    s_nop 0
    ds_read_b128 v[72:75], v235 offset:2176
    ds_read_b128 v[76:79], v237 offset:1936
    v_mfma_f32_16x16x32_bf16 v[20:23], v[104:107], v[108:111], v[20:23]
    global_load_dwordx4 a[184:187], v2, s[64:65] offset:2048 sc1
    ds_read_b128 v[80:83], v236 offset:2176
    ds_read_b128 v[84:87], v237 offset:1952
    s_waitcnt lgkmcnt(9)
    v_mfma_f32_16x16x32_bf16 v[24:27], v[32:35], v[36:39], v[24:27]
    ds_read_b128 v[88:91], v234 offset:1664
    ds_read_b128 v[92:95], v237 offset:384
    v_mfma_f32_16x16x32_bf16 v[16:19], v[40:43], v[44:47], v[16:19]
    ds_read_b128 v[96:99], v235 offset:1664
    ds_read_b128 v[100:103], v237 offset:400
    s_waitcnt lgkmcnt(9)
    v_mfma_f32_16x16x32_bf16 v[20:23], v[48:51], v[52:55], v[20:23]
    ds_read_b128 v[104:107], v236 offset:1664
    global_load_dwordx4 a[188:191], v2, s[64:65] offset:3072 sc1
    ds_read_b128 v[108:111], v237 offset:416
    v_mfma_f32_16x16x32_bf16 v[24:27], v[56:59], v[60:63], v[24:27]
    ds_read_b128 v[32:35], v234 offset:3648
    ds_read_b128 v[36:39], v237 offset:6336
    s_waitcnt lgkmcnt(9)
    v_mfma_f32_16x16x32_bf16 v[16:19], v[64:67], v[68:71], v[16:19]
    ds_read_b128 v[40:43], v235 offset:3648
    ds_read_b128 v[44:47], v237 offset:6352
    v_mfma_f32_16x16x32_bf16 v[20:23], v[72:75], v[76:79], v[20:23]
    ds_read_b128 v[48:51], v236 offset:3648
    ds_read_b128 v[52:55], v237 offset:6368
    s_waitcnt lgkmcnt(9)
    v_mfma_f32_16x16x32_bf16 v[24:27], v[80:83], v[84:87], v[24:27]
    s_add_u32 s64, s64, 8192
    s_addc_u32 s65, s65, 0
    s_nop 0
    global_load_dwordx4 a[192:195], v2, s[64:65] offset:-4096 sc1
    ds_read_b128 v[56:59], v234 offset:3136
    ds_read_b128 v[60:63], v237 offset:4800
    v_mfma_f32_16x16x32_bf16 v[16:19], v[88:91], v[92:95], v[16:19]
    ds_read_b128 v[64:67], v235 offset:3136
    ds_read_b128 v[68:71], v237 offset:4816
    s_waitcnt lgkmcnt(9)
    v_mfma_f32_16x16x32_bf16 v[20:23], v[96:99], v[100:103], v[20:23]
    s_nop 0
    ds_read_b128 v[72:75], v236 offset:3136
    ds_read_b128 v[76:79], v237 offset:4832
    v_mfma_f32_16x16x32_bf16 v[24:27], v[104:107], v[108:111], v[24:27]
    global_load_dwordx4 a[196:199], v2, s[64:65] offset:-3072 sc1
    ds_read_b128 v[80:83], v234 offset:2624
    ds_read_b128 v[84:87], v237 offset:3264
    s_waitcnt lgkmcnt(9)
    v_mfma_f32_16x16x32_bf16 v[16:19], v[32:35], v[36:39], v[16:19]
    ds_read_b128 v[88:91], v235 offset:2624
    ds_read_b128 v[92:95], v237 offset:3280
    s_waitcnt vmcnt(7)
    v_cmp_ne_u32 vcc, s50, v125
    s_nop 0
    s_cbranch_vccnz L_cfr_19
L_cfd_18:
    v_mfma_f32_16x16x32_bf16 v[20:23], v[40:43], v[44:47], v[20:23]
    ds_read_b128 v[96:99], v236 offset:2624
    global_load_dwordx4 a[200:203], v2, s[64:65] offset:-2048 sc1
    ds_read_b128 v[100:103], v237 offset:3296
    s_waitcnt lgkmcnt(9)
    v_mfma_f32_16x16x32_bf16 v[24:27], v[48:51], v[52:55], v[24:27]
    ds_read_b128 v[104:107], v234 offset:2112
    ds_read_b128 v[108:111], v237 offset:1728
    v_mfma_f32_16x16x32_bf16 v[16:19], v[56:59], v[60:63], v[16:19]
    ds_read_b128 v[32:35], v235 offset:2112
    ds_read_b128 v[36:39], v237 offset:1744
    s_waitcnt lgkmcnt(9)
    v_mfma_f32_16x16x32_bf16 v[20:23], v[64:67], v[68:71], v[20:23]
    ds_read_b128 v[40:43], v236 offset:2112
    ds_read_b128 v[44:47], v237 offset:1760
    v_mfma_f32_16x16x32_bf16 v[24:27], v[72:75], v[76:79], v[24:27]
    ds_read_b128 v[48:51], v234 offset:1600
    ds_read_b128 v[52:55], v237 offset:192
    s_waitcnt lgkmcnt(9)
    v_mfma_f32_16x16x32_bf16 v[16:19], v[80:83], v[84:87], v[16:19]
    ds_read_b128 v[56:59], v235 offset:1600
    ds_read_b128 v[60:63], v237 offset:208
    v_mfma_f32_16x16x32_bf16 v[20:23], v[88:91], v[92:95], v[20:23]
    ds_read_b128 v[64:67], v236 offset:1600
    ds_read_b128 v[68:71], v237 offset:224
    s_waitcnt vmcnt(7)
    v_cmp_ne_u32 vcc, s50, v28
    s_nop 0
    s_cbranch_vccnz L_cfr_22
L_cfd_21:
    s_add_u32 s86, s48, 237568
    s_addc_u32 s87, s49, 0
    s_mov_b32 m0, 126976
    s_nop 0
    global_load_lds_dwordx4 v2, s[86:87] sc1
    global_load_lds_dwordx4 v2, s[86:87] offset:1024 sc1
    global_load_lds_dwordx4 v2, s[86:87] offset:2048 sc1
    s_waitcnt lgkmcnt(9)
    v_mfma_f32_16x16x32_bf16 v[24:27], v[96:99], v[100:103], v[24:27]
    ds_read_b128 v[72:75], v234 offset:3584
    ds_read_b128 v[76:79], v237 offset:6144
    v_mfma_f32_16x16x32_bf16 v[16:19], v[104:107], v[108:111], v[16:19]
    ds_read_b128 v[80:83], v235 offset:3584
    ds_read_b128 v[84:87], v237 offset:6160
    s_waitcnt lgkmcnt(9)
    v_mfma_f32_16x16x32_bf16 v[20:23], v[32:35], v[36:39], v[20:23]
    ds_read_b128 v[88:91], v236 offset:3584
    ds_read_b128 v[92:95], v237 offset:6176
    v_mfma_f32_16x16x32_bf16 v[24:27], v[40:43], v[44:47], v[24:27]
    ds_read_b128 v[96:99], v234 offset:3072
    ds_read_b128 v[100:103], v237 offset:4608
    s_waitcnt lgkmcnt(9)
    v_mfma_f32_16x16x32_bf16 v[16:19], v[48:51], v[52:55], v[16:19]
    ds_read_b128 v[104:107], v235 offset:3072
    ds_read_b128 v[108:111], v237 offset:4624
    v_mfma_f32_16x16x32_bf16 v[20:23], v[56:59], v[60:63], v[20:23]
    ds_read_b128 v[32:35], v236 offset:3072
    ds_read_b128 v[36:39], v237 offset:4640
    s_waitcnt lgkmcnt(9)
    v_mfma_f32_16x16x32_bf16 v[24:27], v[64:67], v[68:71], v[24:27]
    ds_read_b128 v[40:43], v234 offset:2560
    ds_read_b128 v[44:47], v237 offset:3072
    v_mfma_f32_16x16x32_bf16 v[16:19], v[72:75], v[76:79], v[16:19]
    ds_read_b128 v[48:51], v235 offset:2560
    ds_read_b128 v[52:55], v237 offset:3088
    global_load_dword v124, v245, s[48:49] sc1
    s_waitcnt lgkmcnt(9)
    v_mfma_f32_16x16x32_bf16 v[20:23], v[80:83], v[84:87], v[20:23]
    ds_read_b128 v[56:59], v236 offset:2560
    ds_read_b128 v[60:63], v237 offset:3104
    v_mfma_f32_16x16x32_bf16 v[24:27], v[88:91], v[92:95], v[24:27]
    ds_read_b128 v[64:67], v234 offset:2048
    ds_read_b128 v[68:71], v237 offset:1536
    s_waitcnt lgkmcnt(9)
    v_mfma_f32_16x16x32_bf16 v[16:19], v[96:99], v[100:103], v[16:19]
    ds_read_b128 v[72:75], v235 offset:2048
    ds_read_b128 v[76:79], v237 offset:1552
    v_mfma_f32_16x16x32_bf16 v[20:23], v[104:107], v[108:111], v[20:23]
    ds_read_b128 v[80:83], v236 offset:2048
    ds_read_b128 v[84:87], v237 offset:1568
    s_waitcnt lgkmcnt(9)
    v_mfma_f32_16x16x32_bf16 v[24:27], v[32:35], v[36:39], v[24:27]
    ds_read_b128 v[88:91], v234 offset:1536
    ds_read_b128 v[92:95], v237 offset:0
    v_mfma_f32_16x16x32_bf16 v[16:19], v[40:43], v[44:47], v[16:19]
    ds_read_b128 v[96:99], v235 offset:1536
    ds_read_b128 v[100:103], v237 offset:16
    s_waitcnt lgkmcnt(9)
    v_mfma_f32_16x16x32_bf16 v[20:23], v[48:51], v[52:55], v[20:23]
    ds_read_b128 v[104:107], v236 offset:1536
    ds_read_b128 v[108:111], v237 offset:32
    v_mfma_f32_16x16x32_bf16 v[24:27], v[56:59], v[60:63], v[24:27]
    s_waitcnt lgkmcnt(7)
    v_mfma_f32_16x16x32_bf16 v[16:19], v[64:67], v[68:71], v[16:19]
    s_nop 0
    ds_read_b64 v[140:141], v238 offset:6144
    ds_read_b64 v[142:143], v238 offset:18432
    ds_read_b64 v[144:145], v238 offset:6160
    ds_read_b64 v[146:147], v238 offset:18448
    ds_read_b64 v[148:149], v238 offset:6176
    ds_read_b64 v[150:151], v238 offset:18464
    v_mfma_f32_16x16x32_bf16 v[20:23], v[72:75], v[76:79], v[20:23]
    s_waitcnt lgkmcnt(9)
    v_mfma_f32_16x16x32_bf16 v[24:27], v[80:83], v[84:87], v[24:27]
    v_mfma_f32_16x16x32_bf16 v[16:19], v[88:91], v[92:95], v[16:19]
    s_waitcnt lgkmcnt(6)
    v_mfma_f32_16x16x32_bf16 v[20:23], v[96:99], v[100:103], v[20:23]
    v_mfma_f32_16x16x32_bf16 v[24:27], v[104:107], v[108:111], v[24:27]
    s_waitcnt lgkmcnt(4)
    v_lshlrev_b32 v48, 16, v140
    v_and_b32 v49, 0xffff0000, v140
    v_lshlrev_b32 v50, 16, v142
    v_and_b32 v51, 0xffff0000, v142
    v_lshlrev_b32 v52, 16, v141
    v_and_b32 v53, 0xffff0000, v141
    v_lshlrev_b32_e64 v54, 16, v143
    v_and_b32 v55, 0xffff0000, v143
    v_pk_fma_f32 v[48:49], v[48:49], v[112:113], v[50:51] op_sel:[0,1,0] op_sel_hi:[1,1,1]
    v_pk_fma_f32 v[52:53], v[52:53], v[112:113], v[54:55] op_sel:[0,1,0] op_sel_hi:[1,1,1]
    v_pk_fma_f32 v[48:49], v[16:17], v[112:113], v[48:49] op_sel_hi:[1,0,1]
    v_pk_fma_f32 v[52:53], v[18:19], v[112:113], v[52:53] op_sel_hi:[1,0,1]
    v_pk_mul_f32 v[50:51], v[48:49], v[114:115] op_sel_hi:[1,0]
    v_pk_mul_f32 v[54:55], v[52:53], v[114:115] op_sel_hi:[1,0]
    v_cvt_pk_bf16_f32 v56, v48, v49
    v_cvt_pk_bf16_f32 v57, v52, v53
    v_cvt_pk_bf16_f32 v58, v50, v51
    v_cvt_pk_bf16_f32 v59, v54, v55
    s_add_u32 s6, s48, 1310720
    s_addc_u32 s7, s49, 0
    v_permlane16_swap_b32 v56, v58
    v_permlane16_swap_b32 v57, v59
    global_store_dwordx4 v239, v[56:59], s[6:7] sc1
    s_waitcnt lgkmcnt(2)
    v_lshlrev_b32 v64, 16, v144
    v_and_b32 v65, 0xffff0000, v144
    v_lshlrev_b32 v66, 16, v146
    v_and_b32 v67, 0xffff0000, v146
    v_lshlrev_b32 v68, 16, v145
    v_and_b32 v69, 0xffff0000, v145
    v_lshlrev_b32 v70, 16, v147
    v_and_b32 v71, 0xffff0000, v147
    v_pk_fma_f32 v[64:65], v[64:65], v[116:117], v[66:67] op_sel:[0,1,0] op_sel_hi:[1,1,1]
    v_pk_fma_f32 v[68:69], v[68:69], v[116:117], v[70:71] op_sel:[0,1,0] op_sel_hi:[1,1,1]
    v_pk_fma_f32 v[64:65], v[20:21], v[116:117], v[64:65] op_sel_hi:[1,0,1]
    v_pk_fma_f32 v[68:69], v[22:23], v[116:117], v[68:69] op_sel_hi:[1,0,1]
    v_pk_mul_f32 v[66:67], v[64:65], v[118:119] op_sel_hi:[1,0]
    v_pk_mul_f32 v[70:71], v[68:69], v[118:119] op_sel_hi:[1,0]
    v_cvt_pk_bf16_f32 v72, v64, v65
    v_cvt_pk_bf16_f32 v73, v68, v69
    v_cvt_pk_bf16_f32 v74, v66, v67
    v_cvt_pk_bf16_f32 v75, v70, v71
    s_add_u32 s6, s48, 1310720
    s_addc_u32 s7, s49, 0
    v_permlane16_swap_b32 v72, v74
    v_permlane16_swap_b32 v73, v75
    global_store_dwordx4 v240, v[72:75], s[6:7] sc1
    s_waitcnt lgkmcnt(0)
    v_lshlrev_b32 v80, 16, v148
    v_and_b32 v81, 0xffff0000, v148
    v_lshlrev_b32 v82, 16, v150
    v_and_b32 v83, 0xffff0000, v150
    v_lshlrev_b32 v84, 16, v149
    v_and_b32 v85, 0xffff0000, v149
    v_lshlrev_b32 v86, 16, v151
    v_and_b32 v87, 0xffff0000, v151
    v_pk_fma_f32 v[80:81], v[80:81], v[120:121], v[82:83] op_sel:[0,1,0] op_sel_hi:[1,1,1]
    v_pk_fma_f32 v[84:85], v[84:85], v[120:121], v[86:87] op_sel:[0,1,0] op_sel_hi:[1,1,1]
    v_pk_fma_f32 v[80:81], v[24:25], v[120:121], v[80:81] op_sel_hi:[1,0,1]
    v_pk_fma_f32 v[84:85], v[26:27], v[120:121], v[84:85] op_sel_hi:[1,0,1]
    v_pk_mul_f32 v[82:83], v[80:81], v[122:123] op_sel_hi:[1,0]
    v_pk_mul_f32 v[86:87], v[84:85], v[122:123] op_sel_hi:[1,0]
    v_cvt_pk_bf16_f32 v88, v80, v81
    v_cvt_pk_bf16_f32 v89, v84, v85
    v_cvt_pk_bf16_f32 v90, v82, v83
    v_cvt_pk_bf16_f32 v91, v86, v87
    s_add_u32 s6, s48, 1310720
    s_addc_u32 s7, s49, 0
    v_permlane16_swap_b32 v88, v90
    v_permlane16_swap_b32 v89, v91
    global_store_dwordx4 v241, v[88:91], s[6:7] sc1
    s_waitcnt vmcnt(3)
    v_cmp_ne_u32 vcc, s50, v124
    s_nop 0
    s_cbranch_vccnz L_cfr_25
L_cfd_24:
    s_branch L_POST
L_SIDE_W:
    s_mov_b32 s90, 0
    v_mov_b32 v24, 126020
L_ls_26:
    ds_read_b32 v25, v24
    s_add_u32 s90, s90, 1
    s_waitcnt lgkmcnt(0)
    v_cmp_ne_u32 vcc, 1, v25
    s_nop 0
    s_cbranch_vccz L_lsd_27
    s_cmp_gt_u32 s90, 1048576
    s_cbranch_scc0 L_ls_26
L_lsd_27:
    s_mul_i32 s8, s70, 40960
    s_lshl_b32 s9, s71, 7
    s_add_u32 s8, s8, s9
    v_add_u32 v21, s8, v205
    s_add_u32 m0, s56, 0
    s_nop 0
    global_load_lds_dwordx4 v21, s[38:39]
    s_add_u32 m0, s56, 1024
    v_add_u32 v21, 10240, v21
    global_load_lds_dwordx4 v21, s[38:39]
    s_add_u32 m0, s56, 2048
    v_add_u32 v21, 10240, v21
    global_load_lds_dwordx4 v21, s[38:39]
    s_add_u32 m0, s56, 3072
    v_add_u32 v21, 10240, v21
    global_load_lds_dwordx4 v21, s[38:39]
    s_mul_i32 s8, s72, 40960
    s_lshl_b32 s9, s73, 7
    s_add_u32 s8, s8, s9
    v_add_u32 v21, s8, v205
    s_add_u32 m0, s56, 4096
    s_nop 0
    global_load_lds_dwordx4 v21, s[38:39]
    s_add_u32 m0, s56, 5120
    v_add_u32 v21, 10240, v21
    global_load_lds_dwordx4 v21, s[38:39]
    s_add_u32 m0, s56, 6144
    v_add_u32 v21, 10240, v21
    global_load_lds_dwordx4 v21, s[38:39]
    s_add_u32 m0, s56, 7168
    v_add_u32 v21, 10240, v21
    global_load_lds_dwordx4 v21, s[38:39]
    s_mul_i32 s8, s74, 40960
    s_lshl_b32 s9, s75, 7
    s_add_u32 s8, s8, s9
    v_add_u32 v21, s8, v205
    s_add_u32 m0, s56, 8192
    s_nop 0
    global_load_lds_dwordx4 v21, s[38:39]
    s_add_u32 m0, s56, 9216
    v_add_u32 v21, 10240, v21
    global_load_lds_dwordx4 v21, s[38:39]
    s_add_u32 m0, s56, 10240
    v_add_u32 v21, 10240, v21
    global_load_lds_dwordx4 v21, s[38:39]
    s_add_u32 m0, s56, 11264
    v_add_u32 v21, 10240, v21
    global_load_lds_dwordx4 v21, s[38:39]
    s_mul_i32 s8, s76, 40960
    s_lshl_b32 s9, s77, 7
    s_add_u32 s8, s8, s9
    v_add_u32 v21, s8, v205
    s_add_u32 m0, s56, 12288
    s_nop 0
    global_load_lds_dwordx4 v21, s[38:39]
    s_add_u32 m0, s56, 13312
    v_add_u32 v21, 10240, v21
    global_load_lds_dwordx4 v21, s[38:39]
    s_add_u32 m0, s56, 14336
    v_add_u32 v21, 10240, v21
    global_load_lds_dwordx4 v21, s[38:39]
    s_add_u32 m0, s56, 15360
    v_add_u32 v21, 10240, v21
    global_load_lds_dwordx4 v21, s[38:39]
    s_waitcnt vmcnt(12)
    s_nop 0
    ds_read_b64_tr_b16 v[128:129], v206 offset:0
    ds_read_b64_tr_b16 v[130:131], v206 offset:2048
    ds_read_b64_tr_b16 v[132:133], v206 offset:32
    ds_read_b64_tr_b16 v[134:135], v206 offset:2080
    ds_read_b64_tr_b16 v[136:137], v206 offset:64
    ds_read_b64_tr_b16 v[138:139], v206 offset:2112
    ds_read_b64_tr_b16 v[140:141], v206 offset:96
    ds_read_b64_tr_b16 v[142:143], v206 offset:2144
    s_waitcnt lgkmcnt(6)
    global_store_dwordx4 v96, v[128:131], s[48:49] sc1
    s_waitcnt lgkmcnt(4)
    global_store_dwordx4 v97, v[132:135], s[48:49] sc1
    s_waitcnt lgkmcnt(2)
    global_store_dwordx4 v98, v[136:139], s[48:49] sc1
    s_waitcnt lgkmcnt(0)
    global_store_dwordx4 v99, v[140:143], s[48:49] sc1
    s_waitcnt vmcnt(12)
    s_nop 0
    ds_read_b64_tr_b16 v[144:145], v206 offset:4096
    ds_read_b64_tr_b16 v[146:147], v206 offset:6144
    ds_read_b64_tr_b16 v[148:149], v206 offset:4128
    ds_read_b64_tr_b16 v[150:151], v206 offset:6176
    ds_read_b64_tr_b16 v[152:153], v206 offset:4160
    ds_read_b64_tr_b16 v[154:155], v206 offset:6208
    ds_read_b64_tr_b16 v[156:157], v206 offset:4192
    ds_read_b64_tr_b16 v[158:159], v206 offset:6240
    s_waitcnt lgkmcnt(6)
    global_store_dwordx4 v100, v[144:147], s[48:49] sc1
    s_waitcnt lgkmcnt(4)
    global_store_dwordx4 v101, v[148:151], s[48:49] sc1
    s_waitcnt lgkmcnt(2)
    global_store_dwordx4 v102, v[152:155], s[48:49] sc1
    s_waitcnt lgkmcnt(0)
    global_store_dwordx4 v103, v[156:159], s[48:49] sc1
    s_waitcnt vmcnt(12)
    s_nop 0
    ds_read_b64_tr_b16 v[160:161], v206 offset:8192
    ds_read_b64_tr_b16 v[162:163], v206 offset:10240
    ds_read_b64_tr_b16 v[164:165], v206 offset:8224
    ds_read_b64_tr_b16 v[166:167], v206 offset:10272
    ds_read_b64_tr_b16 v[168:169], v206 offset:8256
    ds_read_b64_tr_b16 v[170:171], v206 offset:10304
    ds_read_b64_tr_b16 v[172:173], v206 offset:8288
    ds_read_b64_tr_b16 v[174:175], v206 offset:10336
    s_waitcnt lgkmcnt(6)
    global_store_dwordx4 v104, v[160:163], s[48:49] sc1
    s_waitcnt lgkmcnt(4)
    global_store_dwordx4 v105, v[164:167], s[48:49] sc1
    s_waitcnt lgkmcnt(2)
    global_store_dwordx4 v106, v[168:171], s[48:49] sc1
    s_waitcnt lgkmcnt(0)
    global_store_dwordx4 v107, v[172:175], s[48:49] sc1
    s_waitcnt vmcnt(12)
    s_nop 0
    ds_read_b64_tr_b16 v[176:177], v206 offset:12288
    ds_read_b64_tr_b16 v[178:179], v206 offset:14336
    ds_read_b64_tr_b16 v[180:181], v206 offset:12320
    ds_read_b64_tr_b16 v[182:183], v206 offset:14368
    ds_read_b64_tr_b16 v[184:185], v206 offset:12352
    ds_read_b64_tr_b16 v[186:187], v206 offset:14400
    ds_read_b64_tr_b16 v[188:189], v206 offset:12384
    ds_read_b64_tr_b16 v[190:191], v206 offset:14432
    s_waitcnt lgkmcnt(6)
    global_store_dwordx4 v108, v[176:179], s[48:49] sc1
    s_waitcnt lgkmcnt(4)
    global_store_dwordx4 v109, v[180:183], s[48:49] sc1
    s_waitcnt lgkmcnt(2)
    global_store_dwordx4 v110, v[184:187], s[48:49] sc1
    s_waitcnt lgkmcnt(0)
    global_store_dwordx4 v111, v[188:191], s[48:49] sc1
    s_waitcnt vmcnt(0)
    v_mov_b32 v24, 126024
    v_mov_b32 v25, 1
    s_mov_b64 exec, 1
    ds_add_rtn_u32 v24, v24, v25
    s_mov_b64 exec, -1
    s_waitcnt lgkmcnt(0)
    v_readfirstlane_b32 s88, v24
    s_nop 0
    s_cmp_lg_u32 s88, 2
    s_cbranch_scc1 L_sig_28
    s_lshl_b32 s88, s2, 5
    s_add_u32 s88, s88, 200704
    v_lshl_add_u32 v24, v1, 2, s88
    v_mov_b32 v25, s50
    s_mov_b64 exec, 0xff
    global_store_dword v24, v25, s[48:49] sc1
    s_mov_b64 exec, -1
L_sig_28:
L_SIDE_R:
    s_cmp_lg_u32 s3, 3
    s_cbranch_scc1 L_nosl_31
    v_add_u32 v24, 0, v1
    v_min_u32 v24, 255, v24
    v_lshlrev_b32 v24, 6, v24
    v_add_u32 v24, 4096, v24
    v_add_u32 v25, 64, v1
    v_min_u32 v25, 255, v25
    v_lshlrev_b32 v25, 6, v25
    v_add_u32 v25, 4096, v25
    v_add_u32 v26, 128, v1
    v_min_u32 v26, 255, v26
    v_lshlrev_b32 v26, 6, v26
    v_add_u32 v26, 4096, v26
    v_add_u32 v27, 192, v1
    v_min_u32 v27, 255, v27
    v_lshlrev_b32 v27, 6, v27
    v_add_u32 v27, 4096, v27
    s_cmp_lt_u32 s2, 240
    s_cbranch_scc1 L_nosl_31_p
    s_sleep 44
L_nosl_31_p:
    s_sleep 6
    s_mov_b32 s90, 0
L_poll_32:
    global_load_dword v28, v24, s[48:49] offset:0 sc1
    global_load_dword v29, v25, s[48:49] offset:0 sc1
    global_load_dword v30, v26, s[48:49] offset:0 sc1
    global_load_dword v31, v27, s[48:49] offset:0 sc1
    s_add_u32 s90, s90, 1
    s_waitcnt vmcnt(0)
    v_cmp_ne_u32 vcc, s50, v28
    v_cmp_ne_u32 s[88:89], s50, v29
    s_nop 0
    s_or_b64 vcc, vcc, s[88:89]
    v_cmp_ne_u32 s[88:89], s50, v30
    s_nop 0
    s_or_b64 vcc, vcc, s[88:89]
    v_cmp_ne_u32 s[88:89], s50, v31
    s_nop 0
    s_or_b64 vcc, vcc, s[88:89]
    s_nop 0
    s_cbranch_vccz L_polld_33
    s_cmp_gt_u32 s90, 65536
    s_cbranch_scc1 L_polld_33
    s_sleep 8
    s_branch L_poll_32
L_polld_33:
    v_mov_b32 v22, 126028
    v_mov_b32 v23, 1
    ds_write_b32 v22, v23
    s_cmp_lt_u32 s2, 248
    s_cbranch_scc1 L_nosl_31
    s_sub_u32 s6, s2, 248
    s_lshl_b32 s6, s6, 8
    v_add_u32 v32, s6, v1
    v_add_u32 v32, 0, v32
    v_min_u32 v32, 1919, v32
    v_lshlrev_b32 v36, 3, v32
    v_add_u32 v36, 867328, v36
    v_add_u32 v37, 30720, v36
    v_add_u32 v38, 61440, v36
    v_add_u32 v39, 92160, v36
    v_add_u32 v33, s6, v1
    v_add_u32 v33, 64, v33
    v_min_u32 v33, 1919, v33
    v_lshlrev_b32 v40, 3, v33
    v_add_u32 v40, 867328, v40
    v_add_u32 v41, 30720, v40
    v_add_u32 v42, 61440, v40
    v_add_u32 v43, 92160, v40
    v_add_u32 v34, s6, v1
    v_add_u32 v34, 128, v34
    v_min_u32 v34, 1919, v34
    v_lshlrev_b32 v44, 3, v34
    v_add_u32 v44, 867328, v44
    v_add_u32 v45, 30720, v44
    v_add_u32 v46, 61440, v44
    v_add_u32 v47, 92160, v44
    v_add_u32 v35, s6, v1
    v_add_u32 v35, 192, v35
    v_min_u32 v35, 1919, v35
    v_lshlrev_b32_e64 v48, 3, v35
    v_add_u32 v48, 867328, v48
    v_add_u32 v49, 30720, v48
    v_add_u32 v50, 61440, v48
    v_add_u32 v51, 92160, v48
    global_load_dwordx2 v[64:65], v36, s[48:49] sc1
    global_load_dwordx2 v[66:67], v37, s[48:49] sc1
    global_load_dwordx2 v[68:69], v38, s[48:49] sc1
    global_load_dwordx2 v[70:71], v39, s[48:49] sc1
    global_load_dwordx2 v[72:73], v40, s[48:49] sc1
    global_load_dwordx2 v[74:75], v41, s[48:49] sc1
    global_load_dwordx2 v[76:77], v42, s[48:49] sc1
    global_load_dwordx2 v[78:79], v43, s[48:49] sc1
    global_load_dwordx2 v[80:81], v44, s[48:49] sc1
    global_load_dwordx2 v[82:83], v45, s[48:49] sc1
    global_load_dwordx2 v[84:85], v46, s[48:49] sc1
    global_load_dwordx2 v[86:87], v47, s[48:49] sc1
    global_load_dwordx2 v[88:89], v48, s[48:49] sc1
    global_load_dwordx2 v[90:91], v49, s[48:49] sc1
    global_load_dwordx2 v[92:93], v50, s[48:49] sc1
    global_load_dwordx2 v[94:95], v51, s[48:49] sc1
    s_waitcnt vmcnt(12)
    v_bitop3_b32 v54, v65, v67, s50 bitop3:0x7e
    v_bitop3_b32 v55, v69, v71, s50 bitop3:0x7e
    v_or_b32 v54, v54, v55
    v_cmp_ne_u32 vcc, 0, v54
    s_nop 0
    s_cbranch_vccnz L_cfr_38
L_cfd_37:
    v_add_f32 v64, v64, v66
    v_add_f32 v68, v68, v70
    v_add_f32 v64, v64, v68
    v_cvt_pk_bf16_f32 v64, v64, v64
    v_lshlrev_b32 v65, 16, v64
    s_waitcnt vmcnt(8)
    v_bitop3_b32 v54, v73, v75, s50 bitop3:0x7e
    v_bitop3_b32 v55, v77, v79, s50 bitop3:0x7e
    v_or_b32 v54, v54, v55
    v_cmp_ne_u32 vcc, 0, v54
    s_nop 0
    s_cbranch_vccnz L_cfr_41
L_cfd_40:
    v_add_f32 v72, v72, v74
    v_add_f32 v76, v76, v78
    v_add_f32 v72, v72, v76
    v_cvt_pk_bf16_f32 v72, v72, v72
    v_lshlrev_b32 v73, 16, v72
    s_waitcnt vmcnt(4)
    v_bitop3_b32 v54, v81, v83, s50 bitop3:0x7e
    v_bitop3_b32 v55, v85, v87, s50 bitop3:0x7e
    v_or_b32 v54, v54, v55
    v_cmp_ne_u32 vcc, 0, v54
    s_nop 0
    s_cbranch_vccnz L_cfr_44
L_cfd_43:
    v_add_f32 v80, v80, v82
    v_add_f32 v84, v84, v86
    v_add_f32 v80, v80, v84
    v_cvt_pk_bf16_f32 v80, v80, v80
    v_lshlrev_b32 v81, 16, v80
    s_waitcnt vmcnt(0)
    v_bitop3_b32 v54, v89, v91, s50 bitop3:0x7e
    v_bitop3_b32 v55, v93, v95, s50 bitop3:0x7e
    v_or_b32 v54, v54, v55
    v_cmp_ne_u32 vcc, 0, v54
    s_nop 0
    s_cbranch_vccnz L_cfr_47
L_cfd_46:
    v_add_f32 v88, v88, v90
    v_add_f32 v92, v92, v94
    v_add_f32 v88, v88, v92
    v_cvt_pk_bf16_f32 v88, v88, v88
    v_lshlrev_b32 v89, 16, v88
    s_cmp_ge_u32 s2, 253
    s_cbranch_scc1 L_gb_34
    v_add_f32 v65, 1.0, v65
    v_cmp_le_u32 vcc, 640, v32
    v_cvt_pk_bf16_f32 v65, v65, v65
    v_lshlrev_b32 v36, 1, v32
    v_add_u32 v36, 237568, v36
    v_cndmask_b32 v64, v64, v65, vcc
    global_store_short v36, v64, s[48:49] sc1
    v_add_f32 v73, 1.0, v73
    v_cmp_le_u32 vcc, 640, v33
    v_cvt_pk_bf16_f32 v73, v73, v73
    v_lshlrev_b32 v37, 1, v33
    v_add_u32 v37, 237568, v37
    v_cndmask_b32 v72, v72, v73, vcc
    global_store_short v37, v72, s[48:49] sc1
    v_add_f32 v81, 1.0, v81
    v_cmp_le_u32 vcc, 640, v34
    v_cvt_pk_bf16_f32 v81, v81, v81
    v_lshlrev_b32 v38, 1, v34
    v_add_u32 v38, 237568, v38
    v_cndmask_b32 v80, v80, v81, vcc
    global_store_short v38, v80, s[48:49] sc1
    v_add_f32 v89, 1.0, v89
    v_cmp_le_u32 vcc, 640, v35
    v_cvt_pk_bf16_f32 v89, v89, v89
    v_lshlrev_b32 v39, 1, v35
    v_add_u32 v39, 237568, v39
    v_cndmask_b32 v88, v88, v89, vcc
    global_store_short v39, v88, s[48:49] sc1
    s_branch L_mvd_35
L_gb_34:
    v_lshlrev_b32 v36, 2, v32
    v_add_u32 v36, 235008, v36
    global_store_dword v36, v65, s[48:49] sc1
    v_lshlrev_b32 v37, 2, v33
    v_add_u32 v37, 235008, v37
    global_store_dword v37, v73, s[48:49] sc1
    v_lshlrev_b32 v38, 2, v34
    v_add_u32 v38, 235008, v38
    global_store_dword v38, v81, s[48:49] sc1
    v_lshlrev_b32 v39, 2, v35
    v_add_u32 v39, 235008, v39
    global_store_dword v39, v89, s[48:49] sc1
L_mvd_35:
    s_waitcnt vmcnt(0)
    s_sub_u32 s6, s2, 248
    s_lshl_b32 s88, s6, 5
    s_add_u32 s88, s88, 233472
    v_lshl_add_u32 v24, v1, 2, s88
    v_mov_b32 v25, s50
    s_mov_b64 exec, 0xff
    global_store_dword v24, v25, s[48:49] sc1
    s_mov_b64 exec, -1
L_nosl_31:
    s_mov_b32 s90, 0
    v_mov_b32 v22, 126028
L_ls_48:
    ds_read_b32 v23, v22
    s_add_u32 s90, s90, 1
    s_waitcnt lgkmcnt(0)
    v_cmp_ne_u32 vcc, 1, v23
    s_nop 0
    s_cbranch_vccz L_lsd_49
    s_cmp_gt_u32 s90, 1048576
    s_cbranch_scc0 L_ls_48
L_lsd_49:
    v_min_u32 v16, 41, v1
    v_lshlrev_b32 v16, 5, v16
    v_add_u32 v16, 207552, v16
    v_min_u32 v17, 213, v0
    v_lshlrev_b32 v17, 5, v17
    v_add_u32 v17, 69632, v17
    v_and_b32 v18, 7, v1
    v_lshlrev_b32 v18, 5, v18
    v_add_u32 v18, 233472, v18
    global_load_dwordx4 a[0:3], v2, s[64:65] offset:-4096 sc1
    global_load_dwordx4 a[4:7], v2, s[64:65] offset:-3072 sc1
    global_load_dwordx4 a[8:11], v2, s[64:65] offset:-2048 sc1
    global_load_dwordx4 a[12:15], v2, s[64:65] offset:-1024 sc1
    global_load_dwordx4 a[16:19], v2, s[64:65] offset:0 sc1
    global_load_dwordx4 a[20:23], v2, s[64:65] offset:1024 sc1
    global_load_dwordx4 a[24:27], v2, s[64:65] offset:2048 sc1
    global_load_dwordx4 a[28:31], v2, s[64:65] offset:3072 sc1
    s_add_u32 s64, s64, 8192
    s_addc_u32 s65, s65, 0
    s_nop 0
    global_load_dwordx4 a[32:35], v2, s[64:65] offset:-4096 sc1
    global_load_dwordx4 a[36:39], v2, s[64:65] offset:-3072 sc1
    global_load_dwordx4 a[40:43], v2, s[64:65] offset:-2048 sc1
    global_load_dwordx4 a[44:47], v2, s[64:65] offset:-1024 sc1
    global_load_dwordx4 a[48:51], v2, s[64:65] offset:0 sc1
    global_load_dwordx4 a[52:55], v2, s[64:65] offset:1024 sc1
    global_load_dwordx4 a[56:59], v2, s[64:65] offset:2048 sc1
    global_load_dwordx4 a[60:63], v2, s[64:65] offset:3072 sc1
    s_add_u32 s64, s64, 8192
    s_addc_u32 s65, s65, 0
    s_nop 0
    global_load_dwordx4 a[64:67], v2, s[64:65] offset:-4096 sc1
    global_load_dwordx4 a[68:71], v2, s[64:65] offset:-3072 sc1
    global_load_dwordx4 a[72:75], v2, s[64:65] offset:-2048 sc1
    global_load_dwordx4 a[76:79], v2, s[64:65] offset:-1024 sc1
    global_load_dwordx4 a[80:83], v2, s[64:65] offset:0 sc1
    global_load_dwordx4 a[84:87], v2, s[64:65] offset:1024 sc1
    global_load_dwordx4 a[88:91], v2, s[64:65] offset:2048 sc1
    global_load_dwordx4 a[92:95], v2, s[64:65] offset:3072 sc1
    s_add_u32 s64, s64, 8192
    s_addc_u32 s65, s65, 0
    s_nop 0
    global_load_dwordx4 a[96:99], v2, s[64:65] offset:-4096 sc1
    global_load_dwordx4 a[100:103], v2, s[64:65] offset:-3072 sc1
    global_load_dwordx4 a[104:107], v2, s[64:65] offset:-2048 sc1
    global_load_dwordx4 a[108:111], v2, s[64:65] offset:-1024 sc1
    global_load_dwordx4 a[112:115], v2, s[64:65] offset:0 sc1
    global_load_dwordx4 a[116:119], v2, s[64:65] offset:1024 sc1
    global_load_dwordx4 a[120:123], v2, s[64:65] offset:2048 sc1
    global_load_dwordx4 a[124:127], v2, s[64:65] offset:3072 sc1
    s_add_u32 s64, s64, 8192
    s_addc_u32 s65, s65, 0
    s_nop 0
    global_load_dwordx4 a[128:131], v2, s[64:65] offset:-4096 sc1
    global_load_dwordx4 a[132:135], v2, s[64:65] offset:-3072 sc1
    global_load_dwordx4 a[136:139], v2, s[64:65] offset:-2048 sc1
    global_load_dwordx4 a[140:143], v2, s[64:65] offset:-1024 sc1
    global_load_dwordx4 a[144:147], v2, s[64:65] offset:0 sc1
    global_load_dwordx4 a[148:151], v2, s[64:65] offset:1024 sc1
    global_load_dwordx4 a[152:155], v2, s[64:65] offset:2048 sc1
    global_load_dwordx4 a[156:159], v2, s[64:65] offset:3072 sc1
    s_add_u32 s64, s64, 8192
    s_addc_u32 s65, s65, 0
    s_nop 0
    global_load_dwordx4 a[160:163], v2, s[64:65] offset:-4096 sc1
    global_load_dwordx4 a[164:167], v2, s[64:65] offset:-3072 sc1
    global_load_dwordx4 a[168:171], v2, s[64:65] offset:-2048 sc1
    global_load_dwordx4 a[172:175], v2, s[64:65] offset:-1024 sc1
    global_load_dwordx4 a[176:179], v2, s[64:65] offset:0 sc1
    global_load_dwordx4 a[180:183], v2, s[64:65] offset:1024 sc1
    global_load_dwordx4 a[184:187], v2, s[64:65] offset:2048 sc1
    global_load_dwordx4 a[188:191], v2, s[64:65] offset:3072 sc1
    s_add_u32 s64, s64, 8192
    s_addc_u32 s65, s65, 0
    global_load_dwordx4 a[192:195], v2, s[64:65] offset:-4096 sc1
    global_load_dwordx4 a[196:199], v2, s[64:65] offset:-3072 sc1
    global_load_dwordx4 a[200:203], v2, s[64:65] offset:-2048 sc1
    v_min_u32 v13, 213, v0
    v_lshlrev_b32 v13, 5, v13
    v_add_u32 v13, 102400, v13
    v_lshrrev_b32 v12, 2, v1
    v_lshlrev_b32 v12, 6, v12
    v_bfe_u32 v4, v1, 4, 1
    v_lshl_add_u32 v12, v4, 5, v12
    v_and_b32 v4, 3, v1
    v_lshl_add_u32 v12, v4, 3, v12
    v_add_u32 v8, 45056, v12
    v_xor_b32 v9, 32, v8
    s_and_b32 s6, s3, 1
    s_lshl_b32 s6, s6, 5
    v_xor_b32 v10, s6, v12
    v_add_u32 v10, 113664, v10
    v_lshrrev_b32 v4, 4, v1
    s_lshl_b32 s6, s61, 12
    s_add_u32 s6, s6, 266240
    s_lshl_b32 s7, s3, 10
    s_add_u32 s6, s6, s7
    v_add_u32 v11, s6, v2
    v_and_b32 v5, 31, v1
    v_lshlrev_b32 v5, 3, v5
    s_lshl_b32 s6, s3, 8
    s_add_u32 s6, s6, 123904
    v_add_u32 v128, s6, v5
    v_lshrrev_b32_e64 v6, 5, v1
    v_lshl_add_u32 v129, v6, 9, v5
    v_add_u32 v129, 123904, v129
    s_mul_i32 s6, s62, 320
    s_add_u32 s6, s6, 240128
    v_lshl_add_u32 v6, v4, 4, s6
    v_bfe_u32 v5, v1, 3, 1
    v_mul_u32_u24 v5, 1280, v5
    v_sub_u32 v5, 128256, v5
    v_lshl_add_u32 v5, v4, 3, v5
    v_and_b32 v15, 1, v1
    s_lshl_b32 s6, s61, 3
    s_lshl_b32 s7, s3, 1
    s_add_u32 s6, s6, s7
    v_add_u32 v15, s6, v15
    v_lshlrev_b32 v15, 7, v15
    v_add_u32 v15, 135168, v15
    s_mul_i32 s88, s2, 37
    s_add_u32 s88, s88, 7
    s_and_b32 s88, s88, 127
    s_lshl_b32 s88, s88, 5
    s_add_u32 s88, s88, 69632
    v_mov_b32 v22, s88
    s_mov_b32 s90, 0
L_poll_51:
    global_load_dword v23, v22, s[48:49] offset:0 sc1
    s_add_u32 s90, s90, 1
    s_waitcnt vmcnt(0)
    v_cmp_ne_u32 vcc, s50, v23
    s_nop 0
    s_cbranch_vccz L_polld_52
    s_cmp_gt_u32 s90, 65536
    s_cbranch_scc1 L_polld_52
    s_sleep 6
    s_branch L_poll_51
L_polld_52:
    s_sleep 8
    s_mov_b32 s90, 0
L_poll_53:
    global_load_dword v20, v16, s[48:49] offset:0 sc1
    global_load_dword v21, v17, s[48:49] offset:0 sc1
    global_load_dword v22, v18, s[48:49] offset:0 sc1
    s_add_u32 s90, s90, 1
    s_waitcnt vmcnt(0)
    v_cmp_ne_u32 vcc, s50, v20
    v_cmp_ne_u32 s[88:89], s50, v21
    s_nop 0
    s_or_b64 vcc, vcc, s[88:89]
    v_cmp_ne_u32 s[88:89], s50, v22
    s_nop 0
    s_or_b64 vcc, vcc, s[88:89]
    s_nop 0
    s_cbranch_vccz L_polld_54
    s_cmp_gt_u32 s90, 65536
    s_cbranch_scc1 L_polld_54
    s_sleep 8
    s_branch L_poll_53
L_polld_54:
    s_cmp_lg_u32 s3, 3
    s_cbranch_scc1 L_n3_50
    s_add_u32 s86, s48, 237568
    s_addc_u32 s87, s49, 0
    s_mov_b32 m0, 126976
    s_nop 0
    global_load_lds_dwordx4 v2, s[86:87] sc1
    global_load_lds_dwordx4 v2, s[86:87] offset:1024 sc1
    global_load_lds_dwordx4 v2, s[86:87] offset:2048 sc1
L_n3_50:
    s_waitcnt vmcnt(0)
L_POST:
    v_mov_b32 v113, v128
    v_mov_b32 v114, v129
    s_barrier
    s_mul_i32 s10, s61, 40960
    s_add_u32 s10, s10, 0
    s_mul_i32 s11, s62, 5120
    s_add_u32 s11, s11, s10
    s_add_u32 s11, s11, 10485760
    s_add_u32 s82, s48, s11
    s_addc_u32 s83, s49, 0
    s_add_u32 s10, s10, 13107200
    s_add_u32 s76, s48, s10
    s_addc_u32 s77, s49, 0
    s_lshl_b32 s78, s3, 10
    v_lshlrev_b32 v3, 4, v0
    v_add_u32 v115, 2048, v2
    s_cmp_lg_u32 s3, 0
    s_cbranch_scc1 L_XP0
    s_mov_b32 m0, 115712
    s_nop 0
    global_load_lds_dwordx4 v115, s[82:83] offset:2048 sc1
L_XP0:
    s_add_u32 m0, s78, 113664
    s_nop 0
    global_load_lds_dwordx4 v3, s[82:83] sc1
    s_add_u32 m0, s78, 45056
    s_nop 0
    global_load_lds_dwordx4 v3, s[76:77] sc1
    s_add_u32 s76, s76, 4096
    s_addc_u32 s77, s77, 0
    s_add_u32 m0, s78, 49152
    s_nop 0
    global_load_lds_dwordx4 v3, s[76:77] sc1
    s_add_u32 s76, s76, 4096
    s_addc_u32 s77, s77, 0
    s_add_u32 m0, s78, 53248
    s_nop 0
    global_load_lds_dwordx4 v3, s[76:77] sc1
    s_add_u32 s76, s76, 4096
    s_addc_u32 s77, s77, 0
    s_add_u32 m0, s78, 57344
    s_nop 0
    global_load_lds_dwordx4 v3, s[76:77] sc1
    v_mov_b32 v106, 0
    v_mov_b32 v107, 0
    v_mov_b32 v108, 0x3f803f80
    v_mov_b32 v109, 0x3f803f80
    v_mov_b32 v110, 0x3f803f80
    v_mov_b32 v111, 0x3f803f80
    s_lshl_b32 s6, s63, 9
    s_add_u32 s6, s6, 266240
    s_and_b32 s7, s3, 1
    s_lshl_b32 s7, s7, 8
    s_add_u32 s6, s6, s7
    v_and_b32 v4, 15, v1
    v_lshl_add_u32 v4, v4, 4, s6
    v_and_b32 v14, 3, v1
    v_cmp_eq_u32 s[12:13], 1, v14
    v_cmp_eq_u32 s[14:15], 2, v14
    v_cmp_eq_u32 s[94:95], 3, v14
    ds_read_b64 v[64:65], v5 offset:0
    ds_read_b64 v[66:67], v5 offset:32
    ds_read_b64 v[68:69], v5 offset:64
    ds_read_b64 v[70:71], v5 offset:96
    ds_read_b64 v[72:73], v5 offset:128
    ds_read_b64 v[74:75], v5 offset:160
    ds_read_b64 v[76:77], v5 offset:192
    ds_read_b64 v[78:79], v5 offset:224
    s_waitcnt vmcnt(6)
    s_waitcnt lgkmcnt(6)
    v_mfma_f32_16x16x32_bf16 v[16:19], a[0:3], v[64:67], 0
    ds_read_b64 v[80:81], v5 offset:256
    ds_read_b64 v[82:83], v5 offset:288
    v_mfma_f32_16x16x32_bf16 v[20:23], a[4:7], v[64:67], 0
    v_mfma_f32_16x16x32_bf16 v[24:27], a[8:11], v[64:67], 0
    s_waitcnt lgkmcnt(6)
    v_mfma_f32_16x16x32_bf16 v[16:19], a[12:15], v[68:71], v[16:19]
    ds_read_b64 v[84:85], v5 offset:320
    ds_read_b64 v[86:87], v5 offset:352
    v_mfma_f32_16x16x32_bf16 v[20:23], a[16:19], v[68:71], v[20:23]
    v_mfma_f32_16x16x32_bf16 v[24:27], a[20:23], v[68:71], v[24:27]
    s_waitcnt lgkmcnt(6)
    v_mfma_f32_16x16x32_bf16 v[16:19], a[24:27], v[72:75], v[16:19]
    ds_read_b64 v[64:65], v5 offset:384
    ds_read_b64 v[66:67], v5 offset:416
    v_mfma_f32_16x16x32_bf16 v[20:23], a[28:31], v[72:75], v[20:23]
    v_mfma_f32_16x16x32_bf16 v[24:27], a[32:35], v[72:75], v[24:27]
    s_waitcnt lgkmcnt(6)
    v_mfma_f32_16x16x32_bf16 v[16:19], a[36:39], v[76:79], v[16:19]
    ds_read_b64 v[68:69], v5 offset:448
    ds_read_b64 v[70:71], v5 offset:480
    v_mfma_f32_16x16x32_bf16 v[20:23], a[40:43], v[76:79], v[20:23]
    v_mfma_f32_16x16x32_bf16 v[24:27], a[44:47], v[76:79], v[24:27]
    s_waitcnt lgkmcnt(6)
    v_mfma_f32_16x16x32_bf16 v[16:19], a[48:51], v[80:83], v[16:19]
    ds_read_b64 v[72:73], v5 offset:512
    ds_read_b64 v[74:75], v5 offset:544
    v_mfma_f32_16x16x32_bf16 v[20:23], a[52:55], v[80:83], v[20:23]
    s_add_u32 s76, s76, 4096
    s_addc_u32 s77, s77, 0
    s_add_u32 m0, s78, 61440
    v_mfma_f32_16x16x32_bf16 v[24:27], a[56:59], v[80:83], v[24:27]
    global_load_lds_dwordx4 v3, s[76:77] sc1
    s_waitcnt lgkmcnt(6)
    v_mfma_f32_16x16x32_bf16 v[16:19], a[60:63], v[84:87], v[16:19]
    ds_read_b64 v[76:77], v5 offset:576
    ds_read_b64 v[78:79], v5 offset:608
    v_mfma_f32_16x16x32_bf16 v[20:23], a[64:67], v[84:87], v[20:23]
    s_add_u32 s76, s76, 4096
    s_addc_u32 s77, s77, 0
    s_add_u32 m0, s78, 65536
    v_mfma_f32_16x16x32_bf16 v[24:27], a[68:71], v[84:87], v[24:27]
    global_load_lds_dwordx4 v3, s[76:77] sc1
    s_waitcnt lgkmcnt(6)
    v_mfma_f32_16x16x32_bf16 v[16:19], a[72:75], v[64:67], v[16:19]
    ds_read_b64 v[80:81], v5 offset:640
    ds_read_b64 v[82:83], v5 offset:672
    v_mfma_f32_16x16x32_bf16 v[20:23], a[76:79], v[64:67], v[20:23]
    s_add_u32 s76, s76, 4096
    s_addc_u32 s77, s77, 0
    s_add_u32 m0, s78, 69632
    v_mfma_f32_16x16x32_bf16 v[24:27], a[80:83], v[64:67], v[24:27]
    global_load_lds_dwordx4 v3, s[76:77] sc1
    s_waitcnt vmcnt(8)
    s_barrier
    s_cmp_lg_u32 s3, 3
    s_cbranch_scc1 L_fw_55
    s_lshl_b32 s88, s2, 5
    s_add_u32 s88, s88, 102400
    v_lshl_add_u32 v126, v1, 2, s88
    v_mov_b32 v127, s50
    s_mov_b64 exec, 0xff
    global_store_dword v126, v127, s[48:49] sc1
    s_mov_b64 exec, -1
L_fw_55:
    s_waitcnt lgkmcnt(6)
    v_mfma_f32_16x16x32_bf16 v[16:19], a[84:87], v[68:71], v[16:19]
    ds_read_b64 v[84:85], v5 offset:704
    ds_read_b64 v[86:87], v5 offset:736
    v_mfma_f32_16x16x32_bf16 v[20:23], a[88:91], v[68:71], v[20:23]
    s_add_u32 s76, s76, 4096
    s_addc_u32 s77, s77, 0
    s_add_u32 m0, s78, 73728
    v_mfma_f32_16x16x32_bf16 v[24:27], a[92:95], v[68:71], v[24:27]
    global_load_lds_dwordx4 v3, s[76:77] sc1
    s_waitcnt lgkmcnt(6)
    v_mfma_f32_16x16x32_bf16 v[16:19], a[96:99], v[72:75], v[16:19]
    ds_read_b64 v[64:65], v5 offset:768
    ds_read_b64 v[66:67], v5 offset:800
    v_mfma_f32_16x16x32_bf16 v[20:23], a[100:103], v[72:75], v[20:23]
    s_add_u32 s76, s76, 4096
    s_addc_u32 s77, s77, 0
    s_add_u32 m0, s78, 77824
    v_mfma_f32_16x16x32_bf16 v[24:27], a[104:107], v[72:75], v[24:27]
    global_load_lds_dwordx4 v3, s[76:77] sc1
    s_waitcnt lgkmcnt(6)
    v_mfma_f32_16x16x32_bf16 v[16:19], a[108:111], v[76:79], v[16:19]
    ds_read_b64 v[68:69], v5 offset:832
    ds_read_b64 v[70:71], v5 offset:864
    v_mfma_f32_16x16x32_bf16 v[20:23], a[112:115], v[76:79], v[20:23]
    s_add_u32 s76, s76, 4096
    s_addc_u32 s77, s77, 0
    s_add_u32 m0, s78, 81920
    v_mfma_f32_16x16x32_bf16 v[24:27], a[116:119], v[76:79], v[24:27]
    global_load_lds_dwordx4 v3, s[76:77] sc1
    s_waitcnt lgkmcnt(6)
    v_mfma_f32_16x16x32_bf16 v[16:19], a[120:123], v[80:83], v[16:19]
    ds_read_b64 v[72:73], v5 offset:896
    ds_read_b64 v[74:75], v5 offset:928
    v_mfma_f32_16x16x32_bf16 v[20:23], a[124:127], v[80:83], v[20:23]
    global_load_dwordx4 a[204:207], v2, s[64:65] offset:-1024 sc1
    v_mfma_f32_16x16x32_bf16 v[24:27], a[128:131], v[80:83], v[24:27]
    s_waitcnt lgkmcnt(6)
    v_mfma_f32_16x16x32_bf16 v[16:19], a[132:135], v[84:87], v[16:19]
    ds_read_b64 v[76:77], v5 offset:960
    ds_read_b64 v[78:79], v5 offset:992
    v_mfma_f32_16x16x32_bf16 v[20:23], a[136:139], v[84:87], v[20:23]
    v_mfma_f32_16x16x32_bf16 v[24:27], a[140:143], v[84:87], v[24:27]
    global_load_dwordx4 a[208:211], v2, s[64:65] offset:0 sc1
    s_waitcnt lgkmcnt(6)
    v_mfma_f32_16x16x32_bf16 v[16:19], a[144:147], v[64:67], v[16:19]
    ds_read_b64 v[80:81], v5 offset:1024
    ds_read_b64 v[82:83], v5 offset:1056
    v_mfma_f32_16x16x32_bf16 v[20:23], a[148:151], v[64:67], v[20:23]
    v_mfma_f32_16x16x32_bf16 v[24:27], a[152:155], v[64:67], v[24:27]
    global_load_dwordx4 a[212:215], v2, s[64:65] offset:1024 sc1
    s_waitcnt lgkmcnt(6)
    v_mfma_f32_16x16x32_bf16 v[16:19], a[156:159], v[68:71], v[16:19]
    v_mfma_f32_16x16x32_bf16 v[20:23], a[160:163], v[68:71], v[20:23]
    v_mfma_f32_16x16x32_bf16 v[24:27], a[164:167], v[68:71], v[24:27]
    s_waitcnt lgkmcnt(4)
    v_mfma_f32_16x16x32_bf16 v[16:19], a[168:171], v[72:75], v[16:19]
    global_load_dwordx4 a[216:219], v2, s[64:65] offset:2048 sc1
    v_mfma_f32_16x16x32_bf16 v[20:23], a[172:175], v[72:75], v[20:23]
    v_mfma_f32_16x16x32_bf16 v[24:27], a[176:179], v[72:75], v[24:27]
    s_waitcnt lgkmcnt(2)
    v_mfma_f32_16x16x32_bf16 v[16:19], a[180:183], v[76:79], v[16:19]
    v_mfma_f32_16x16x32_bf16 v[20:23], a[184:187], v[76:79], v[20:23]
    global_load_dwordx4 a[220:223], v2, s[64:65] offset:3072 sc1
    v_mfma_f32_16x16x32_bf16 v[24:27], a[188:191], v[76:79], v[24:27]
    s_waitcnt lgkmcnt(0)
    v_mfma_f32_16x16x32_bf16 v[16:19], a[192:195], v[80:83], v[16:19]
    v_mfma_f32_16x16x32_bf16 v[20:23], a[196:199], v[80:83], v[20:23]
    s_add_u32 s64, s64, 8192
    s_addc_u32 s65, s65, 0
    v_mfma_f32_16x16x32_bf16 v[24:27], a[200:203], v[80:83], v[24:27]
    global_load_dwordx4 a[224:227], v2, s[64:65] offset:-4096 sc1
    s_waitcnt vmcnt(14)
    s_barrier
    ds_read_b64_tr_b16 v[96:97], v10 offset:0
    ds_read_b64_tr_b16 v[98:99], v10 offset:1024
    ds_read_b64_tr_b16 v[100:101], v10 offset:2048
    ds_read_b64_tr_b16 v[102:103], v10 offset:3072
    ds_read_b64_tr_b16 v[104:105], v10 offset:4096
    global_load_dwordx4 a[228:231], v2, s[64:65] offset:-3072 sc1
    ds_read_b64_tr_b16 v[64:65], v8 offset:0
    ds_read_b64_tr_b16 v[66:67], v8 offset:1024
    ds_read_b64_tr_b16 v[68:69], v9 offset:0
    ds_read_b64_tr_b16 v[70:71], v9 offset:1024
    ds_read_b64_tr_b16 v[72:73], v8 offset:2048
    ds_read_b64_tr_b16 v[74:75], v8 offset:3072
    ds_read_b64_tr_b16 v[76:77], v9 offset:2048
    ds_read_b64_tr_b16 v[78:79], v9 offset:3072
    s_waitcnt lgkmcnt(8)
    v_mfma_f32_16x16x32_bf16 v[124:127], v[96:99], v[96:99], 0
    v_mfma_f32_16x16x32_bf16 v[120:123], v[108:111], v[96:99], 0
    v_mfma_f32_16x16x32_bf16 v[124:127], v[100:103], v[100:103], v[124:127]
    v_mfma_f32_16x16x32_bf16 v[120:123], v[108:111], v[100:103], v[120:123]
    v_mfma_f32_16x16x32_bf16 v[124:127], v[104:107], v[104:107], v[124:127]
    v_mfma_f32_16x16x32_bf16 v[120:123], v[108:111], v[104:107], v[120:123]
    s_waitcnt lgkmcnt(4)
    v_mfma_f32_16x16x32_bf16 v[40:43], a[0:3], v[64:67], 0
    ds_read_b64_tr_b16 v[80:81], v8 offset:4096
    v_mfma_f32_16x16x32_bf16 v[44:47], a[0:3], v[68:71], 0
    ds_read_b64_tr_b16 v[82:83], v8 offset:5120
    v_mfma_f32_16x16x32_bf16 v[48:51], a[4:7], v[64:67], 0
    ds_read_b64_tr_b16 v[84:85], v9 offset:4096
    v_mfma_f32_16x16x32_bf16 v[52:55], a[4:7], v[68:71], 0
    ds_read_b64_tr_b16 v[86:87], v9 offset:5120
    v_mfma_f32_16x16x32_bf16 v[56:59], a[8:11], v[64:67], 0
    v_cndmask_b32 v121, v124, v125, s[12:13]
    v_mov_b32 v122, s50
    s_mul_i32 s10, s61, 96
    s_mul_i32 s11, s62, 12
    s_add_u32 s10, s10, s11
    s_mul_i32 s11, s3, 3
    s_add_u32 s10, s10, s11
    s_lshl_b32 s10, s10, 10
    s_add_u32 s10, s10, 16777216
    s_add_u32 s80, s48, s10
    s_addc_u32 s81, s49, 0
    v_mfma_f32_16x16x32_bf16 v[60:63], a[8:11], v[68:71], 0
    v_cndmask_b32 v121, v121, v126, s[14:15]
    v_mov_b32 v123, s50
    s_waitcnt lgkmcnt(4)
    v_mfma_f32_16x16x32_bf16 v[40:43], a[12:15], v[72:75], v[40:43]
    ds_read_b64_tr_b16 v[88:89], v8 offset:6144
    v_cndmask_b32 v121, v121, v127, s[94:95]
    v_mfma_f32_16x16x32_bf16 v[44:47], a[12:15], v[76:79], v[44:47]
    ds_read_b64_tr_b16 v[90:91], v8 offset:7168
    s_mov_b32 exec_lo, 0x00f0000f
    s_mov_b32 exec_hi, 0xf0000f00
    global_store_dwordx4 v4, v[120:123], s[48:49] sc1
    s_mov_b64 exec, -1
    v_mfma_f32_16x16x32_bf16 v[48:51], a[16:19], v[72:75], v[48:51]
    ds_read_b64_tr_b16 v[92:93], v9 offset:6144
    v_mfma_f32_16x16x32_bf16 v[52:55], a[16:19], v[76:79], v[52:55]
    ds_read_b64_tr_b16 v[94:95], v9 offset:7168
    v_mfma_f32_16x16x32_bf16 v[56:59], a[20:23], v[72:75], v[56:59]
    global_load_dwordx4 a[232:235], v2, s[64:65] offset:-2048 sc1
    v_mfma_f32_16x16x32_bf16 v[60:63], a[20:23], v[76:79], v[60:63]
    global_load_dwordx4 a[236:239], v2, s[64:65] offset:-1024 sc1
    s_waitcnt lgkmcnt(4)
    v_mfma_f32_16x16x32_bf16 v[40:43], a[24:27], v[80:83], v[40:43]
    s_waitcnt vmcnt(15)
    s_barrier
    ds_read_b64_tr_b16 v[64:65], v8 offset:8192
    v_mfma_f32_16x16x32_bf16 v[44:47], a[24:27], v[84:87], v[44:47]
    ds_read_b64_tr_b16 v[66:67], v8 offset:9216
    v_mfma_f32_16x16x32_bf16 v[48:51], a[28:31], v[80:83], v[48:51]
    ds_read_b64_tr_b16 v[68:69], v9 offset:8192
    v_mfma_f32_16x16x32_bf16 v[52:55], a[28:31], v[84:87], v[52:55]
    ds_read_b64_tr_b16 v[70:71], v9 offset:9216
    v_mfma_f32_16x16x32_bf16 v[56:59], a[32:35], v[80:83], v[56:59]
    global_load_dwordx4 v[128:131], v2, s[66:67] offset:-4096 sc1
    v_mfma_f32_16x16x32_bf16 v[60:63], a[32:35], v[84:87], v[60:63]
    global_load_dwordx4 v[132:135], v2, s[66:67] offset:-3072 sc1
    s_waitcnt lgkmcnt(4)
    v_mfma_f32_16x16x32_bf16 v[40:43], a[36:39], v[88:91], v[40:43]
    ds_read_b64_tr_b16 v[72:73], v8 offset:10240
    v_mfma_f32_16x16x32_bf16 v[44:47], a[36:39], v[92:95], v[44:47]
    ds_read_b64_tr_b16 v[74:75], v8 offset:11264
    v_mfma_f32_16x16x32_bf16 v[48:51], a[40:43], v[88:91], v[48:51]
    ds_read_b64_tr_b16 v[76:77], v9 offset:10240
    v_mfma_f32_16x16x32_bf16 v[52:55], a[40:43], v[92:95], v[52:55]
    ds_read_b64_tr_b16 v[78:79], v9 offset:11264
    v_mfma_f32_16x16x32_bf16 v[56:59], a[44:47], v[88:91], v[56:59]
    global_load_dwordx4 v[136:139], v2, s[66:67] offset:-2048 sc1
    v_mfma_f32_16x16x32_bf16 v[60:63], a[44:47], v[92:95], v[60:63]
    global_load_dwordx4 v[140:143], v2, s[66:67] offset:-1024 sc1
    s_waitcnt lgkmcnt(4)
    v_mfma_f32_16x16x32_bf16 v[40:43], a[48:51], v[64:67], v[40:43]
    ds_read_b64_tr_b16 v[80:81], v8 offset:12288
    v_mfma_f32_16x16x32_bf16 v[44:47], a[48:51], v[68:71], v[44:47]
    ds_read_b64_tr_b16 v[82:83], v8 offset:13312
    v_mfma_f32_16x16x32_bf16 v[48:51], a[52:55], v[64:67], v[48:51]
    ds_read_b64_tr_b16 v[84:85], v9 offset:12288
    v_mfma_f32_16x16x32_bf16 v[52:55], a[52:55], v[68:71], v[52:55]
    ds_read_b64_tr_b16 v[86:87], v9 offset:13312
    v_mfma_f32_16x16x32_bf16 v[56:59], a[56:59], v[64:67], v[56:59]
    global_load_dwordx4 v[144:147], v2, s[66:67] offset:0 sc1
    v_mfma_f32_16x16x32_bf16 v[60:63], a[56:59], v[68:71], v[60:63]
    global_load_dwordx4 v[148:151], v2, s[66:67] offset:1024 sc1
    s_waitcnt lgkmcnt(4)
    v_mfma_f32_16x16x32_bf16 v[40:43], a[60:63], v[72:75], v[40:43]
    ds_read_b64_tr_b16 v[88:89], v8 offset:14336
    v_mfma_f32_16x16x32_bf16 v[44:47], a[60:63], v[76:79], v[44:47]
    ds_read_b64_tr_b16 v[90:91], v8 offset:15360
    v_mfma_f32_16x16x32_bf16 v[48:51], a[64:67], v[72:75], v[48:51]
    ds_read_b64_tr_b16 v[92:93], v9 offset:14336
    v_mfma_f32_16x16x32_bf16 v[52:55], a[64:67], v[76:79], v[52:55]
    ds_read_b64_tr_b16 v[94:95], v9 offset:15360
    v_mfma_f32_16x16x32_bf16 v[56:59], a[68:71], v[72:75], v[56:59]
    global_load_dwordx4 v[152:155], v2, s[66:67] offset:2048 sc1
    v_mfma_f32_16x16x32_bf16 v[60:63], a[68:71], v[76:79], v[60:63]
    global_load_dwordx4 v[156:159], v2, s[66:67] offset:3072 sc1
    s_waitcnt lgkmcnt(4)
    v_mfma_f32_16x16x32_bf16 v[40:43], a[72:75], v[80:83], v[40:43]
    ds_read_b64_tr_b16 v[64:65], v8 offset:16384
    v_mfma_f32_16x16x32_bf16 v[44:47], a[72:75], v[84:87], v[44:47]
    ds_read_b64_tr_b16 v[66:67], v8 offset:17408
    v_mfma_f32_16x16x32_bf16 v[48:51], a[76:79], v[80:83], v[48:51]
    ds_read_b64_tr_b16 v[68:69], v9 offset:16384
    v_mfma_f32_16x16x32_bf16 v[52:55], a[76:79], v[84:87], v[52:55]
    ds_read_b64_tr_b16 v[70:71], v9 offset:17408
    v_mfma_f32_16x16x32_bf16 v[56:59], a[80:83], v[80:83], v[56:59]
    s_add_u32 s66, s66, 8192
    s_addc_u32 s67, s67, 0
    v_mfma_f32_16x16x32_bf16 v[60:63], a[80:83], v[84:87], v[60:63]
    global_load_dwordx4 v[160:163], v2, s[66:67] offset:-4096 sc1
    s_waitcnt lgkmcnt(4)
    v_mfma_f32_16x16x32_bf16 v[40:43], a[84:87], v[88:91], v[40:43]
    ds_read_b64_tr_b16 v[72:73], v8 offset:18432
    v_mfma_f32_16x16x32_bf16 v[44:47], a[84:87], v[92:95], v[44:47]
    ds_read_b64_tr_b16 v[74:75], v8 offset:19456
    v_mfma_f32_16x16x32_bf16 v[48:51], a[88:91], v[88:91], v[48:51]
    ds_read_b64_tr_b16 v[76:77], v9 offset:18432
    v_mfma_f32_16x16x32_bf16 v[52:55], a[88:91], v[92:95], v[52:55]
    ds_read_b64_tr_b16 v[78:79], v9 offset:19456
    v_mfma_f32_16x16x32_bf16 v[56:59], a[92:95], v[88:91], v[56:59]
    global_load_dwordx4 v[164:167], v2, s[66:67] offset:-3072 sc1
    v_mfma_f32_16x16x32_bf16 v[60:63], a[92:95], v[92:95], v[60:63]
    global_load_dwordx4 v[168:171], v2, s[66:67] offset:-2048 sc1
    s_waitcnt lgkmcnt(4)
    v_mfma_f32_16x16x32_bf16 v[40:43], a[96:99], v[64:67], v[40:43]
    s_waitcnt vmcnt(21)
    s_barrier
    ds_read_b64_tr_b16 v[80:81], v8 offset:20480
    v_mfma_f32_16x16x32_bf16 v[44:47], a[96:99], v[68:71], v[44:47]
    ds_read_b64_tr_b16 v[82:83], v8 offset:21504
    v_mfma_f32_16x16x32_bf16 v[48:51], a[100:103], v[64:67], v[48:51]
    ds_read_b64_tr_b16 v[84:85], v9 offset:20480
    v_mfma_f32_16x16x32_bf16 v[52:55], a[100:103], v[68:71], v[52:55]
    ds_read_b64_tr_b16 v[86:87], v9 offset:21504
    v_mfma_f32_16x16x32_bf16 v[56:59], a[104:107], v[64:67], v[56:59]
    global_load_dwordx4 v[172:175], v2, s[66:67] offset:-1024 sc1
    v_mfma_f32_16x16x32_bf16 v[60:63], a[104:107], v[68:71], v[60:63]
    global_load_dwordx4 v[176:179], v2, s[66:67] offset:0 sc1
    s_waitcnt lgkmcnt(4)
    v_mfma_f32_16x16x32_bf16 v[40:43], a[108:111], v[72:75], v[40:43]
    ds_read_b64_tr_b16 v[88:89], v8 offset:22528
    global_load_dwordx4 v[96:99], v11, s[48:49] sc1
    v_mfma_f32_16x16x32_bf16 v[44:47], a[108:111], v[76:79], v[44:47]
    ds_read_b64_tr_b16 v[90:91], v8 offset:23552
    v_mfma_f32_16x16x32_bf16 v[48:51], a[112:115], v[72:75], v[48:51]
    ds_read_b64_tr_b16 v[92:93], v9 offset:22528
    v_mfma_f32_16x16x32_bf16 v[52:55], a[112:115], v[76:79], v[52:55]
    ds_read_b64_tr_b16 v[94:95], v9 offset:23552
    v_mfma_f32_16x16x32_bf16 v[56:59], a[116:119], v[72:75], v[56:59]
    global_load_dwordx4 v[180:183], v2, s[66:67] offset:1024 sc1
    v_mfma_f32_16x16x32_bf16 v[60:63], a[116:119], v[76:79], v[60:63]
    global_load_dwordx4 v[184:187], v2, s[66:67] offset:2048 sc1
    s_waitcnt lgkmcnt(4)
    v_mfma_f32_16x16x32_bf16 v[40:43], a[120:123], v[80:83], v[40:43]
    s_nop 0
    ds_read_b64_tr_b16 v[64:65], v8 offset:24576
    global_load_dword v112, v13, s[48:49] sc1
    v_mfma_f32_16x16x32_bf16 v[44:47], a[120:123], v[84:87], v[44:47]
    ds_read_b64_tr_b16 v[66:67], v8 offset:25600
    v_mfma_f32_16x16x32_bf16 v[48:51], a[124:127], v[80:83], v[48:51]
    ds_read_b64_tr_b16 v[68:69], v9 offset:24576
    s_mul_i32 s10, s61, 40960
    s_add_u32 s10, s10, 1310720
    s_mul_i32 s11, s62, 5120
    s_add_u32 s11, s11, s10
    s_add_u32 s11, s11, 10485760
    s_add_u32 s82, s48, s11
    s_addc_u32 s83, s49, 0
    s_add_u32 s10, s10, 13107200
    s_add_u32 s76, s48, s10
    s_addc_u32 s77, s49, 0
    s_lshl_b32 s78, s3, 10
    v_lshlrev_b32 v3, 4, v0
    v_add_u32 v115, 2048, v2
    v_mfma_f32_16x16x32_bf16 v[52:55], a[124:127], v[84:87], v[52:55]
    ds_read_b64_tr_b16 v[70:71], v9 offset:25600
    v_mfma_f32_16x16x32_bf16 v[56:59], a[128:131], v[80:83], v[56:59]
    global_load_dwordx4 v[188:191], v2, s[66:67] offset:3072 sc1
    v_mfma_f32_16x16x32_bf16 v[60:63], a[128:131], v[84:87], v[60:63]
    s_waitcnt lgkmcnt(4)
    v_mfma_f32_16x16x32_bf16 v[40:43], a[132:135], v[88:91], v[40:43]
    ds_read_b64_tr_b16 v[72:73], v8 offset:26624
    v_mfma_f32_16x16x32_bf16 v[44:47], a[132:135], v[92:95], v[44:47]
    ds_read_b64_tr_b16 v[74:75], v8 offset:27648
    v_mfma_f32_16x16x32_bf16 v[48:51], a[136:139], v[88:91], v[48:51]
    ds_read_b64_tr_b16 v[76:77], v9 offset:26624
    v_mfma_f32_16x16x32_bf16 v[52:55], a[136:139], v[92:95], v[52:55]
    ds_read_b64_tr_b16 v[78:79], v9 offset:27648
    v_mfma_f32_16x16x32_bf16 v[56:59], a[140:143], v[88:91], v[56:59]
    s_add_u32 s66, s66, 8192
    s_addc_u32 s67, s67, 0
    v_mfma_f32_16x16x32_bf16 v[60:63], a[140:143], v[92:95], v[60:63]
    global_load_dwordx4 v[192:195], v2, s[66:67] offset:-4096 sc1
    s_waitcnt lgkmcnt(4)
    v_mfma_f32_16x16x32_bf16 v[40:43], a[144:147], v[64:67], v[40:43]
    ds_read_b64_tr_b16 v[80:81], v8 offset:28672
    v_mfma_f32_16x16x32_bf16 v[44:47], a[144:147], v[68:71], v[44:47]
    ds_read_b64_tr_b16 v[82:83], v8 offset:29696
    v_mfma_f32_16x16x32_bf16 v[48:51], a[148:151], v[64:67], v[48:51]
    ds_read_b64_tr_b16 v[84:85], v9 offset:28672
    v_mfma_f32_16x16x32_bf16 v[52:55], a[148:151], v[68:71], v[52:55]
    ds_read_b64_tr_b16 v[86:87], v9 offset:29696
    v_mfma_f32_16x16x32_bf16 v[56:59], a[152:155], v[64:67], v[56:59]
    global_load_dwordx4 v[196:199], v2, s[66:67] offset:-3072 sc1
    v_mfma_f32_16x16x32_bf16 v[60:63], a[152:155], v[68:71], v[60:63]
    global_load_dwordx4 v[200:203], v2, s[66:67] offset:-2048 sc1
    s_waitcnt lgkmcnt(4)
    v_mfma_f32_16x16x32_bf16 v[40:43], a[156:159], v[72:75], v[40:43]
    ds_read_b64_tr_b16 v[88:89], v8 offset:30720
    v_mfma_f32_16x16x32_bf16 v[44:47], a[156:159], v[76:79], v[44:47]
    ds_read_b64_tr_b16 v[90:91], v8 offset:31744
    v_mfma_f32_16x16x32_bf16 v[48:51], a[160:163], v[72:75], v[48:51]
    ds_read_b64_tr_b16 v[92:93], v9 offset:30720
    v_mfma_f32_16x16x32_bf16 v[52:55], a[160:163], v[76:79], v[52:55]
    ds_read_b64_tr_b16 v[94:95], v9 offset:31744
    v_mfma_f32_16x16x32_bf16 v[56:59], a[164:167], v[72:75], v[56:59]
    global_load_dwordx4 v[204:207], v2, s[66:67] offset:-1024 sc1
    v_mfma_f32_16x16x32_bf16 v[60:63], a[164:167], v[76:79], v[60:63]
    global_load_dwordx4 v[208:211], v2, s[66:67] offset:0 sc1
    s_waitcnt lgkmcnt(4)
    v_mfma_f32_16x16x32_bf16 v[40:43], a[168:171], v[80:83], v[40:43]
    ds_read_b64_tr_b16 v[64:65], v8 offset:32768
    v_mfma_f32_16x16x32_bf16 v[44:47], a[168:171], v[84:87], v[44:47]
    ds_read_b64_tr_b16 v[66:67], v8 offset:33792
    v_mfma_f32_16x16x32_bf16 v[48:51], a[172:175], v[80:83], v[48:51]
    ds_read_b64_tr_b16 v[68:69], v9 offset:32768
    v_mfma_f32_16x16x32_bf16 v[52:55], a[172:175], v[84:87], v[52:55]
    ds_read_b64_tr_b16 v[70:71], v9 offset:33792
    v_mfma_f32_16x16x32_bf16 v[56:59], a[176:179], v[80:83], v[56:59]
    s_waitcnt vmcnt(9)
    v_cmp_ne_u32 vcc, s50, v98
    s_nop 0
    s_cbranch_vccnz L_cfr_58
L_cfd_57:
    v_mov_b32 v98, v96
    v_mfma_f32_16x16x32_bf16 v[60:63], a[176:179], v[84:87], v[60:63]
    v_mov_b32 v99, v97
    v_permlane32_swap_b32 v96, v98
    s_waitcnt lgkmcnt(4)
    v_mfma_f32_16x16x32_bf16 v[40:43], a[180:183], v[88:91], v[40:43]
    ds_read_b64_tr_b16 v[72:73], v8 offset:34816
    v_permlane32_swap_b32 v97, v99
    v_mfma_f32_16x16x32_bf16 v[44:47], a[180:183], v[92:95], v[44:47]
    ds_read_b64_tr_b16 v[74:75], v8 offset:35840
    v_add_f32 v96, v96, v98
    v_add_f32 v97, v97, v99
    v_mfma_f32_16x16x32_bf16 v[48:51], a[184:187], v[88:91], v[48:51]
    ds_read_b64_tr_b16 v[76:77], v9 offset:34816
    ds_write_b64 v113, v[96:97]
    v_mfma_f32_16x16x32_bf16 v[52:55], a[184:187], v[92:95], v[52:55]
    ds_read_b64_tr_b16 v[78:79], v9 offset:35840
    v_mfma_f32_16x16x32_bf16 v[56:59], a[188:191], v[88:91], v[56:59]
    global_load_dwordx4 v[212:215], v2, s[66:67] offset:1024 sc1
    v_mfma_f32_16x16x32_bf16 v[60:63], a[188:191], v[92:95], v[60:63]
    global_load_dwordx4 v[216:219], v2, s[66:67] offset:2048 sc1
    s_waitcnt lgkmcnt(5)
    v_mfma_f32_16x16x32_bf16 v[40:43], a[192:195], v[64:67], v[40:43]
    ds_read_b64_tr_b16 v[80:81], v8 offset:36864
    v_mfma_f32_16x16x32_bf16 v[44:47], a[192:195], v[68:71], v[44:47]
    ds_read_b64_tr_b16 v[82:83], v8 offset:37888
    s_waitcnt vmcnt(8)
    v_cmp_ne_u32 vcc, s50, v112
    s_nop 0
    s_cbranch_vccnz L_cfr_61
L_cfd_60:
    s_waitcnt lgkmcnt(3)
    s_barrier
    ds_read2_b64 v[96:99], v114 offset0:0 offset1:32
    s_cmp_lg_u32 s3, 0
    s_cbranch_scc1 L_XP1
    s_mov_b32 m0, 120832
    s_nop 0
    global_load_lds_dwordx4 v115, s[82:83] offset:2048 sc1
L_XP1:
    s_add_u32 m0, s78, 118784
    s_nop 0
    global_load_lds_dwordx4 v3, s[82:83] sc1
    s_add_u32 m0, s78, 4096
    s_nop 0
    global_load_lds_dwordx4 v3, s[76:77] sc1
    v_mfma_f32_16x16x32_bf16 v[48:51], a[196:199], v[64:67], v[48:51]
    ds_read_b64_tr_b16 v[84:85], v9 offset:36864
    v_mfma_f32_16x16x32_bf16 v[52:55], a[196:199], v[68:71], v[52:55]
    ds_read_b64_tr_b16 v[86:87], v9 offset:37888
    v_mfma_f32_16x16x32_bf16 v[56:59], a[200:203], v[64:67], v[56:59]
    ds_read_b64 v[124:125], v5 offset:1088
    ds_read_b64 v[126:127], v5 offset:1120
    v_mfma_f32_16x16x32_bf16 v[60:63], a[200:203], v[68:71], v[60:63]
    s_add_u32 s76, s76, 4096
    s_addc_u32 s77, s77, 0
    s_add_u32 m0, s78, 8192
    s_waitcnt lgkmcnt(7)
    v_mfma_f32_16x16x32_bf16 v[40:43], a[204:207], v[72:75], v[40:43]
    ds_read_b64_tr_b16 v[88:89], v8 offset:38912
    v_mfma_f32_16x16x32_bf16 v[44:47], a[204:207], v[76:79], v[44:47]
    ds_read_b64_tr_b16 v[90:91], v8 offset:39936
    s_waitcnt lgkmcnt(6)
    v_add_f32 v96, v96, v98
    v_mfma_f32_16x16x32_bf16 v[48:51], a[208:211], v[72:75], v[48:51]
    ds_read_b64_tr_b16 v[92:93], v9 offset:38912
    v_add_f32 v97, v97, v99
    v_mov_b32 v98, v96
    v_mfma_f32_16x16x32_bf16 v[52:55], a[208:211], v[76:79], v[52:55]
    ds_read_b64_tr_b16 v[94:95], v9 offset:39936
    v_mov_b32 v99, v97
    v_permlane32_swap_b32 v96, v98
    v_mfma_f32_16x16x32_bf16 v[56:59], a[212:215], v[72:75], v[56:59]
    ds_read_b64 v[120:121], v5 offset:1152
    ds_read_b64 v[122:123], v5 offset:1184
    v_permlane32_swap_b32 v97, v99
    v_mfma_f32_16x16x32_bf16 v[60:63], a[212:215], v[76:79], v[60:63]
    v_add_f32 v96, v96, v98
    v_add_f32 v97, v97, v99
    s_waitcnt lgkmcnt(6)
    v_mfma_f32_16x16x32_bf16 v[16:19], a[204:207], v[124:127], v[16:19]
    global_load_lds_dwordx4 v3, s[76:77] sc1
    v_mfma_f32_16x16x32_bf16 v[20:23], a[208:211], v[124:127], v[20:23]
    s_add_u32 s76, s76, 4096
    s_addc_u32 s77, s77, 0
    s_add_u32 m0, s78, 12288
    v_mfma_f32_16x16x32_bf16 v[24:27], a[212:215], v[124:127], v[24:27]
    global_load_lds_dwordx4 v3, s[76:77] sc1
    v_mfma_f32_16x16x32_bf16 v[40:43], a[216:219], v[80:83], v[40:43]
    v_mul_f32 v96, 0x3acccccd, v96
    v_mul_f32 v97, 0x3acccccd, v97
    v_mfma_f32_16x16x32_bf16 v[44:47], a[216:219], v[84:87], v[44:47]
    v_fma_f32 v97, -v96, v96, v97
    v_mfma_f32_16x16x32_bf16 v[48:51], a[220:223], v[80:83], v[48:51]
    v_max_f32 v97, 0, v97
    v_cvt_pk_bf16_f32 v104, -v96, v97
    v_mfma_f32_16x16x32_bf16 v[52:55], a[220:223], v[84:87], v[52:55]
    v_and_b32 v97, 0xffff0000, v104
    v_lshlrev_b32 v116, 16, v104
    v_mfma_f32_16x16x32_bf16 v[56:59], a[224:227], v[80:83], v[56:59]
    ds_read_b64 v[124:125], v5 offset:1216
    ds_read_b64 v[126:127], v5 offset:1248
    v_add_f32 v97, 0x3727c5ac, v97
    v_mfma_f32_16x16x32_bf16 v[60:63], a[224:227], v[84:87], v[60:63]
    v_cvt_pk_bf16_f32 v97, v97, v97
    v_lshlrev_b32 v97, 16, v97
    s_waitcnt lgkmcnt(2)
    v_mfma_f32_16x16x32_bf16 v[16:19], a[216:219], v[120:123], v[16:19]
    s_add_u32 s76, s76, 4096
    s_addc_u32 s77, s77, 0
    s_add_u32 m0, s78, 16384
    v_mfma_f32_16x16x32_bf16 v[20:23], a[220:223], v[120:123], v[20:23]
    global_load_lds_dwordx4 v3, s[76:77] sc1
    v_mfma_f32_16x16x32_bf16 v[24:27], a[224:227], v[120:123], v[24:27]
    s_add_u32 s76, s76, 4096
    s_addc_u32 s77, s77, 0
    s_add_u32 m0, s78, 20480
    v_mfma_f32_16x16x32_bf16 v[40:43], a[228:231], v[88:91], v[40:43]
    v_sqrt_f32 v97, v97
    v_mov_b32 v118, v116
    v_mfma_f32_16x16x32_bf16 v[44:47], a[228:231], v[92:95], v[44:47]
    v_cvt_pk_bf16_f32 v97, v97, v97
    v_mfma_f32_16x16x32_bf16 v[48:51], a[232:235], v[88:91], v[48:51]
    v_lshlrev_b32 v97, 16, v97
    v_rcp_f32 v117, v97
    v_mfma_f32_16x16x32_bf16 v[52:55], a[232:235], v[92:95], v[52:55]
    v_permlane16_swap_b32 v116, v118
    v_mov_b32 v119, v117
    v_mfma_f32_16x16x32_bf16 v[56:59], a[236:239], v[88:91], v[56:59]
    s_nop 0
    v_permlane16_swap_b32 v117, v119
    v_mfma_f32_16x16x32_bf16 v[60:63], a[236:239], v[92:95], v[60:63]
    global_load_lds_dwordx4 v3, s[76:77] sc1
    s_waitcnt lgkmcnt(0)
    v_mfma_f32_16x16x32_bf16 v[16:19], a[228:231], v[124:127], v[16:19]
    s_add_u32 s76, s76, 4096
    s_addc_u32 s77, s77, 0
    s_add_u32 m0, s78, 24576
    v_mfma_f32_16x16x32_bf16 v[20:23], a[232:235], v[124:127], v[20:23]
    global_load_lds_dwordx4 v3, s[76:77] sc1
    v_mfma_f32_16x16x32_bf16 v[24:27], a[236:239], v[124:127], v[24:27]
    s_add_u32 s76, s76, 4096
    s_addc_u32 s77, s77, 0
    s_add_u32 m0, s78, 28672
    s_nop 0
    global_load_lds_dwordx4 v3, s[76:77] sc1
    v_add_u32 v8, 4096, v12
    s_add_u32 s76, s76, 4096
    s_addc_u32 s77, s77, 0
    s_add_u32 m0, s78, 32768
    s_nop 0
    global_load_lds_dwordx4 v3, s[76:77] sc1
    v_xor_b32 v9, 32, v8
    s_add_u32 s76, s76, 4096
    s_addc_u32 s77, s77, 0
    s_add_u32 m0, s78, 36864
    s_nop 0
    global_load_lds_dwordx4 v3, s[76:77] sc1
    v_add_u32 v11, 131072, v11
    v_mov_b32 v28, v16
    v_mov_b32 v29, v17
    v_mov_b32 v30, v18
    v_mov_b32 v31, v19
    v_mov_b32 v32, v20
    v_mov_b32 v33, v21
    v_mov_b32 v34, v22
    v_mov_b32 v35, v23
    v_mov_b32 v36, v24
    v_mov_b32 v37, v25
    v_mov_b32 v38, v26
    v_mov_b32_e64 v39, v27
    s_add_u32 s76, s76, 4096
    s_addc_u32 s77, s77, 0
    s_add_u32 m0, s78, 40960
    s_nop 0
    global_load_lds_dwordx4 v3, s[76:77] sc1
    v_mov_b32_dpp v28, v16 row_shl:8 row_mask:0xf bank_mask:0xf
    v_mov_b32_dpp v29, v17 row_shl:8 row_mask:0xf bank_mask:0xf
    v_mov_b32_dpp v30, v18 row_shl:8 row_mask:0xf bank_mask:0xf
    v_mov_b32_dpp v31, v19 row_shl:8 row_mask:0xf bank_mask:0xf
    v_mov_b32_dpp v32, v20 row_shl:8 row_mask:0xf bank_mask:0xf
    v_mov_b32_dpp v33, v21 row_shl:8 row_mask:0xf bank_mask:0xf
    v_mov_b32_dpp v34, v22 row_shl:8 row_mask:0xf bank_mask:0xf
    v_mov_b32_dpp v35, v23 row_shl:8 row_mask:0xf bank_mask:0xf
    v_mov_b32_dpp v36, v24 row_shl:8 row_mask:0xf bank_mask:0xf
    v_mov_b32_dpp v37, v25 row_shl:8 row_mask:0xf bank_mask:0xf
    v_mov_b32_dpp v38, v26 row_shl:8 row_mask:0xf bank_mask:0xf
    v_mov_b32_dpp v39, v27 row_shl:8 row_mask:0xf bank_mask:0xf
    v_mov_b32_dpp v16, v16 row_shr:8 row_mask:0xf bank_mask:0xf
    v_mov_b32_dpp v17, v17 row_shr:8 row_mask:0xf bank_mask:0xf
    global_load_dwordx4 v[220:223], v2, s[66:67] offset:3072 sc1
    v_mov_b32_dpp v18, v18 row_shr:8 row_mask:0xf bank_mask:0xf
    v_mov_b32_dpp v19, v19 row_shr:8 row_mask:0xf bank_mask:0xf
    v_mov_b32_dpp v20, v20 row_shr:8 row_mask:0xf bank_mask:0xf
    v_mov_b32_dpp v21, v21 row_shr:8 row_mask:0xf bank_mask:0xf
    v_mov_b32_dpp v22, v22 row_shr:8 row_mask:0xf bank_mask:0xf
    v_mov_b32_dpp v23, v23 row_shr:8 row_mask:0xf bank_mask:0xf
    v_mov_b32_dpp v24, v24 row_shr:8 row_mask:0xf bank_mask:0xf
    v_mov_b32_dpp v25, v25 row_shr:8 row_mask:0xf bank_mask:0xf
    v_mov_b32_dpp v26, v26 row_shr:8 row_mask:0xf bank_mask:0xf
    v_mov_b32_dpp v27, v27 row_shr:8 row_mask:0xf bank_mask:0xf
    s_mov_b32 s8, 0xbfb8aa3b
    v_pk_fma_f32 v[40:41], v[16:17], v[116:117], v[40:41] op_sel_hi:[1,0,1]
    v_pk_fma_f32 v[42:43], v[18:19], v[116:117], v[42:43] op_sel_hi:[1,0,1]
    v_pk_fma_f32 v[44:45], v[16:17], v[118:119], v[44:45] op_sel_hi:[1,0,1]
    s_add_u32 s66, s66, 8192
    s_addc_u32 s67, s67, 0
    s_nop 0
    global_load_dwordx4 v[224:227], v2, s[66:67] offset:-4096 sc1
    v_pk_fma_f32 v[46:47], v[18:19], v[118:119], v[46:47] op_sel_hi:[1,0,1]
    v_pk_fma_f32 v[40:41], v[40:41], v[116:117], v[28:29] op_sel:[0,1,0] op_sel_hi:[1,1,1]
    v_pk_fma_f32 v[42:43], v[42:43], v[116:117], v[30:31] op_sel:[0,1,0] op_sel_hi:[1,1,1]
    v_pk_fma_f32 v[44:45], v[44:45], v[118:119], v[28:29] op_sel:[0,1,0] op_sel_hi:[1,1,1]
    v_pk_fma_f32 v[46:47], v[46:47], v[118:119], v[30:31] op_sel:[0,1,0] op_sel_hi:[1,1,1]
    v_pk_mul_f32 v[64:65], v[40:41], s[8:9] op_sel_hi:[1,0]
    v_pk_mul_f32 v[66:67], v[42:43], s[8:9] op_sel_hi:[1,0]
    v_pk_mul_f32 v[68:69], v[44:45], s[8:9] op_sel_hi:[1,0]
    v_pk_mul_f32 v[70:71], v[46:47], s[8:9] op_sel_hi:[1,0]
    v_exp_f32 v64, v64
    v_exp_f32 v65, v65
    v_exp_f32 v66, v66
    global_load_dwordx4 v[228:231], v2, s[66:67] offset:-3072 sc1
    v_exp_f32 v67, v67
    v_exp_f32 v68, v68
    v_exp_f32 v69, v69
    v_exp_f32 v70, v70
    v_exp_f32 v71, v71
    v_pk_add_f32 v[64:65], v[64:65], 1.0 op_sel_hi:[1,0]
    v_pk_add_f32 v[66:67], v[66:67], 1.0 op_sel_hi:[1,0]
    v_pk_add_f32 v[68:69], v[68:69], 1.0 op_sel_hi:[1,0]
    global_load_dwordx4 v[232:235], v2, s[66:67] offset:-2048 sc1
    v_pk_add_f32 v[70:71], v[70:71], 1.0 op_sel_hi:[1,0]
    v_rcp_f32 v64, v64
    v_rcp_f32 v65, v65
    v_rcp_f32 v66, v66
    v_rcp_f32 v67, v67
    v_rcp_f32 v68, v68
    v_rcp_f32 v69, v69
    v_rcp_f32 v70, v70
    global_load_dwordx4 v[236:239], v2, s[66:67] offset:-1024 sc1
    v_rcp_f32 v71, v71
    v_pk_mul_f32 v[64:65], v[64:65], v[40:41]
    v_pk_mul_f32 v[66:67], v[66:67], v[42:43]
    v_pk_mul_f32 v[68:69], v[68:69], v[44:45]
    v_pk_mul_f32 v[70:71], v[70:71], v[46:47]
    v_cvt_pk_bf16_f32 v80, v64, v65
    v_cvt_pk_bf16_f32 v81, v66, v67
    v_cvt_pk_bf16_f32 v82, v68, v69
    v_cvt_pk_bf16_f32 v83, v70, v71
    global_store_dwordx4 v2, v[80:83], s[80:81] offset:0 sc1
    v_pk_fma_f32 v[48:49], v[20:21], v[116:117], v[48:49] op_sel_hi:[1,0,1]
    v_pk_fma_f32 v[50:51], v[22:23], v[116:117], v[50:51] op_sel_hi:[1,0,1]
    v_pk_fma_f32 v[52:53], v[20:21], v[118:119], v[52:53] op_sel_hi:[1,0,1]
    v_pk_fma_f32 v[54:55], v[22:23], v[118:119], v[54:55] op_sel_hi:[1,0,1]
    v_pk_fma_f32 v[48:49], v[48:49], v[116:117], v[32:33] op_sel:[0,1,0] op_sel_hi:[1,1,1]
    v_pk_fma_f32 v[50:51], v[50:51], v[116:117], v[34:35] op_sel:[0,1,0] op_sel_hi:[1,1,1]
    v_pk_fma_f32 v[52:53], v[52:53], v[118:119], v[32:33] op_sel:[0,1,0] op_sel_hi:[1,1,1]
    v_pk_fma_f32 v[54:55], v[54:55], v[118:119], v[34:35] op_sel:[0,1,0] op_sel_hi:[1,1,1]
    v_pk_mul_f32 v[72:73], v[48:49], s[8:9] op_sel_hi:[1,0]
    v_pk_mul_f32 v[74:75], v[50:51], s[8:9] op_sel_hi:[1,0]
    v_pk_mul_f32 v[76:77], v[52:53], s[8:9] op_sel_hi:[1,0]
    v_pk_mul_f32 v[78:79], v[54:55], s[8:9] op_sel_hi:[1,0]
    v_exp_f32 v72, v72
    v_exp_f32 v73, v73
    v_exp_f32 v74, v74
    global_load_dwordx4 v[240:243], v2, s[66:67] offset:0 sc1
    v_exp_f32 v75, v75
    v_exp_f32 v76, v76
    v_exp_f32 v77, v77
    v_exp_f32 v78, v78
    v_exp_f32 v79, v79
    v_pk_add_f32 v[72:73], v[72:73], 1.0 op_sel_hi:[1,0]
    v_pk_add_f32 v[74:75], v[74:75], 1.0 op_sel_hi:[1,0]
    v_pk_add_f32 v[76:77], v[76:77], 1.0 op_sel_hi:[1,0]
    global_load_dwordx4 v[244:247], v2, s[66:67] offset:1024 sc1
    v_pk_add_f32 v[78:79], v[78:79], 1.0 op_sel_hi:[1,0]
    v_rcp_f32 v72, v72
    v_rcp_f32 v73, v73
    v_rcp_f32 v74, v74
    v_rcp_f32 v75, v75
    v_rcp_f32 v76, v76
    v_rcp_f32 v77, v77
    v_rcp_f32 v78, v78
    global_load_dwordx4 v[248:251], v2, s[66:67] offset:2048 sc1
    v_rcp_f32 v79, v79
    v_pk_mul_f32 v[72:73], v[72:73], v[48:49]
    v_pk_mul_f32 v[74:75], v[74:75], v[50:51]
    v_pk_mul_f32 v[76:77], v[76:77], v[52:53]
    v_pk_mul_f32 v[78:79], v[78:79], v[54:55]
    v_cvt_pk_bf16_f32 v84, v72, v73
    v_cvt_pk_bf16_f32 v85, v74, v75
    v_cvt_pk_bf16_f32 v86, v76, v77
    v_cvt_pk_bf16_f32 v87, v78, v79
    global_store_dwordx4 v2, v[84:87], s[80:81] offset:1024 sc1
    v_pk_fma_f32 v[56:57], v[24:25], v[116:117], v[56:57] op_sel_hi:[1,0,1]
    v_pk_fma_f32 v[58:59], v[26:27], v[116:117], v[58:59] op_sel_hi:[1,0,1]
    v_pk_fma_f32 v[60:61], v[24:25], v[118:119], v[60:61] op_sel_hi:[1,0,1]
    v_pk_fma_f32 v[62:63], v[26:27], v[118:119], v[62:63] op_sel_hi:[1,0,1]
    v_pk_fma_f32 v[56:57], v[56:57], v[116:117], v[36:37] op_sel:[0,1,0] op_sel_hi:[1,1,1]
    v_pk_fma_f32 v[58:59], v[58:59], v[116:117], v[38:39] op_sel:[0,1,0] op_sel_hi:[1,1,1]
    v_pk_fma_f32 v[60:61], v[60:61], v[118:119], v[36:37] op_sel:[0,1,0] op_sel_hi:[1,1,1]
    v_pk_fma_f32 v[62:63], v[62:63], v[118:119], v[38:39] op_sel:[0,1,0] op_sel_hi:[1,1,1]
    v_pk_mul_f32 v[64:65], v[56:57], s[8:9] op_sel_hi:[1,0]
    v_pk_mul_f32 v[66:67], v[58:59], s[8:9] op_sel_hi:[1,0]
    v_pk_mul_f32 v[68:69], v[60:61], s[8:9] op_sel_hi:[1,0]
    v_pk_mul_f32 v[70:71], v[62:63], s[8:9] op_sel_hi:[1,0]
    v_exp_f32 v64, v64
    v_exp_f32 v65, v65
    v_exp_f32 v66, v66
    global_load_dwordx4 v[252:255], v2, s[66:67] offset:3072 sc1
    v_exp_f32 v67, v67
    v_exp_f32 v68, v68
    v_exp_f32 v69, v69
    v_exp_f32 v70, v70
    v_exp_f32 v71, v71
    v_pk_add_f32 v[64:65], v[64:65], 1.0 op_sel_hi:[1,0]
    v_pk_add_f32 v[66:67], v[66:67], 1.0 op_sel_hi:[1,0]
    v_pk_add_f32 v[68:69], v[68:69], 1.0 op_sel_hi:[1,0]
    v_pk_add_f32 v[70:71], v[70:71], 1.0 op_sel_hi:[1,0]
    v_rcp_f32 v64, v64
    v_rcp_f32 v65, v65
    v_rcp_f32 v66, v66
    v_rcp_f32 v67, v67
    v_rcp_f32 v68, v68
    v_rcp_f32 v69, v69
    v_rcp_f32 v70, v70
    v_rcp_f32 v71, v71
    v_pk_mul_f32 v[64:65], v[64:65], v[56:57]
    v_pk_mul_f32 v[66:67], v[66:67], v[58:59]
    v_pk_mul_f32 v[68:69], v[68:69], v[60:61]
    v_pk_mul_f32 v[70:71], v[70:71], v[62:63]
    v_cvt_pk_bf16_f32 v88, v64, v65
    v_cvt_pk_bf16_f32 v89, v66, v67
    v_cvt_pk_bf16_f32 v90, v68, v69
    v_cvt_pk_bf16_f32 v91, v70, v71
    global_store_dwordx4 v2, v[88:91], s[80:81] offset:2048 sc1
    v_mov_b32 v106, 0
    v_mov_b32 v107, 0
    v_mov_b32 v108, 0x3f803f80
    v_mov_b32 v109, 0x3f803f80
    v_mov_b32 v110, 0x3f803f80
    v_mov_b32 v111, 0x3f803f80
    s_lshl_b32 s6, s63, 9
    s_add_u32 s6, s6, 397312
    s_and_b32 s7, s3, 1
    s_lshl_b32 s7, s7, 8
    s_add_u32 s6, s6, s7
    v_and_b32 v4, 15, v1
    v_lshl_add_u32 v4, v4, 4, s6
    v_and_b32 v14, 3, v1
    v_cmp_eq_u32 s[12:13], 1, v14
    v_cmp_eq_u32 s[14:15], 2, v14
    v_cmp_eq_u32 s[94:95], 3, v14
    s_waitcnt vmcnt(20)
    s_barrier
    ds_read_b64_tr_b16 v[96:97], v10 offset:5120
    ds_read_b64_tr_b16 v[98:99], v10 offset:6144
    ds_read_b64_tr_b16 v[100:101], v10 offset:7168
    ds_read_b64_tr_b16 v[102:103], v10 offset:8192
    ds_read_b64_tr_b16 v[104:105], v10 offset:9216
    ds_read_b64_tr_b16 v[64:65], v8 offset:0
    ds_read_b64_tr_b16 v[66:67], v8 offset:1024
    ds_read_b64_tr_b16 v[68:69], v9 offset:0
    ds_read_b64_tr_b16 v[70:71], v9 offset:1024
    ds_read_b64_tr_b16 v[72:73], v8 offset:2048
    ds_read_b64_tr_b16 v[74:75], v8 offset:3072
    ds_read_b64_tr_b16 v[76:77], v9 offset:2048
    ds_read_b64_tr_b16 v[78:79], v9 offset:3072
    s_waitcnt lgkmcnt(8)
    v_mfma_f32_16x16x32_bf16 v[124:127], v[96:99], v[96:99], 0
    v_mfma_f32_16x16x32_bf16 v[120:123], v[108:111], v[96:99], 0
    v_mfma_f32_16x16x32_bf16 v[124:127], v[100:103], v[100:103], v[124:127]
    v_mfma_f32_16x16x32_bf16 v[120:123], v[108:111], v[100:103], v[120:123]
    v_mfma_f32_16x16x32_bf16 v[124:127], v[104:107], v[104:107], v[124:127]
    v_mfma_f32_16x16x32_bf16 v[120:123], v[108:111], v[104:107], v[120:123]
    s_waitcnt lgkmcnt(4)
    v_mfma_f32_16x16x32_bf16 v[40:43], a[0:3], v[64:67], 0
    ds_read_b64_tr_b16 v[80:81], v8 offset:4096
    v_mfma_f32_16x16x32_bf16 v[44:47], a[0:3], v[68:71], 0
    ds_read_b64_tr_b16 v[82:83], v8 offset:5120
    v_mfma_f32_16x16x32_bf16 v[48:51], a[4:7], v[64:67], 0
    ds_read_b64_tr_b16 v[84:85], v9 offset:4096
    s_mul_i32 s10, s61, 96
    s_mul_i32 s11, s3, 24
    s_add_u32 s10, s10, s11
    s_lshl_b32 s10, s10, 10
    s_add_u32 s10, s10, 16777216
    s_add_u32 s68, s48, s10
    s_addc_u32 s69, s49, 0
    s_mul_i32 s70, s3, 24576
    v_mfma_f32_16x16x32_bf16 v[52:55], a[4:7], v[68:71], 0
    ds_read_b64_tr_b16 v[86:87], v9 offset:5120
    v_mfma_f32_16x16x32_bf16 v[56:59], a[8:11], v[64:67], 0
    v_cndmask_b32 v121, v124, v125, s[12:13]
    v_mov_b32 v122, s50
    s_mul_i32 s10, s61, 96
    s_mul_i32 s11, s62, 12
    s_add_u32 s10, s10, s11
    s_mul_i32 s11, s3, 3
    s_add_u32 s10, s10, s11
    s_lshl_b32 s10, s10, 10
    s_add_u32 s10, s10, 19922944
    s_add_u32 s84, s48, s10
    s_addc_u32 s85, s49, 0
    v_mfma_f32_16x16x32_bf16 v[60:63], a[8:11], v[68:71], 0
    v_cndmask_b32 v121, v121, v126, s[14:15]
    v_mov_b32_e64 v123, s50
    s_waitcnt lgkmcnt(4)
    v_mfma_f32_16x16x32_bf16 v[40:43], a[12:15], v[72:75], v[40:43]
    ds_read_b64_tr_b16 v[88:89], v8 offset:6144
    v_cndmask_b32 v121, v121, v127, s[94:95]
    v_mfma_f32_16x16x32_bf16 v[44:47], a[12:15], v[76:79], v[44:47]
    ds_read_b64_tr_b16 v[90:91], v8 offset:7168
    s_mov_b32 exec_lo, 0x00f0000f
    s_mov_b32 exec_hi, 0xf0000f00
    global_store_dwordx4 v4, v[120:123], s[48:49] sc1
    s_mov_b64 exec, -1
    v_mfma_f32_16x16x32_bf16 v[48:51], a[16:19], v[72:75], v[48:51]
    ds_read_b64_tr_b16 v[92:93], v9 offset:6144
    v_mfma_f32_16x16x32_bf16 v[52:55], a[16:19], v[76:79], v[52:55]
    ds_read_b64_tr_b16 v[94:95], v9 offset:7168
    v_mfma_f32_16x16x32_bf16 v[56:59], a[20:23], v[72:75], v[56:59]
    s_add_u32 s66, s66, 8192
    s_addc_u32 s67, s67, 0
    v_mfma_f32_16x16x32_bf16 v[60:63], a[20:23], v[76:79], v[60:63]
    s_waitcnt lgkmcnt(4)
    v_mfma_f32_16x16x32_bf16 v[40:43], a[24:27], v[80:83], v[40:43]
    s_waitcnt vmcnt(18)
    s_barrier
    ds_read_b64_tr_b16 v[64:65], v8 offset:8192
    v_mfma_f32_16x16x32_bf16 v[44:47], a[24:27], v[84:87], v[44:47]
    ds_read_b64_tr_b16 v[66:67], v8 offset:9216
    v_mfma_f32_16x16x32_bf16 v[48:51], a[28:31], v[80:83], v[48:51]
    ds_read_b64_tr_b16 v[68:69], v9 offset:8192
    v_mfma_f32_16x16x32_bf16 v[52:55], a[28:31], v[84:87], v[52:55]
    ds_read_b64_tr_b16 v[70:71], v9 offset:9216
    v_mfma_f32_16x16x32_bf16 v[56:59], a[32:35], v[80:83], v[56:59]
    global_load_dwordx4 a[0:3], v2, s[66:67] offset:-4096 sc1
    v_mfma_f32_16x16x32_bf16 v[60:63], a[32:35], v[84:87], v[60:63]
    s_waitcnt lgkmcnt(4)
    v_mfma_f32_16x16x32_bf16 v[40:43], a[36:39], v[88:91], v[40:43]
    ds_read_b64_tr_b16 v[72:73], v8 offset:10240
    v_mfma_f32_16x16x32_bf16 v[44:47], a[36:39], v[92:95], v[44:47]
    ds_read_b64_tr_b16 v[74:75], v8 offset:11264
    v_mfma_f32_16x16x32_bf16 v[48:51], a[40:43], v[88:91], v[48:51]
    ds_read_b64_tr_b16 v[76:77], v9 offset:10240
    v_mfma_f32_16x16x32_bf16 v[52:55], a[40:43], v[92:95], v[52:55]
    ds_read_b64_tr_b16 v[78:79], v9 offset:11264
    v_mfma_f32_16x16x32_bf16 v[56:59], a[44:47], v[88:91], v[56:59]
    global_load_dwordx4 a[4:7], v2, s[66:67] offset:-3072 sc1
    v_mfma_f32_16x16x32_bf16 v[60:63], a[44:47], v[92:95], v[60:63]
    s_waitcnt lgkmcnt(4)
    v_mfma_f32_16x16x32_bf16 v[40:43], a[48:51], v[64:67], v[40:43]
    ds_read_b64_tr_b16 v[80:81], v8 offset:12288
    v_mfma_f32_16x16x32_bf16 v[44:47], a[48:51], v[68:71], v[44:47]
    ds_read_b64_tr_b16 v[82:83], v8 offset:13312
    v_mfma_f32_16x16x32_bf16 v[48:51], a[52:55], v[64:67], v[48:51]
    ds_read_b64_tr_b16 v[84:85], v9 offset:12288
    v_mfma_f32_16x16x32_bf16 v[52:55], a[52:55], v[68:71], v[52:55]
    ds_read_b64_tr_b16 v[86:87], v9 offset:13312
    v_mfma_f32_16x16x32_bf16 v[56:59], a[56:59], v[64:67], v[56:59]
    global_load_dwordx4 a[8:11], v2, s[66:67] offset:-2048 sc1
    v_mfma_f32_16x16x32_bf16 v[60:63], a[56:59], v[68:71], v[60:63]
    s_waitcnt lgkmcnt(4)
    v_mfma_f32_16x16x32_bf16 v[40:43], a[60:63], v[72:75], v[40:43]
    ds_read_b64_tr_b16 v[88:89], v8 offset:14336
    v_mfma_f32_16x16x32_bf16 v[44:47], a[60:63], v[76:79], v[44:47]
    ds_read_b64_tr_b16 v[90:91], v8 offset:15360
    v_mfma_f32_16x16x32_bf16 v[48:51], a[64:67], v[72:75], v[48:51]
    ds_read_b64_tr_b16 v[92:93], v9 offset:14336
    v_mfma_f32_16x16x32_bf16 v[52:55], a[64:67], v[76:79], v[52:55]
    ds_read_b64_tr_b16 v[94:95], v9 offset:15360
    v_mfma_f32_16x16x32_bf16 v[56:59], a[68:71], v[72:75], v[56:59]
    global_load_dwordx4 a[12:15], v2, s[66:67] offset:-1024 sc1
    v_mfma_f32_16x16x32_bf16 v[60:63], a[68:71], v[76:79], v[60:63]
    s_waitcnt lgkmcnt(4)
    v_mfma_f32_16x16x32_bf16 v[40:43], a[72:75], v[80:83], v[40:43]
    ds_read_b64_tr_b16 v[64:65], v8 offset:16384
    v_mfma_f32_16x16x32_bf16 v[44:47], a[72:75], v[84:87], v[44:47]
    ds_read_b64_tr_b16 v[66:67], v8 offset:17408
    v_mfma_f32_16x16x32_bf16 v[48:51], a[76:79], v[80:83], v[48:51]
    ds_read_b64_tr_b16 v[68:69], v9 offset:16384
    v_mfma_f32_16x16x32_bf16 v[52:55], a[76:79], v[84:87], v[52:55]
    ds_read_b64_tr_b16 v[70:71], v9 offset:17408
    v_mfma_f32_16x16x32_bf16 v[56:59], a[80:83], v[80:83], v[56:59]
    global_load_dwordx4 a[16:19], v2, s[66:67] offset:0 sc1
    v_mfma_f32_16x16x32_bf16 v[60:63], a[80:83], v[84:87], v[60:63]
    s_waitcnt lgkmcnt(4)
    v_mfma_f32_16x16x32_bf16 v[40:43], a[84:87], v[88:91], v[40:43]
    ds_read_b64_tr_b16 v[72:73], v8 offset:18432
    v_mfma_f32_16x16x32_bf16 v[44:47], a[84:87], v[92:95], v[44:47]
    ds_read_b64_tr_b16 v[74:75], v8 offset:19456
    v_mfma_f32_16x16x32_bf16 v[48:51], a[88:91], v[88:91], v[48:51]
    ds_read_b64_tr_b16 v[76:77], v9 offset:18432
    v_mfma_f32_16x16x32_bf16 v[52:55], a[88:91], v[92:95], v[52:55]
    ds_read_b64_tr_b16 v[78:79], v9 offset:19456
    v_mfma_f32_16x16x32_bf16 v[56:59], a[92:95], v[88:91], v[56:59]
    global_load_dwordx4 a[20:23], v2, s[66:67] offset:1024 sc1
    v_mfma_f32_16x16x32_bf16 v[60:63], a[92:95], v[92:95], v[60:63]
    s_waitcnt lgkmcnt(4)
    v_mfma_f32_16x16x32_bf16 v[40:43], a[96:99], v[64:67], v[40:43]
    s_waitcnt vmcnt(19)
    s_barrier
    ds_read_b64_tr_b16 v[80:81], v8 offset:20480
    v_mfma_f32_16x16x32_bf16 v[44:47], a[96:99], v[68:71], v[44:47]
    ds_read_b64_tr_b16 v[82:83], v8 offset:21504
    v_mfma_f32_16x16x32_bf16 v[48:51], a[100:103], v[64:67], v[48:51]
    ds_read_b64_tr_b16 v[84:85], v9 offset:20480
    v_mfma_f32_16x16x32_bf16 v[52:55], a[100:103], v[68:71], v[52:55]
    ds_read_b64_tr_b16 v[86:87], v9 offset:21504
    v_mfma_f32_16x16x32_bf16 v[56:59], a[104:107], v[64:67], v[56:59]
    global_load_dwordx4 a[24:27], v2, s[66:67] offset:2048 sc1
    v_mfma_f32_16x16x32_bf16 v[60:63], a[104:107], v[68:71], v[60:63]
    s_waitcnt lgkmcnt(4)
    v_mfma_f32_16x16x32_bf16 v[40:43], a[108:111], v[72:75], v[40:43]
    ds_read_b64_tr_b16 v[88:89], v8 offset:22528
    global_load_dwordx4 v[96:99], v11, s[48:49] sc1
    s_waitcnt vmcnt(9)
    s_barrier
    s_cmp_lg_u32 s3, 3
    s_cbranch_scc1 L_fw_62
    s_lshl_b32 s88, s63, 7
    s_add_u32 s88, s88, 135168
    v_lshl_add_u32 v126, v1, 2, s88
    v_mov_b32 v127, s50
    s_mov_b32 exec_hi, 0
    global_store_dword v126, v127, s[48:49] sc1
    s_mov_b64 exec, -1
L_fw_62:
    v_mfma_f32_16x16x32_bf16 v[44:47], a[108:111], v[76:79], v[44:47]
    ds_read_b64_tr_b16 v[90:91], v8 offset:23552
    v_mfma_f32_16x16x32_bf16 v[48:51], a[112:115], v[72:75], v[48:51]
    ds_read_b64_tr_b16 v[92:93], v9 offset:22528
    v_mfma_f32_16x16x32_bf16 v[52:55], a[112:115], v[76:79], v[52:55]
    ds_read_b64_tr_b16 v[94:95], v9 offset:23552
    v_mfma_f32_16x16x32_bf16 v[56:59], a[116:119], v[72:75], v[56:59]
    global_load_dwordx4 a[28:31], v2, s[66:67] offset:3072 sc1
    v_mfma_f32_16x16x32_bf16 v[60:63], a[116:119], v[76:79], v[60:63]
    s_waitcnt lgkmcnt(4)
    v_mfma_f32_16x16x32_bf16 v[40:43], a[120:123], v[80:83], v[40:43]
    ds_read_b64_tr_b16 v[64:65], v8 offset:24576
    v_mfma_f32_16x16x32_bf16 v[44:47], a[120:123], v[84:87], v[44:47]
    ds_read_b64_tr_b16 v[66:67], v8 offset:25600
    v_mfma_f32_16x16x32_bf16 v[48:51], a[124:127], v[80:83], v[48:51]
    ds_read_b64_tr_b16 v[68:69], v9 offset:24576
    v_mfma_f32_16x16x32_bf16 v[52:55], a[124:127], v[84:87], v[52:55]
    ds_read_b64_tr_b16 v[70:71], v9 offset:25600
    v_mfma_f32_16x16x32_bf16 v[56:59], a[128:131], v[80:83], v[56:59]
    s_add_u32 s66, s66, 8192
    s_addc_u32 s67, s67, 0
    v_mfma_f32_16x16x32_bf16 v[60:63], a[128:131], v[84:87], v[60:63]
    global_load_dwordx4 a[32:35], v2, s[66:67] offset:-4096 sc1
    s_waitcnt lgkmcnt(4)
    v_mfma_f32_16x16x32_bf16 v[40:43], a[132:135], v[88:91], v[40:43]
    ds_read_b64_tr_b16 v[72:73], v8 offset:26624
    v_mfma_f32_16x16x32_bf16 v[44:47], a[132:135], v[92:95], v[44:47]
    ds_read_b64_tr_b16 v[74:75], v8 offset:27648
    v_mfma_f32_16x16x32_bf16 v[48:51], a[136:139], v[88:91], v[48:51]
    ds_read_b64_tr_b16 v[76:77], v9 offset:26624
    v_mfma_f32_16x16x32_bf16 v[52:55], a[136:139], v[92:95], v[52:55]
    ds_read_b64_tr_b16 v[78:79], v9 offset:27648
    v_mfma_f32_16x16x32_bf16 v[56:59], a[140:143], v[88:91], v[56:59]
    global_load_dwordx4 a[36:39], v2, s[66:67] offset:-3072 sc1
    v_mfma_f32_16x16x32_bf16 v[60:63], a[140:143], v[92:95], v[60:63]
    global_load_dwordx4 a[40:43], v2, s[66:67] offset:-2048 sc1
    s_waitcnt lgkmcnt(4)
    v_mfma_f32_16x16x32_bf16 v[40:43], a[144:147], v[64:67], v[40:43]
    ds_read_b64_tr_b16 v[80:81], v8 offset:28672
    v_mfma_f32_16x16x32_bf16 v[44:47], a[144:147], v[68:71], v[44:47]
    ds_read_b64_tr_b16 v[82:83], v8 offset:29696
    v_mfma_f32_16x16x32_bf16 v[48:51], a[148:151], v[64:67], v[48:51]
    ds_read_b64_tr_b16 v[84:85], v9 offset:28672
    v_mfma_f32_16x16x32_bf16 v[52:55], a[148:151], v[68:71], v[52:55]
    ds_read_b64_tr_b16 v[86:87], v9 offset:29696
    v_mfma_f32_16x16x32_bf16 v[56:59], a[152:155], v[64:67], v[56:59]
    global_load_dwordx4 a[44:47], v2, s[66:67] offset:-1024 sc1
    v_mfma_f32_16x16x32_bf16 v[60:63], a[152:155], v[68:71], v[60:63]
    global_load_dwordx4 a[48:51], v2, s[66:67] offset:0 sc1
    s_waitcnt lgkmcnt(4)
    v_mfma_f32_16x16x32_bf16 v[40:43], a[156:159], v[72:75], v[40:43]
    ds_read_b64_tr_b16 v[88:89], v8 offset:30720
    v_mfma_f32_16x16x32_bf16 v[44:47], a[156:159], v[76:79], v[44:47]
    ds_read_b64_tr_b16 v[90:91], v8 offset:31744
    v_mfma_f32_16x16x32_bf16 v[48:51], a[160:163], v[72:75], v[48:51]
    ds_read_b64_tr_b16 v[92:93], v9 offset:30720
    v_mfma_f32_16x16x32_bf16 v[52:55], a[160:163], v[76:79], v[52:55]
    ds_read_b64_tr_b16 v[94:95], v9 offset:31744
    v_mfma_f32_16x16x32_bf16 v[56:59], a[164:167], v[72:75], v[56:59]
    global_load_dwordx4 a[52:55], v2, s[66:67] offset:1024 sc1
    v_mfma_f32_16x16x32_bf16 v[60:63], a[164:167], v[76:79], v[60:63]
    global_load_dwordx4 a[56:59], v2, s[66:67] offset:2048 sc1
    s_waitcnt lgkmcnt(4)
    v_mfma_f32_16x16x32_bf16 v[40:43], a[168:171], v[80:83], v[40:43]
    ds_read_b64_tr_b16 v[64:65], v8 offset:32768
    v_mfma_f32_16x16x32_bf16 v[44:47], a[168:171], v[84:87], v[44:47]
    ds_read_b64_tr_b16 v[66:67], v8 offset:33792
    v_mfma_f32_16x16x32_bf16 v[48:51], a[172:175], v[80:83], v[48:51]
    ds_read_b64_tr_b16 v[68:69], v9 offset:32768
    v_mfma_f32_16x16x32_bf16 v[52:55], a[172:175], v[84:87], v[52:55]
    ds_read_b64_tr_b16 v[70:71], v9 offset:33792
    v_mfma_f32_16x16x32_bf16 v[56:59], a[176:179], v[80:83], v[56:59]
    s_waitcnt vmcnt(8)
    v_cmp_ne_u32 vcc, s50, v98
    s_nop 0
    s_cbranch_vccnz L_cfr_65
L_cfd_64:
    v_mov_b32 v98, v96
    v_mfma_f32_16x16x32_bf16 v[60:63], a[176:179], v[84:87], v[60:63]
    v_mov_b32 v99, v97
    v_permlane32_swap_b32 v96, v98
    s_waitcnt lgkmcnt(4)
    v_mfma_f32_16x16x32_bf16 v[40:43], a[180:183], v[88:91], v[40:43]
    ds_read_b64_tr_b16 v[72:73], v8 offset:34816
    v_permlane32_swap_b32 v97, v99
    v_mfma_f32_16x16x32_bf16 v[44:47], a[180:183], v[92:95], v[44:47]
    ds_read_b64_tr_b16 v[74:75], v8 offset:35840
    v_add_f32 v96, v96, v98
    v_add_f32 v97, v97, v99
    v_mfma_f32_16x16x32_bf16 v[48:51], a[184:187], v[88:91], v[48:51]
    ds_read_b64_tr_b16 v[76:77], v9 offset:34816
    ds_write_b64 v113, v[96:97]
    v_mfma_f32_16x16x32_bf16 v[52:55], a[184:187], v[92:95], v[52:55]
    ds_read_b64_tr_b16 v[78:79], v9 offset:35840
    v_mfma_f32_16x16x32_bf16 v[56:59], a[188:191], v[88:91], v[56:59]
    global_load_dwordx4 a[60:63], v2, s[66:67] offset:3072 sc1
    v_mfma_f32_16x16x32_bf16 v[60:63], a[188:191], v[92:95], v[60:63]
    s_add_u32 s66, s66, 8192
    s_addc_u32 s67, s67, 0
    s_waitcnt lgkmcnt(5)
    v_mfma_f32_16x16x32_bf16 v[40:43], a[192:195], v[64:67], v[40:43]
    ds_read_b64_tr_b16 v[80:81], v8 offset:36864
    v_mfma_f32_16x16x32_bf16 v[44:47], a[192:195], v[68:71], v[44:47]
    ds_read_b64_tr_b16 v[82:83], v8 offset:37888
    s_waitcnt lgkmcnt(3)
    s_barrier
    ds_read2_b64 v[96:99], v114 offset0:0 offset1:32
    v_mfma_f32_16x16x32_bf16 v[48:51], a[196:199], v[64:67], v[48:51]
    ds_read_b64_tr_b16 v[84:85], v9 offset:36864
    v_mfma_f32_16x16x32_bf16 v[52:55], a[196:199], v[68:71], v[52:55]
    ds_read_b64_tr_b16 v[86:87], v9 offset:37888
    v_mfma_f32_16x16x32_bf16 v[56:59], a[200:203], v[64:67], v[56:59]
    global_load_dwordx4 a[64:67], v2, s[66:67] offset:-4096 sc1
    v_mfma_f32_16x16x32_bf16 v[60:63], a[200:203], v[68:71], v[60:63]
    global_load_dwordx4 a[68:71], v2, s[66:67] offset:-3072 sc1
    s_waitcnt lgkmcnt(5)
    v_mfma_f32_16x16x32_bf16 v[40:43], a[204:207], v[72:75], v[40:43]
    ds_read_b64_tr_b16 v[88:89], v8 offset:38912
    v_mfma_f32_16x16x32_bf16 v[44:47], a[204:207], v[76:79], v[44:47]
    ds_read_b64_tr_b16 v[90:91], v8 offset:39936
    s_waitcnt lgkmcnt(4)
    v_add_f32 v96, v96, v98
    v_mfma_f32_16x16x32_bf16 v[48:51], a[208:211], v[72:75], v[48:51]
    ds_read_b64_tr_b16 v[92:93], v9 offset:38912
    v_add_f32 v97, v97, v99
    v_mov_b32 v98, v96
    v_mfma_f32_16x16x32_bf16 v[52:55], a[208:211], v[76:79], v[52:55]
    ds_read_b64_tr_b16 v[94:95], v9 offset:39936
    v_mov_b32 v99, v97
    v_permlane32_swap_b32 v96, v98
    v_mfma_f32_16x16x32_bf16 v[56:59], a[212:215], v[72:75], v[56:59]
    v_permlane32_swap_b32 v97, v99
    v_mfma_f32_16x16x32_bf16 v[60:63], a[212:215], v[76:79], v[60:63]
    v_add_f32 v96, v96, v98
    v_add_f32 v97, v97, v99
    s_waitcnt lgkmcnt(4)
    v_mfma_f32_16x16x32_bf16 v[40:43], a[216:219], v[80:83], v[40:43]
    v_mul_f32 v96, 0x3acccccd, v96
    v_mul_f32 v97, 0x3acccccd, v97
    v_mfma_f32_16x16x32_bf16 v[44:47], a[216:219], v[84:87], v[44:47]
    v_fma_f32 v97, -v96, v96, v97
    v_mfma_f32_16x16x32_bf16 v[48:51], a[220:223], v[80:83], v[48:51]
    v_max_f32 v97, 0, v97
    v_cvt_pk_bf16_f32 v104, -v96, v97
    v_mfma_f32_16x16x32_bf16 v[52:55], a[220:223], v[84:87], v[52:55]
    v_and_b32 v97, 0xffff0000, v104
    v_lshlrev_b32 v116, 16, v104
    v_mfma_f32_16x16x32_bf16 v[56:59], a[224:227], v[80:83], v[56:59]
    v_add_f32 v97, 0x3727c5ac, v97
    v_mfma_f32_16x16x32_bf16 v[60:63], a[224:227], v[84:87], v[60:63]
    v_cvt_pk_bf16_f32 v97, v97, v97
    v_lshlrev_b32 v97, 16, v97
    s_waitcnt lgkmcnt(0)
    v_mfma_f32_16x16x32_bf16 v[40:43], a[228:231], v[88:91], v[40:43]
    v_sqrt_f32 v97, v97
    v_mov_b32 v118, v116
    v_mfma_f32_16x16x32_bf16 v[44:47], a[228:231], v[92:95], v[44:47]
    v_cvt_pk_bf16_f32 v97, v97, v97
    v_mfma_f32_16x16x32_bf16 v[48:51], a[232:235], v[88:91], v[48:51]
    v_lshlrev_b32 v97, 16, v97
    v_rcp_f32 v117, v97
    v_mfma_f32_16x16x32_bf16 v[52:55], a[232:235], v[92:95], v[52:55]
    v_permlane16_swap_b32 v116, v118
    v_mov_b32_e64 v119, v117
    v_mfma_f32_16x16x32_bf16 v[56:59], a[236:239], v[88:91], v[56:59]
    s_nop 0
    v_permlane16_swap_b32 v117, v119
    v_mfma_f32_16x16x32_bf16 v[60:63], a[236:239], v[92:95], v[60:63]
    global_load_dword v112, v15, s[48:49] sc1
    s_barrier
    s_mov_b32 s8, 0xbfb8aa3b
    v_pk_fma_f32 v[40:41], v[16:17], v[116:117], v[40:41] op_sel_hi:[1,0,1]
    global_load_dwordx4 a[72:75], v2, s[66:67] offset:-2048 sc1
    v_pk_fma_f32 v[42:43], v[18:19], v[116:117], v[42:43] op_sel_hi:[1,0,1]
    global_load_dwordx4 a[76:79], v2, s[66:67] offset:-1024 sc1
    v_pk_fma_f32 v[44:45], v[16:17], v[118:119], v[44:45] op_sel_hi:[1,0,1]
    global_load_dwordx4 a[80:83], v2, s[66:67] offset:0 sc1
    v_pk_fma_f32 v[46:47], v[18:19], v[118:119], v[46:47] op_sel_hi:[1,0,1]
    global_load_dwordx4 a[84:87], v2, s[66:67] offset:1024 sc1
    v_pk_fma_f32 v[40:41], v[40:41], v[116:117], v[28:29] op_sel:[0,1,0] op_sel_hi:[1,1,1]
    v_pk_fma_f32 v[42:43], v[42:43], v[116:117], v[30:31] op_sel:[0,1,0] op_sel_hi:[1,1,1]
    v_pk_fma_f32 v[44:45], v[44:45], v[118:119], v[28:29] op_sel:[0,1,0] op_sel_hi:[1,1,1]
    v_pk_fma_f32 v[46:47], v[46:47], v[118:119], v[30:31] op_sel:[0,1,0] op_sel_hi:[1,1,1]
    v_pk_mul_f32 v[64:65], v[40:41], s[8:9] op_sel_hi:[1,0]
    v_pk_mul_f32 v[66:67], v[42:43], s[8:9] op_sel_hi:[1,0]
    v_pk_mul_f32 v[68:69], v[44:45], s[8:9] op_sel_hi:[1,0]
    v_pk_mul_f32 v[70:71], v[46:47], s[8:9] op_sel_hi:[1,0]
    global_load_dwordx4 a[88:91], v2, s[66:67] offset:2048 sc1
    v_exp_f32 v64, v64
    v_exp_f32 v65, v65
    v_exp_f32 v66, v66
    v_exp_f32 v67, v67
    v_exp_f32 v68, v68
    v_exp_f32 v69, v69
    v_exp_f32 v70, v70
    v_exp_f32 v71, v71
    v_pk_add_f32 v[64:65], v[64:65], 1.0 op_sel_hi:[1,0]
    v_pk_add_f32 v[66:67], v[66:67], 1.0 op_sel_hi:[1,0]
    v_pk_add_f32 v[68:69], v[68:69], 1.0 op_sel_hi:[1,0]
    v_pk_add_f32 v[70:71], v[70:71], 1.0 op_sel_hi:[1,0]
    v_rcp_f32 v64, v64
    v_rcp_f32 v65, v65
    v_rcp_f32 v66, v66
    v_rcp_f32 v67, v67
    v_rcp_f32 v68, v68
    v_rcp_f32 v69, v69
    v_rcp_f32 v70, v70
    v_rcp_f32 v71, v71
    v_pk_mul_f32 v[64:65], v[64:65], v[40:41]
    v_pk_mul_f32 v[66:67], v[66:67], v[42:43]
    v_pk_mul_f32 v[68:69], v[68:69], v[44:45]
    v_pk_mul_f32 v[70:71], v[70:71], v[46:47]
    v_cvt_pk_bf16_f32 v80, v64, v65
    v_cvt_pk_bf16_f32 v81, v66, v67
    v_cvt_pk_bf16_f32 v82, v68, v69
    v_cvt_pk_bf16_f32 v83, v70, v71
    global_store_dwordx4 v2, v[80:83], s[84:85] offset:0 sc1
    s_waitcnt vmcnt(6)
    v_cmp_ne_u32 vcc, s50, v112
    s_nop 0
    s_cbranch_vccnz L_cfr_68
L_cfd_67:
    s_add_u32 m0, s70, 0
    s_nop 0
    global_load_lds_dwordx4 v2, s[68:69] offset:0 sc1
    global_load_lds_dwordx4 v2, s[68:69] offset:1024 sc1
    s_add_u32 m0, s70, 0
    s_nop 0
    global_load_lds_dwordx4 v2, s[68:69] offset:2048 sc1
    global_load_lds_dwordx4 v2, s[68:69] offset:3072 sc1
    s_add_u32 s68, s68, 4096
    s_addc_u32 s69, s69, 0
    s_add_u32 m0, s70, 4096
    s_nop 0
    global_load_lds_dwordx4 v2, s[68:69] offset:0 sc1
    global_load_lds_dwordx4 v2, s[68:69] offset:1024 sc1
    v_pk_fma_f32 v[48:49], v[20:21], v[116:117], v[48:49] op_sel_hi:[1,0,1]
    v_pk_fma_f32 v[50:51], v[22:23], v[116:117], v[50:51] op_sel_hi:[1,0,1]
    v_pk_fma_f32 v[52:53], v[20:21], v[118:119], v[52:53] op_sel_hi:[1,0,1]
    v_pk_fma_f32 v[54:55], v[22:23], v[118:119], v[54:55] op_sel_hi:[1,0,1]
    v_pk_fma_f32 v[48:49], v[48:49], v[116:117], v[32:33] op_sel:[0,1,0] op_sel_hi:[1,1,1]
    v_pk_fma_f32 v[50:51], v[50:51], v[116:117], v[34:35] op_sel:[0,1,0] op_sel_hi:[1,1,1]
    v_pk_fma_f32 v[52:53], v[52:53], v[118:119], v[32:33] op_sel:[0,1,0] op_sel_hi:[1,1,1]
    v_pk_fma_f32 v[54:55], v[54:55], v[118:119], v[34:35] op_sel:[0,1,0] op_sel_hi:[1,1,1]
    v_pk_mul_f32 v[72:73], v[48:49], s[8:9] op_sel_hi:[1,0]
    v_pk_mul_f32 v[74:75], v[50:51], s[8:9] op_sel_hi:[1,0]
    v_pk_mul_f32 v[76:77], v[52:53], s[8:9] op_sel_hi:[1,0]
    v_pk_mul_f32 v[78:79], v[54:55], s[8:9] op_sel_hi:[1,0]
    v_exp_f32 v72, v72
    v_exp_f32 v73, v73
    v_exp_f32 v74, v74
    v_exp_f32 v75, v75
    v_exp_f32 v76, v76
    v_exp_f32 v77, v77
    v_exp_f32 v78, v78
    v_exp_f32 v79, v79
    v_pk_add_f32 v[72:73], v[72:73], 1.0 op_sel_hi:[1,0]
    v_pk_add_f32 v[74:75], v[74:75], 1.0 op_sel_hi:[1,0]
    v_pk_add_f32 v[76:77], v[76:77], 1.0 op_sel_hi:[1,0]
    v_pk_add_f32 v[78:79], v[78:79], 1.0 op_sel_hi:[1,0]
    v_rcp_f32 v72, v72
    v_rcp_f32 v73, v73
    v_rcp_f32 v74, v74
    v_rcp_f32 v75, v75
    v_rcp_f32 v76, v76
    v_rcp_f32 v77, v77
    v_rcp_f32 v78, v78
    v_rcp_f32 v79, v79
    v_pk_mul_f32 v[72:73], v[72:73], v[48:49]
    v_pk_mul_f32 v[74:75], v[74:75], v[50:51]
    v_pk_mul_f32 v[76:77], v[76:77], v[52:53]
    v_pk_mul_f32 v[78:79], v[78:79], v[54:55]
    v_cvt_pk_bf16_f32 v84, v72, v73
    v_cvt_pk_bf16_f32 v85, v74, v75
    v_cvt_pk_bf16_f32 v86, v76, v77
    v_cvt_pk_bf16_f32 v87, v78, v79
    global_store_dwordx4 v2, v[84:87], s[84:85] offset:1024 sc1
    v_pk_fma_f32 v[56:57], v[24:25], v[116:117], v[56:57] op_sel_hi:[1,0,1]
    v_pk_fma_f32 v[58:59], v[26:27], v[116:117], v[58:59] op_sel_hi:[1,0,1]
    v_pk_fma_f32 v[60:61], v[24:25], v[118:119], v[60:61] op_sel_hi:[1,0,1]
    v_pk_fma_f32 v[62:63], v[26:27], v[118:119], v[62:63] op_sel_hi:[1,0,1]
    v_pk_fma_f32 v[56:57], v[56:57], v[116:117], v[36:37] op_sel:[0,1,0] op_sel_hi:[1,1,1]
    v_pk_fma_f32 v[58:59], v[58:59], v[116:117], v[38:39] op_sel:[0,1,0] op_sel_hi:[1,1,1]
    v_pk_fma_f32 v[60:61], v[60:61], v[118:119], v[36:37] op_sel:[0,1,0] op_sel_hi:[1,1,1]
    v_pk_fma_f32 v[62:63], v[62:63], v[118:119], v[38:39] op_sel:[0,1,0] op_sel_hi:[1,1,1]
    v_pk_mul_f32 v[64:65], v[56:57], s[8:9] op_sel_hi:[1,0]
    v_pk_mul_f32 v[66:67], v[58:59], s[8:9] op_sel_hi:[1,0]
    v_pk_mul_f32 v[68:69], v[60:61], s[8:9] op_sel_hi:[1,0]
    v_pk_mul_f32 v[70:71], v[62:63], s[8:9] op_sel_hi:[1,0]
    v_exp_f32 v64, v64
    v_exp_f32 v65, v65
    v_exp_f32 v66, v66
    v_exp_f32 v67, v67
    s_add_u32 m0, s70, 4096
    s_nop 0
    global_load_lds_dwordx4 v2, s[68:69] offset:2048 sc1
    v_exp_f32 v68, v68
    v_exp_f32 v69, v69
    v_exp_f32 v70, v70
    v_exp_f32 v71, v71
    v_pk_add_f32 v[64:65], v[64:65], 1.0 op_sel_hi:[1,0]
    v_pk_add_f32 v[66:67], v[66:67], 1.0 op_sel_hi:[1,0]
    v_pk_add_f32 v[68:69], v[68:69], 1.0 op_sel_hi:[1,0]
    v_pk_add_f32 v[70:71], v[70:71], 1.0 op_sel_hi:[1,0]
    global_load_lds_dwordx4 v2, s[68:69] offset:3072 sc1
    v_rcp_f32 v64, v64
    v_rcp_f32 v65, v65
    v_rcp_f32 v66, v66
    v_rcp_f32 v67, v67
    v_rcp_f32 v68, v68
    v_rcp_f32 v69, v69
    v_rcp_f32 v70, v70
    s_add_u32 s68, s68, 4096
    s_addc_u32 s69, s69, 0
    s_add_u32 m0, s70, 8192
    s_nop 0
    global_load_lds_dwordx4 v2, s[68:69] offset:0 sc1
    v_rcp_f32_e64 v71, v71
    v_pk_mul_f32 v[64:65], v[64:65], v[56:57]
    v_pk_mul_f32 v[66:67], v[66:67], v[58:59]
    v_pk_mul_f32 v[68:69], v[68:69], v[60:61]
    v_pk_mul_f32 v[70:71], v[70:71], v[62:63]
    v_cvt_pk_bf16_f32 v88, v64, v65
    v_cvt_pk_bf16_f32 v89, v66, v67
    v_cvt_pk_bf16_f32 v90, v68, v69
    v_cvt_pk_bf16_f32 v91, v70, v71
    global_store_dwordx4 v2, v[88:91], s[84:85] offset:2048 sc1
    v_add_u32 v15, 32768, v15
    v_mov_b32 v22, v10
    s_lshl_b32 s6, s3, 6
    v_add_u32 v14, s6, v6
    v_add_u32 v56, s70, v2
    v_add_u32 v57, 8, v56
    global_load_dwordx4 v[8:11], v6, s[48:49] offset:256 sc1
    global_load_dwordx4 v[4:7], v14, s[48:49] sc1
    s_waitcnt vmcnt(11)
    ds_read2st64_b64 v[32:35], v56 offset0:0 offset1:2
    ds_read2st64_b64 v[36:39], v57 offset0:0 offset1:2
    s_waitcnt vmcnt(9)
    ds_read2st64_b64 v[40:43], v56 offset0:4 offset1:6
    ds_read2st64_b64 v[44:47], v57 offset0:4 offset1:6
    s_waitcnt lgkmcnt(2)
    v_mfma_f32_16x16x32_bf16 a[112:115], v[128:131], v[32:35], 0
    v_mfma_f32_16x16x32_bf16 a[116:119], v[128:131], v[36:39], 0
    s_waitcnt vmcnt(7)
    ds_read2st64_b64 v[48:51], v56 offset0:8 offset1:10
    s_mul_i32 s10, s61, 96
    s_mul_i32 s11, s3, 24
    s_add_u32 s10, s10, s11
    s_lshl_b32 s10, s10, 10
    s_add_u32 s10, s10, 19922944
    s_add_u32 s72, s48, s10
    s_addc_u32 s73, s49, 0
    s_mul_i32 s70, s3, 24576
    v_mfma_f32_16x16x32_bf16 a[120:123], v[132:135], v[32:35], 0
    global_load_lds_dwordx4 v2, s[68:69] offset:1024 sc1
    ds_read2st64_b64 v[52:55], v57 offset0:8 offset1:10
    s_add_u32 s6, s3, 1
    s_and_b32 s6, s6, 3
    s_mul_i32 s6, s6, 6144
    s_add_u32 s6, s6, 126976
    v_add_u32 v17, s6, v2
    s_add_u32 m0, s70, 8192
    s_nop 0
    global_load_lds_dwordx4 v2, s[68:69] offset:2048 sc1
    v_mfma_f32_16x16x32_bf16 a[124:127], v[132:135], v[36:39], 0
    v_mfma_f32_16x16x32_bf16 a[128:131], v[136:139], v[32:35], 0
    s_add_u32 s6, s3, 2
    s_and_b32 s6, s6, 3
    s_mul_i32 s6, s6, 6144
    s_add_u32 s6, s6, 126976
    v_add_u32 v18, s6, v2
    v_mfma_f32_16x16x32_bf16 a[132:135], v[136:139], v[36:39], 0
    global_load_lds_dwordx4 v2, s[68:69] offset:3072 sc1
    v_mfma_f32_16x16x32_bf16 a[136:139], v[140:143], v[32:35], 0
    v_mfma_f32_16x16x32_bf16 a[140:143], v[140:143], v[36:39], 0
    s_add_u32 s6, s3, 3
    s_and_b32 s6, s6, 3
    s_mul_i32 s6, s6, 6144
    s_add_u32 s6, s6, 126976
    v_add_u32 v19, s6, v2
    v_mfma_f32_16x16x32_bf16 a[144:147], v[144:147], v[32:35], 0
    s_add_u32 s68, s68, 4096
    s_addc_u32 s69, s69, 0
    s_add_u32 m0, s70, 12288
    s_nop 0
    global_load_lds_dwordx4 v2, s[68:69] offset:0 sc1
    v_mfma_f32_16x16x32_bf16 a[148:151], v[144:147], v[36:39], 0
    s_waitcnt lgkmcnt(2)
    v_mfma_f32_16x16x32_bf16 a[112:115], v[148:151], v[40:43], a[112:115]
    s_lshl_b32 s6, s3, 10
    s_add_u32 s7, s6, 151552
    v_add_u32 v16, s7, v2
    v_mfma_f32_16x16x32_bf16 a[116:119], v[148:151], v[44:47], a[116:119]
    s_waitcnt vmcnt(8)
    ds_read2st64_b64 v[32:35], v56 offset0:12 offset1:14
    global_load_lds_dwordx4 v2, s[68:69] offset:1024 sc1
    v_mfma_f32_16x16x32_bf16 a[120:123], v[152:155], v[40:43], a[120:123]
    ds_read2st64_b64 v[36:39], v57 offset0:12 offset1:14
    v_mfma_f32_16x16x32_bf16 a[124:127], v[152:155], v[44:47], a[124:127]
    s_add_u32 s7, s6, 113664
    v_add_u32 v20, s7, v12
    v_xor_b32 v21, 32, v20
    v_mfma_f32_16x16x32_bf16 a[128:131], v[156:159], v[40:43], a[128:131]
    v_mfma_f32_16x16x32_bf16 a[132:135], v[156:159], v[44:47], a[132:135]
    s_add_u32 m0, s70, 12288
    s_nop 0
    global_load_lds_dwordx4 v2, s[68:69] offset:2048 sc1
    v_mfma_f32_16x16x32_bf16 a[136:139], v[160:163], v[40:43], a[136:139]
    s_mul_i32 s6, s3, 6144
    s_add_u32 s6, s6, 126976
    v_add_u32 v23, s6, v2
    v_mfma_f32_16x16x32_bf16 a[140:143], v[160:163], v[44:47], a[140:143]
    v_mfma_f32_16x16x32_bf16 a[144:147], v[164:167], v[40:43], a[144:147]
    global_load_lds_dwordx4 v2, s[68:69] offset:3072 sc1
    v_mfma_f32_16x16x32_bf16 a[148:151], v[164:167], v[44:47], a[148:151]
    s_and_b32 s6, s3, 1
    s_lshl_b32 s6, s6, 12
    s_add_u32 s6, s6, 151552
    v_add_u32 v3, s6, v2
    s_waitcnt lgkmcnt(2)
    v_mfma_f32_16x16x32_bf16 a[112:115], v[168:171], v[48:51], a[112:115]
    s_waitcnt vmcnt(9)
    s_barrier
    s_cmp_lg_u32 s3, 3
    s_cbranch_scc1 L_fw_69
    s_lshl_b32 s88, s63, 7
    s_add_u32 s88, s88, 167936
    v_lshl_add_u32 v58, v1, 2, s88
    v_mov_b32 v59, s50
    s_mov_b32 exec_hi, 0
    global_store_dword v58, v59, s[48:49] sc1
    s_mov_b64 exec, -1
L_fw_69:
    v_mfma_f32_16x16x32_bf16 a[116:119], v[168:171], v[52:55], a[116:119]
    s_add_u32 s68, s68, 4096
    s_addc_u32 s69, s69, 0
    s_add_u32 m0, s70, 16384
    s_nop 0
    global_load_lds_dwordx4 v2, s[68:69] offset:0 sc1
    s_waitcnt vmcnt(7)
    s_nop 0
    ds_read2st64_b64 v[40:43], v56 offset0:16 offset1:18
    global_load_lds_dwordx4 v2, s[68:69] offset:1024 sc1
    v_mfma_f32_16x16x32_bf16 a[120:123], v[172:175], v[48:51], a[120:123]
    ds_read2st64_b64 v[44:47], v57 offset0:16 offset1:18
    s_mul_i32 s6, s61, 40960
    s_mul_i32 s7, s62, 160
    s_add_u32 s6, s6, s7
    v_and_b32 v31, 15, v1
    v_mfma_f32_16x16x32_bf16 a[124:127], v[172:175], v[52:55], a[124:127]
    v_mfma_f32_16x16x32_bf16 a[128:131], v[176:179], v[48:51], a[128:131]
    v_mfma_f32_16x16x32_bf16 a[132:135], v[176:179], v[52:55], a[132:135]
    s_add_u32 m0, s70, 16384
    s_nop 0
    global_load_lds_dwordx4 v2, s[68:69] offset:2048 sc1
    v_mul_u32_u24 v31, 1280, v31
    v_add_u32 v31, s6, v31
    v_bfe_u32 v30, v1, 4, 1
    v_mfma_f32_16x16x32_bf16 a[136:139], v[180:183], v[48:51], a[136:139]
    v_mfma_f32_16x16x32_bf16 a[140:143], v[180:183], v[52:55], a[140:143]
    v_mfma_f32_16x16x32_bf16 a[144:147], v[184:187], v[48:51], a[144:147]
    global_load_lds_dwordx4 v2, s[68:69] offset:3072 sc1
    v_mul_u32_u24 v30, 20480, v30
    v_lshrrev_b32 v24, 5, v1
    v_lshl_add_u32 v30, v24, 4, v30
    v_mfma_f32_16x16x32_bf16 a[148:151], v[184:187], v[52:55], a[148:151]
    s_waitcnt lgkmcnt(2)
    v_mfma_f32_16x16x32_bf16 a[112:115], v[188:191], v[32:35], a[112:115]
    v_mfma_f32_16x16x32_bf16 a[116:119], v[188:191], v[36:39], a[116:119]
    s_add_u32 s68, s68, 4096
    s_addc_u32 s69, s69, 0
    s_add_u32 m0, s70, 20480
    s_nop 0
    global_load_lds_dwordx4 v2, s[68:69] offset:0 sc1
    s_waitcnt vmcnt(9)
    ds_read2st64_b64 v[48:51], v56 offset0:20 offset1:22
    s_lshl_b32 s7, s3, 5
    v_add3_u32 v30, v30, s7, v31
    v_lshrrev_b32 v24, 4, v1
    v_mfma_f32_16x16x32_bf16 a[120:123], v[192:195], v[32:35], a[120:123]
    ds_read2st64_b64 v[52:55], v57 offset0:20 offset1:22
    v_mfma_f32_16x16x32_bf16 a[124:127], v[192:195], v[36:39], a[124:127]
    global_load_lds_dwordx4 v2, s[68:69] offset:1024 sc1
    v_mfma_f32_16x16x32_bf16 a[128:131], v[196:199], v[32:35], a[128:131]
    s_and_b32 s7, s3, 1
    s_mul_i32 s7, s7, 20480
    s_add_u32 s7, s7, 128
    v_lshl_add_u32 v24, v24, 3, s7
    v_mfma_f32_16x16x32_bf16 a[132:135], v[196:199], v[36:39], a[132:135]
    v_mfma_f32_16x16x32_bf16 a[136:139], v[200:203], v[32:35], a[136:139]
    global_load_dwordx4 a[92:95], v2, s[66:67] offset:3072 sc1
    v_mfma_f32_16x16x32_bf16 a[140:143], v[200:203], v[36:39], a[140:143]
    v_add_u32 v31, v31, v24
    v_mfma_f32_16x16x32_bf16 a[144:147], v[204:207], v[32:35], a[144:147]
    v_mfma_f32_16x16x32_bf16 a[148:151], v[204:207], v[36:39], a[148:151]
    s_waitcnt lgkmcnt(2)
    v_mfma_f32_16x16x32_bf16 a[112:115], v[208:211], v[40:43], a[112:115]
    s_add_u32 s66, s66, 8192
    s_addc_u32 s67, s67, 0
    global_load_dwordx4 a[96:99], v2, s[66:67] offset:-4096 sc1
    v_mfma_f32_16x16x32_bf16 a[116:119], v[208:211], v[44:47], a[116:119]
    s_waitcnt vmcnt(10)
    ds_read2st64_b64 v[32:35], v56 offset0:24 offset1:26
    v_mfma_f32_16x16x32_bf16 a[120:123], v[212:215], v[40:43], a[120:123]
    ds_read2st64_b64 v[36:39], v57 offset0:24 offset1:26
    v_mfma_f32_16x16x32_bf16 a[124:127], v[212:215], v[44:47], a[124:127]
    global_load_dwordx4 a[100:103], v2, s[66:67] offset:-3072 sc1
    v_mfma_f32_16x16x32_bf16 a[128:131], v[216:219], v[40:43], a[128:131]
    v_mfma_f32_16x16x32_bf16 a[132:135], v[216:219], v[44:47], a[132:135]
    v_mfma_f32_16x16x32_bf16 a[136:139], v[220:223], v[40:43], a[136:139]
    v_mfma_f32_16x16x32_bf16 a[140:143], v[220:223], v[44:47], a[140:143]
    global_load_dwordx4 a[104:107], v2, s[66:67] offset:-2048 sc1
    v_mfma_f32_16x16x32_bf16 a[144:147], v[224:227], v[40:43], a[144:147]
    v_mfma_f32_16x16x32_bf16 a[148:151], v[224:227], v[44:47], a[148:151]
    s_waitcnt lgkmcnt(2)
    v_mfma_f32_16x16x32_bf16 a[112:115], v[228:231], v[48:51], a[112:115]
    global_load_dwordx4 a[108:111], v2, s[66:67] offset:-1024 sc1
    v_mfma_f32_16x16x32_bf16 a[116:119], v[228:231], v[52:55], a[116:119]
    s_waitcnt vmcnt(11)
    ds_read2st64_b64 v[40:43], v56 offset0:28 offset1:30
    v_mfma_f32_16x16x32_bf16 a[120:123], v[232:235], v[48:51], a[120:123]
    ds_read2st64_b64 v[44:47], v57 offset0:28 offset1:30
    v_mfma_f32_16x16x32_bf16 a[124:127], v[232:235], v[52:55], a[124:127]
    v_mfma_f32_16x16x32_bf16 a[128:131], v[236:239], v[48:51], a[128:131]
    s_add_u32 m0, s70, 20480
    s_nop 0
    global_load_lds_dwordx4 v2, s[68:69] offset:2048 sc1
    v_mfma_f32_16x16x32_bf16 a[132:135], v[236:239], v[52:55], a[132:135]
    v_mfma_f32_16x16x32_bf16 a[136:139], v[240:243], v[48:51], a[136:139]
    v_mfma_f32_16x16x32_bf16 a[140:143], v[240:243], v[52:55], a[140:143]
    global_load_lds_dwordx4 v2, s[68:69] offset:3072 sc1
    v_mfma_f32_16x16x32_bf16 a[144:147], v[244:247], v[48:51], a[144:147]
    v_mfma_f32_16x16x32_bf16 a[148:151], v[244:247], v[52:55], a[148:151]
    s_waitcnt lgkmcnt(2)
    v_mfma_f32_16x16x32_bf16 a[112:115], v[248:251], v[32:35], a[112:115]
    v_mfma_f32_16x16x32_bf16 a[116:119], v[248:251], v[36:39], a[116:119]
    s_waitcnt vmcnt(11)
    ds_read2st64_b64 v[48:51], v56 offset0:32 offset1:34
    v_mfma_f32_16x16x32_bf16 a[120:123], v[252:255], v[32:35], a[120:123]
    ds_read2st64_b64 v[52:55], v57 offset0:32 offset1:34
    v_mfma_f32_16x16x32_bf16 a[124:127], v[252:255], v[36:39], a[124:127]
    v_mfma_f32_16x16x32_bf16 a[128:131], a[0:3], v[32:35], a[128:131]
    v_mfma_f32_16x16x32_bf16 a[132:135], a[0:3], v[36:39], a[132:135]
    v_mfma_f32_16x16x32_bf16 a[136:139], a[4:7], v[32:35], a[136:139]
    v_mfma_f32_16x16x32_bf16 a[140:143], a[4:7], v[36:39], a[140:143]
    v_mfma_f32_16x16x32_bf16 a[144:147], a[8:11], v[32:35], a[144:147]
    v_mfma_f32_16x16x32_bf16 a[148:151], a[8:11], v[36:39], a[148:151]
    s_waitcnt lgkmcnt(2)
    v_mfma_f32_16x16x32_bf16 a[112:115], a[12:15], v[40:43], a[112:115]
    v_mfma_f32_16x16x32_bf16 a[116:119], a[12:15], v[44:47], a[116:119]
    s_waitcnt vmcnt(9)
    ds_read2st64_b64 v[32:35], v56 offset0:36 offset1:38
    v_mfma_f32_16x16x32_bf16 a[120:123], a[16:19], v[40:43], a[120:123]
    ds_read2st64_b64 v[36:39], v57 offset0:36 offset1:38
    v_mfma_f32_16x16x32_bf16 a[124:127], a[16:19], v[44:47], a[124:127]
    v_mfma_f32_16x16x32_bf16 a[128:131], a[20:23], v[40:43], a[128:131]
    v_mfma_f32_16x16x32_bf16 a[132:135], a[20:23], v[44:47], a[132:135]
    global_load_dword v13, v15, s[48:49] sc1
    v_mfma_f32_16x16x32_bf16 a[136:139], a[24:27], v[40:43], a[136:139]
    v_mfma_f32_16x16x32_bf16 a[140:143], a[24:27], v[44:47], a[140:143]
    v_mfma_f32_16x16x32_bf16 a[144:147], a[28:31], v[40:43], a[144:147]
    v_mfma_f32_16x16x32_bf16 a[148:151], a[28:31], v[44:47], a[148:151]
    s_waitcnt lgkmcnt(2)
    v_mfma_f32_16x16x32_bf16 a[112:115], a[32:35], v[48:51], a[112:115]
    v_mfma_f32_16x16x32_bf16 a[116:119], a[32:35], v[52:55], a[116:119]
    s_waitcnt vmcnt(8)
    ds_read2st64_b64 v[40:43], v56 offset0:40 offset1:42
    v_mfma_f32_16x16x32_bf16 a[120:123], a[36:39], v[48:51], a[120:123]
    ds_read2st64_b64 v[44:47], v57 offset0:40 offset1:42
    v_mfma_f32_16x16x32_bf16 a[124:127], a[36:39], v[52:55], a[124:127]
    v_mfma_f32_16x16x32_bf16 a[128:131], a[40:43], v[48:51], a[128:131]
    v_mfma_f32_16x16x32_bf16 a[132:135], a[40:43], v[52:55], a[132:135]
    v_mfma_f32_16x16x32_bf16 a[136:139], a[44:47], v[48:51], a[136:139]
    v_mfma_f32_16x16x32_bf16 a[140:143], a[44:47], v[52:55], a[140:143]
    v_mfma_f32_16x16x32_bf16 a[144:147], a[48:51], v[48:51], a[144:147]
    v_mfma_f32_16x16x32_bf16 a[148:151], a[48:51], v[52:55], a[148:151]
    s_waitcnt lgkmcnt(2)
    v_mfma_f32_16x16x32_bf16 a[112:115], a[52:55], v[32:35], a[112:115]
    v_mfma_f32_16x16x32_bf16 a[116:119], a[52:55], v[36:39], a[116:119]
    s_waitcnt vmcnt(1)
    ds_read2st64_b64 v[48:51], v56 offset0:44 offset1:46
    v_mfma_f32_16x16x32_bf16 a[120:123], a[56:59], v[32:35], a[120:123]
    ds_read2st64_b64 v[52:55], v57 offset0:44 offset1:46
    v_mfma_f32_16x16x32_bf16 a[124:127], a[56:59], v[36:39], a[124:127]
    ds_read_b64_tr_b16 v[24:25], v20 offset:0
    v_mfma_f32_16x16x32_bf16 a[128:131], a[60:63], v[32:35], a[128:131]
    ds_read_b64_tr_b16 v[26:27], v21 offset:0
    v_mfma_f32_16x16x32_bf16 a[132:135], a[60:63], v[36:39], a[132:135]
    ds_read_b64_tr_b16 v[28:29], v22 offset:4096
    s_waitcnt vmcnt(0)
    v_cmp_ne_u32 vcc, s50, v13
    s_nop 0
    s_cbranch_vccnz L_cfr_72
L_cfd_71:
    s_add_u32 m0, s70, 0
    s_nop 0
    global_load_lds_dwordx4 v2, s[72:73] offset:0 sc1
    global_load_lds_dwordx4 v2, s[72:73] offset:1024 sc1
    s_add_u32 m0, s70, 0
    s_nop 0
    global_load_lds_dwordx4 v2, s[72:73] offset:2048 sc1
    global_load_lds_dwordx4 v2, s[72:73] offset:3072 sc1
    v_mfma_f32_16x16x32_bf16 a[136:139], a[64:67], v[32:35], a[136:139]
    v_mfma_f32_16x16x32_bf16 a[140:143], a[64:67], v[36:39], a[140:143]
    v_mfma_f32_16x16x32_bf16 a[144:147], a[68:71], v[32:35], a[144:147]
    s_add_u32 s72, s72, 4096
    s_addc_u32 s73, s73, 0
    s_add_u32 m0, s70, 4096
    s_nop 0
    global_load_lds_dwordx4 v2, s[72:73] offset:0 sc1
    v_mfma_f32_16x16x32_bf16 a[148:151], a[68:71], v[36:39], a[148:151]
    s_waitcnt lgkmcnt(5)
    v_mfma_f32_16x16x32_bf16 a[112:115], a[72:75], v[40:43], a[112:115]
    v_mfma_f32_16x16x32_bf16 a[116:119], a[72:75], v[44:47], a[116:119]
    global_load_lds_dwordx4 v2, s[72:73] offset:1024 sc1
    s_waitcnt vmcnt(4)
    ds_read2st64_b64 v[32:35], v56 offset0:0 offset1:2
    v_mfma_f32_16x16x32_bf16 a[120:123], a[76:79], v[40:43], a[120:123]
    ds_read2st64_b64 v[36:39], v57 offset0:0 offset1:2
    v_mfma_f32_16x16x32_bf16 a[124:127], a[76:79], v[44:47], a[124:127]
    v_mfma_f32_16x16x32_bf16 a[128:131], a[80:83], v[40:43], a[128:131]
    s_add_u32 m0, s70, 4096
    s_nop 0
    global_load_lds_dwordx4 v2, s[72:73] offset:2048 sc1
    v_mfma_f32_16x16x32_bf16 a[132:135], a[80:83], v[44:47], a[132:135]
    v_mfma_f32_16x16x32_bf16 a[136:139], a[84:87], v[40:43], a[136:139]
    v_mfma_f32_16x16x32_bf16 a[140:143], a[84:87], v[44:47], a[140:143]
    global_load_lds_dwordx4 v2, s[72:73] offset:3072 sc1
    v_mfma_f32_16x16x32_bf16 a[144:147], a[88:91], v[40:43], a[144:147]
    v_mfma_f32_16x16x32_bf16 a[148:151], a[88:91], v[44:47], a[148:151]
    s_waitcnt lgkmcnt(5)
    v_mfma_f32_16x16x32_bf16 a[120:123], a[96:99], v[48:51], a[120:123]
    s_add_u32 s72, s72, 4096
    s_addc_u32 s73, s73, 0
    s_add_u32 m0, s70, 8192
    s_nop 0
    global_load_lds_dwordx4 v2, s[72:73] offset:0 sc1
    v_mfma_f32_16x16x32_bf16 a[124:127], a[96:99], v[52:55], a[124:127]
    s_waitcnt vmcnt(5)
    ds_read2st64_b64 v[40:43], v56 offset0:4 offset1:6
    v_mfma_f32_16x16x32_bf16 a[128:131], a[100:103], v[48:51], a[128:131]
    ds_read2st64_b64 v[44:47], v57 offset0:4 offset1:6
    v_mfma_f32_16x16x32_bf16 a[132:135], a[100:103], v[52:55], a[132:135]
    global_load_lds_dwordx4 v2, s[72:73] offset:1024 sc1
    v_mfma_f32_16x16x32_bf16 a[136:139], a[104:107], v[48:51], a[136:139]
    v_mfma_f32_16x16x32_bf16 a[140:143], a[104:107], v[52:55], a[140:143]
    v_mfma_f32_16x16x32_bf16 a[144:147], a[108:111], v[48:51], a[144:147]
    s_add_u32 m0, s70, 8192
    s_nop 0
    global_load_lds_dwordx4 v2, s[72:73] offset:2048 sc1
    v_mfma_f32_16x16x32_bf16 a[148:151], a[108:111], v[52:55], a[148:151]
    v_mfma_f32_16x16x32_bf16 a[112:115], a[92:95], v[48:51], a[112:115]
    v_mfma_f32_16x16x32_bf16 a[116:119], a[92:95], v[52:55], a[116:119]
    global_load_lds_dwordx4 v2, s[72:73] offset:3072 sc1
    s_waitcnt lgkmcnt(2)
    v_mfma_f32_16x16x32_bf16 a[152:155], v[128:131], v[32:35], 0
    v_mfma_f32_16x16x32_bf16 a[156:159], v[128:131], v[36:39], 0
    s_waitcnt vmcnt(6)
    ds_read2st64_b64 v[48:51], v56 offset0:8 offset1:10
    ds_write_b128 v17, a[120:123] offset:2048
    s_add_u32 s72, s72, 4096
    s_addc_u32 s73, s73, 0
    s_add_u32 m0, s70, 12288
    s_nop 0
    global_load_lds_dwordx4 v2, s[72:73] offset:0 sc1
    v_mfma_f32_16x16x32_bf16 a[160:163], v[132:135], v[32:35], 0
    s_nop 0
    ds_read2st64_b64 v[52:55], v57 offset0:8 offset1:10
    ds_write_b128 v17, a[124:127] offset:5120
    global_load_lds_dwordx4 v2, s[72:73] offset:1024 sc1
    v_accvgpr_read_b32 v72, a112
    v_mfma_f32_16x16x32_bf16 a[164:167], v[132:135], v[36:39], 0
    ds_write_b128 v18, a[128:131] offset:1024
    v_accvgpr_read_b32 v73, a113
    v_mfma_f32_16x16x32_bf16 a[168:171], v[136:139], v[32:35], 0
    s_add_u32 m0, s70, 12288
    s_nop 0
    global_load_lds_dwordx4 v2, s[72:73] offset:2048 sc1
    v_accvgpr_read_b32 v74, a114
    v_mfma_f32_16x16x32_bf16 a[172:175], v[136:139], v[36:39], 0
    ds_write_b128 v18, a[132:135] offset:4096
    v_accvgpr_read_b32 v75, a115
    v_mfma_f32_16x16x32_bf16 a[176:179], v[140:143], v[32:35], 0
    global_load_lds_dwordx4 v2, s[72:73] offset:3072 sc1
    ds_write_b128 v19, a[136:139] offset:0
    v_mfma_f32_16x16x32_bf16 a[180:183], v[140:143], v[36:39], 0
    ds_write_b128 v19, a[140:143] offset:3072
    s_add_u32 s72, s72, 4096
    s_addc_u32 s73, s73, 0
    s_add_u32 m0, s70, 16384
    s_nop 0
    global_load_lds_dwordx4 v2, s[72:73] offset:0 sc1
    v_accvgpr_read_b32 v76, a116
    v_mfma_f32_16x16x32_bf16 a[184:187], v[144:147], v[32:35], 0
    v_accvgpr_read_b32 v77, a117
    v_mfma_f32_16x16x32_bf16 a[188:191], v[144:147], v[36:39], 0
    ds_write_b128 v16, a[144:147] offset:0
    global_load_lds_dwordx4 v2, s[72:73] offset:1024 sc1
    v_accvgpr_read_b32 v78, a118
    s_waitcnt lgkmcnt(9)
    v_mfma_f32_16x16x32_bf16 a[152:155], v[148:151], v[40:43], a[152:155]
    ds_write_b128 v16, a[148:151] offset:4096
    v_accvgpr_read_b32 v79, a119
    v_mfma_f32_16x16x32_bf16 a[156:159], v[148:151], v[44:47], a[156:159]
    s_add_u32 m0, s70, 16384
    s_nop 0
    global_load_lds_dwordx4 v2, s[72:73] offset:2048 sc1
    s_waitcnt vmcnt(11)
    ds_read2st64_b64 v[32:35], v56 offset0:12 offset1:14
    v_mfma_f32_16x16x32_bf16 a[160:163], v[152:155], v[40:43], a[160:163]
    ds_read2st64_b64 v[36:39], v57 offset0:12 offset1:14
    v_mfma_f32_16x16x32_bf16 a[164:167], v[152:155], v[44:47], a[164:167]
    v_mfma_f32_16x16x32_bf16 a[168:171], v[156:159], v[40:43], a[168:171]
    global_load_lds_dwordx4 v2, s[72:73] offset:3072 sc1
    v_mfma_f32_16x16x32_bf16 a[172:175], v[156:159], v[44:47], a[172:175]
    v_mfma_f32_16x16x32_bf16 a[176:179], v[160:163], v[40:43], a[176:179]
    s_waitcnt lgkmcnt(2)
    s_barrier
    v_mfma_f32_16x16x32_bf16 a[180:183], v[160:163], v[44:47], a[180:183]
    s_add_u32 s72, s72, 4096
    s_addc_u32 s73, s73, 0
    s_add_u32 m0, s70, 20480
    s_nop 0
    global_load_lds_dwordx4 v2, s[72:73] offset:0 sc1
    ds_read_b128 v[86:89], v23 offset:0
    global_load_lds_dwordx4 v2, s[72:73] offset:1024 sc1
    v_mfma_f32_16x16x32_bf16 a[184:187], v[164:167], v[40:43], a[184:187]
    ds_read_b128 v[90:93], v23 offset:1024
    v_mfma_f32_16x16x32_bf16 a[188:191], v[164:167], v[44:47], a[188:191]
    ds_read_b128 v[94:97], v23 offset:2048
    v_mfma_f32_16x16x32_bf16 a[152:155], v[168:171], v[48:51], a[152:155]
    ds_read_b128 v[98:101], v23 offset:3072
    s_add_u32 m0, s70, 20480
    s_nop 0
    global_load_lds_dwordx4 v2, s[72:73] offset:2048 sc1
    v_mfma_f32_16x16x32_bf16 a[156:159], v[168:171], v[52:55], a[156:159]
    s_waitcnt vmcnt(13)
    ds_read2st64_b64 v[40:43], v56 offset0:16 offset1:18
    ds_read_b128 v[102:105], v23 offset:4096
    v_mfma_f32_16x16x32_bf16 a[160:163], v[172:175], v[48:51], a[160:163]
    ds_read2st64_b64 v[44:47], v57 offset0:16 offset1:18
    v_mfma_f32_16x16x32_bf16 a[164:167], v[172:175], v[52:55], a[164:167]
    global_load_lds_dwordx4 v2, s[72:73] offset:3072 sc1
    ds_read_b128 v[106:109], v23 offset:5120
    v_mfma_f32_16x16x32_bf16 a[168:171], v[176:179], v[48:51], a[168:171]
    ds_read_b128 v[110:113], v3 offset:0
    v_mfma_f32_16x16x32_bf16 a[172:175], v[176:179], v[52:55], a[172:175]
    ds_read_b128 v[114:117], v3 offset:1024
    v_mfma_f32_16x16x32_bf16 a[176:179], v[180:183], v[48:51], a[176:179]
    ds_read_b128 v[118:121], v3 offset:2048
    v_mfma_f32_16x16x32_bf16 a[180:183], v[180:183], v[52:55], a[180:183]
    ds_read_b128 v[122:125], v3 offset:3072
    v_mfma_f32_16x16x32_bf16 a[184:187], v[184:187], v[48:51], a[184:187]
    s_add_u32 s6, s44, 0
    s_addc_u32 s7, s45, 0
    v_mfma_f32_16x16x32_bf16 a[188:191], v[184:187], v[52:55], a[188:191]
    s_waitcnt lgkmcnt(12)
    v_mfma_f32_16x16x32_bf16 a[152:155], v[188:191], v[32:35], a[152:155]
    v_mfma_f32_16x16x32_bf16 a[156:159], v[188:191], v[36:39], a[156:159]
    s_waitcnt vmcnt(12)
    ds_read2st64_b64 v[48:51], v56 offset0:20 offset1:22
    v_mfma_f32_16x16x32_bf16 a[160:163], v[192:195], v[32:35], a[160:163]
    ds_read2st64_b64 v[52:55], v57 offset0:20 offset1:22
    v_mfma_f32_16x16x32_bf16 a[164:167], v[192:195], v[36:39], a[164:167]
    v_mfma_f32_16x16x32_bf16 a[168:171], v[196:199], v[32:35], a[168:171]
    v_mfma_f32_16x16x32_bf16 a[172:175], v[196:199], v[36:39], a[172:175]
    v_mfma_f32_16x16x32_bf16 a[176:179], v[200:203], v[32:35], a[176:179]
    v_mfma_f32_16x16x32_bf16 a[180:183], v[200:203], v[36:39], a[180:183]
    v_mfma_f32_16x16x32_bf16 a[184:187], v[204:207], v[32:35], a[184:187]
    v_mfma_f32_16x16x32_bf16 a[188:191], v[204:207], v[36:39], a[188:191]
    s_waitcnt lgkmcnt(7)
    v_mfma_f32_16x16x32_bf16 a[152:155], v[208:211], v[40:43], a[152:155]
    v_add_f32 v72, v72, v86
    v_mfma_f32_16x16x32_bf16 a[156:159], v[208:211], v[44:47], a[156:159]
    s_waitcnt vmcnt(10)
    ds_read2st64_b64 v[32:35], v56 offset0:24 offset1:26
    v_add_f32 v73, v73, v87
    v_mfma_f32_16x16x32_bf16 a[160:163], v[212:215], v[40:43], a[160:163]
    ds_read2st64_b64 v[36:39], v57 offset0:24 offset1:26
    v_add_f32 v74, v74, v88
    v_mfma_f32_16x16x32_bf16 a[164:167], v[212:215], v[44:47], a[164:167]
    v_add_f32 v75, v75, v89
    v_add_f32 v72, v72, v90
    v_mfma_f32_16x16x32_bf16 a[168:171], v[216:219], v[40:43], a[168:171]
    v_add_f32 v73, v73, v91
    v_mfma_f32_16x16x32_bf16 a[172:175], v[216:219], v[44:47], a[172:175]
    v_add_f32 v74, v74, v92
    v_mfma_f32_16x16x32_bf16 a[176:179], v[220:223], v[40:43], a[176:179]
    v_add_f32 v75, v75, v93
    v_add_f32 v72, v72, v94
    v_mfma_f32_16x16x32_bf16 a[180:183], v[220:223], v[44:47], a[180:183]
    v_add_f32 v73, v73, v95
    v_mfma_f32_16x16x32_bf16 a[184:187], v[224:227], v[40:43], a[184:187]
    v_add_f32 v74, v74, v96
    v_mfma_f32_16x16x32_bf16 a[188:191], v[224:227], v[44:47], a[188:191]
    v_add_f32 v75, v75, v97
    v_lshlrev_b32 v86, 16, v24
    s_waitcnt lgkmcnt(2)
    v_mfma_f32_16x16x32_bf16 a[152:155], v[228:231], v[48:51], a[152:155]
    v_and_b32 v87, 0xffff0000, v24
    v_mfma_f32_16x16x32_bf16 a[156:159], v[228:231], v[52:55], a[156:159]
    s_waitcnt vmcnt(8)
    ds_read2st64_b64 v[40:43], v56 offset0:28 offset1:30
    v_lshlrev_b32 v88, 16, v25
    v_mfma_f32_16x16x32_bf16 a[160:163], v[232:235], v[48:51], a[160:163]
    ds_read2st64_b64 v[44:47], v57 offset0:28 offset1:30
    v_and_b32 v89, 0xffff0000, v25
    v_fmac_f32 v86, v72, v4
    v_mfma_f32_16x16x32_bf16 a[164:167], v[232:235], v[52:55], a[164:167]
    v_fmac_f32 v87, v73, v5
    v_mfma_f32_16x16x32_bf16 a[168:171], v[236:239], v[48:51], a[168:171]
    v_fmac_f32 v88, v74, v6
    v_mfma_f32_16x16x32_bf16 a[172:175], v[236:239], v[52:55], a[172:175]
    v_fmac_f32 v89, v75, v7
    v_cvt_pk_bf16_f32 v80, v86, v87
    v_mfma_f32_16x16x32_bf16 a[176:179], v[240:243], v[48:51], a[176:179]
    v_cvt_pk_bf16_f32 v81, v88, v89
    v_mfma_f32_16x16x32_bf16 a[180:183], v[240:243], v[52:55], a[180:183]
    v_mfma_f32_16x16x32_bf16 a[184:187], v[244:247], v[48:51], a[184:187]
    v_add_f32 v76, v76, v98
    v_add_f32 v77, v77, v99
    v_mfma_f32_16x16x32_bf16 a[188:191], v[244:247], v[52:55], a[188:191]
    v_add_f32 v78, v78, v100
    s_waitcnt lgkmcnt(2)
    v_mfma_f32_16x16x32_bf16 a[152:155], v[248:251], v[32:35], a[152:155]
    v_add_f32 v79, v79, v101
    v_mfma_f32_16x16x32_bf16 a[156:159], v[248:251], v[36:39], a[156:159]
    s_waitcnt vmcnt(6)
    ds_read2st64_b64 v[48:51], v56 offset0:32 offset1:34
    v_add_f32 v76, v76, v102
    v_add_f32 v77, v77, v103
    v_mfma_f32_16x16x32_bf16 a[160:163], v[252:255], v[32:35], a[160:163]
    ds_read2st64_b64 v[52:55], v57 offset0:32 offset1:34
    v_add_f32 v78, v78, v104
    v_mfma_f32_16x16x32_bf16 a[164:167], v[252:255], v[36:39], a[164:167]
    v_add_f32 v79, v79, v105
    v_mfma_f32_16x16x32_bf16 a[168:171], a[0:3], v[32:35], a[168:171]
    v_add_f32 v76, v76, v106
    v_add_f32 v77, v77, v107
    v_mfma_f32_16x16x32_bf16 a[172:175], a[0:3], v[36:39], a[172:175]
    v_add_f32 v78, v78, v108
    v_mfma_f32_16x16x32_bf16 a[176:179], a[4:7], v[32:35], a[176:179]
    v_add_f32 v79, v79, v109
    v_mfma_f32_16x16x32_bf16 a[180:183], a[4:7], v[36:39], a[180:183]
    v_lshlrev_b32 v98, 16, v26
    v_and_b32 v99, 0xffff0000, v26
    v_mfma_f32_16x16x32_bf16 a[184:187], a[8:11], v[32:35], a[184:187]
    v_lshlrev_b32 v100, 16, v27
    v_mfma_f32_16x16x32_bf16 a[188:191], a[8:11], v[36:39], a[188:191]
    v_and_b32 v101, 0xffff0000, v27
    s_waitcnt lgkmcnt(2)
    v_mfma_f32_16x16x32_bf16 a[152:155], a[12:15], v[40:43], a[152:155]
    v_fmac_f32 v98, v76, v4
    v_fmac_f32 v99, v77, v5
    v_mfma_f32_16x16x32_bf16 a[156:159], a[12:15], v[44:47], a[156:159]
    s_waitcnt vmcnt(4)
    ds_read2st64_b64 v[32:35], v56 offset0:36 offset1:38
    v_fmac_f32 v100, v78, v6
    v_mfma_f32_16x16x32_bf16 a[160:163], a[16:19], v[40:43], a[160:163]
    ds_read2st64_b64 v[36:39], v57 offset0:36 offset1:38
    v_fmac_f32 v101, v79, v7
    v_mfma_f32_16x16x32_bf16 a[164:167], a[16:19], v[44:47], a[164:167]
    v_cvt_pk_bf16_f32 v82, v98, v99
    v_cvt_pk_bf16_f32 v83, v100, v101
    v_mfma_f32_16x16x32_bf16 a[168:171], a[20:23], v[40:43], a[168:171]
    v_permlane16_swap_b32 v80, v82
    v_mfma_f32_16x16x32_bf16 a[172:175], a[20:23], v[44:47], a[172:175]
    v_permlane16_swap_b32 v81, v83
    v_mfma_f32_16x16x32_bf16 a[176:179], a[24:27], v[40:43], a[176:179]
    global_store_dwordx4 v30, v[80:83], s[6:7] sc1
    v_mfma_f32_16x16x32_bf16 a[180:183], a[24:27], v[44:47], a[180:183]
    v_add_f32 v110, v110, v114
    v_mfma_f32_16x16x32_bf16 a[184:187], a[28:31], v[40:43], a[184:187]
    v_add_f32 v111, v111, v115
    v_mfma_f32_16x16x32_bf16 a[188:191], a[28:31], v[44:47], a[188:191]
    v_add_f32 v112, v112, v116
    v_add_f32 v113, v113, v117
    s_waitcnt lgkmcnt(2)
    v_mfma_f32_16x16x32_bf16 a[152:155], a[32:35], v[48:51], a[152:155]
    v_add_f32 v110, v110, v118
    v_mfma_f32_16x16x32_bf16 a[156:159], a[32:35], v[52:55], a[156:159]
    s_waitcnt vmcnt(3)
    ds_read2st64_b64 v[40:43], v56 offset0:40 offset1:42
    v_add_f32 v111, v111, v119
    v_mfma_f32_16x16x32_bf16 a[160:163], a[36:39], v[48:51], a[160:163]
    ds_read2st64_b64 v[44:47], v57 offset0:40 offset1:42
    v_add_f32 v112, v112, v120
    v_add_f32 v113, v113, v121
    v_mfma_f32_16x16x32_bf16 a[164:167], a[36:39], v[52:55], a[164:167]
    v_add_f32 v110, v110, v122
    v_mfma_f32_16x16x32_bf16 a[168:171], a[40:43], v[48:51], a[168:171]
    v_add_f32 v111, v111, v123
    v_mfma_f32_16x16x32_bf16 a[172:175], a[40:43], v[52:55], a[172:175]
    v_add_f32 v112, v112, v124
    v_add_f32 v113, v113, v125
    v_mfma_f32_16x16x32_bf16 a[176:179], a[44:47], v[48:51], a[176:179]
    v_lshlrev_b32 v114, 16, v28
    v_mfma_f32_16x16x32_bf16 a[180:183], a[44:47], v[52:55], a[180:183]
    v_and_b32 v115, 0xffff0000, v28
    v_mfma_f32_16x16x32_bf16 a[184:187], a[48:51], v[48:51], a[184:187]
    v_lshlrev_b32 v116, 16, v29
    v_and_b32 v117, 0xffff0000, v29
    v_mfma_f32_16x16x32_bf16 a[188:191], a[48:51], v[52:55], a[188:191]
    v_fmac_f32 v114, v110, v8
    s_waitcnt lgkmcnt(2)
    v_mfma_f32_16x16x32_bf16 a[152:155], a[52:55], v[32:35], a[152:155]
    v_fmac_f32 v115, v111, v9
    v_mfma_f32_16x16x32_bf16 a[156:159], a[52:55], v[36:39], a[156:159]
    s_waitcnt vmcnt(1)
    ds_read2st64_b64 v[48:51], v56 offset0:44 offset1:46
    v_fmac_f32 v116, v112, v10
    v_fmac_f32 v117, v113, v11
    v_mfma_f32_16x16x32_bf16 a[160:163], a[56:59], v[32:35], a[160:163]
    ds_read2st64_b64 v[52:55], v57 offset0:44 offset1:46
    v_cvt_pk_bf16_f32 v84, v114, v115
    v_mfma_f32_16x16x32_bf16 a[164:167], a[56:59], v[36:39], a[164:167]
    ds_read_b64_tr_b16 v[60:61], v20 offset:5120
    v_cvt_pk_bf16_f32 v85, v116, v117
    v_mfma_f32_16x16x32_bf16 a[168:171], a[60:63], v[32:35], a[168:171]
    ds_read_b64_tr_b16 v[62:63], v21 offset:5120
    global_store_dwordx2 v31, v[84:85], s[6:7] sc1
    v_mfma_f32_16x16x32_bf16 a[172:175], a[60:63], v[36:39], a[172:175]
    ds_read_b64_tr_b16 v[64:65], v22 offset:9216
    v_mfma_f32_16x16x32_bf16 a[176:179], a[64:67], v[32:35], a[176:179]
    v_mfma_f32_16x16x32_bf16 a[180:183], a[64:67], v[36:39], a[180:183]
    v_mfma_f32_16x16x32_bf16 a[184:187], a[68:71], v[32:35], a[184:187]
    v_mfma_f32_16x16x32_bf16 a[188:191], a[68:71], v[36:39], a[188:191]
    s_waitcnt lgkmcnt(5)
    v_mfma_f32_16x16x32_bf16 a[152:155], a[72:75], v[40:43], a[152:155]
    s_barrier
    v_mfma_f32_16x16x32_bf16 a[156:159], a[72:75], v[44:47], a[156:159]
    v_mfma_f32_16x16x32_bf16 a[160:163], a[76:79], v[40:43], a[160:163]
    v_mfma_f32_16x16x32_bf16 a[164:167], a[76:79], v[44:47], a[164:167]
    v_mfma_f32_16x16x32_bf16 a[168:171], a[80:83], v[40:43], a[168:171]
    v_mfma_f32_16x16x32_bf16 a[172:175], a[80:83], v[44:47], a[172:175]
    v_mfma_f32_16x16x32_bf16 a[176:179], a[84:87], v[40:43], a[176:179]
    v_mfma_f32_16x16x32_bf16 a[180:183], a[84:87], v[44:47], a[180:183]
    v_mfma_f32_16x16x32_bf16 a[184:187], a[88:91], v[40:43], a[184:187]
    v_mfma_f32_16x16x32_bf16 a[188:191], a[88:91], v[44:47], a[188:191]
    s_waitcnt lgkmcnt(3)
    v_mfma_f32_16x16x32_bf16 a[160:163], a[96:99], v[48:51], a[160:163]
    v_mfma_f32_16x16x32_bf16 a[164:167], a[96:99], v[52:55], a[164:167]
    v_mfma_f32_16x16x32_bf16 a[168:171], a[100:103], v[48:51], a[168:171]
    v_mfma_f32_16x16x32_bf16 a[172:175], a[100:103], v[52:55], a[172:175]
    v_mfma_f32_16x16x32_bf16 a[176:179], a[104:107], v[48:51], a[176:179]
    v_mfma_f32_16x16x32_bf16 a[180:183], a[104:107], v[52:55], a[180:183]
    s_nop 2
    ds_write_b128 v17, a[160:163] offset:2048
    v_mfma_f32_16x16x32_bf16 a[184:187], a[108:111], v[48:51], a[184:187]
    ds_write_b128 v17, a[164:167] offset:5120
    v_mfma_f32_16x16x32_bf16 a[188:191], a[108:111], v[52:55], a[188:191]
    ds_write_b128 v18, a[168:171] offset:1024
    v_mfma_f32_16x16x32_bf16 a[152:155], a[92:95], v[48:51], a[152:155]
    ds_write_b128 v18, a[172:175] offset:4096
    v_mfma_f32_16x16x32_bf16 a[156:159], a[92:95], v[52:55], a[156:159]
    ds_write_b128 v19, a[176:179] offset:0
    ds_write_b128 v19, a[180:183] offset:3072
    ds_write_b128 v16, a[184:187] offset:0
    s_nop 0
    ds_write_b128 v16, a[188:191] offset:4096
    s_nop 0
    v_accvgpr_read_b32 v72, a152
    v_accvgpr_read_b32 v73, a153
    v_accvgpr_read_b32 v74, a154
    v_accvgpr_read_b32 v75, a155
    v_accvgpr_read_b32 v76, a156
    v_accvgpr_read_b32 v77, a157
    v_accvgpr_read_b32 v78, a158
    v_accvgpr_read_b32 v79, a159
    s_waitcnt lgkmcnt(0)
    s_barrier
    ds_read_b128 v[86:89], v23 offset:0
    ds_read_b128 v[90:93], v23 offset:1024
    ds_read_b128 v[94:97], v23 offset:2048
    ds_read_b128 v[98:101], v23 offset:3072
    ds_read_b128 v[102:105], v23 offset:4096
    ds_read_b128 v[106:109], v23 offset:5120
    ds_read_b128 v[110:113], v3 offset:0
    ds_read_b128 v[114:117], v3 offset:1024
    ds_read_b128 v[118:121], v3 offset:2048
    ds_read_b128 v[122:125], v3 offset:3072
    s_add_u32 s6, s44, 1310720
    s_addc_u32 s7, s45, 0
    s_waitcnt lgkmcnt(7)
    v_pk_add_f32 v[72:73], v[72:73], v[86:87]
    v_pk_add_f32 v[74:75], v[74:75], v[88:89]
    v_pk_add_f32 v[72:73], v[72:73], v[90:91]
    v_pk_add_f32 v[74:75], v[74:75], v[92:93]
    v_pk_add_f32 v[72:73], v[72:73], v[94:95]
    v_pk_add_f32 v[74:75], v[74:75], v[96:97]
    v_lshlrev_b32 v86, 16, v60
    v_and_b32 v87, 0xffff0000, v60
    v_lshlrev_b32_e64 v88, 16, v61
    v_and_b32 v89, 0xffff0000, v61
    v_pk_fma_f32 v[72:73], v[72:73], v[4:5], v[86:87]
    v_pk_fma_f32 v[74:75], v[74:75], v[6:7], v[88:89]
    v_cvt_pk_bf16_f32 v80, v72, v73
    v_cvt_pk_bf16_f32 v81, v74, v75
    s_waitcnt lgkmcnt(4)
    v_pk_add_f32 v[76:77], v[76:77], v[98:99]
    v_pk_add_f32 v[78:79], v[78:79], v[100:101]
    v_pk_add_f32 v[76:77], v[76:77], v[102:103]
    v_pk_add_f32 v[78:79], v[78:79], v[104:105]
    v_pk_add_f32 v[76:77], v[76:77], v[106:107]
    v_pk_add_f32 v[78:79], v[78:79], v[108:109]
    v_lshlrev_b32 v98, 16, v62
    v_and_b32 v99, 0xffff0000, v62
    v_lshlrev_b32 v100, 16, v63
    v_and_b32 v101, 0xffff0000, v63
    v_pk_fma_f32 v[76:77], v[76:77], v[4:5], v[98:99]
    v_pk_fma_f32 v[78:79], v[78:79], v[6:7], v[100:101]
    v_cvt_pk_bf16_f32 v82, v76, v77
    v_cvt_pk_bf16_f32 v83, v78, v79
    s_nop 0
    v_permlane16_swap_b32 v80, v82
    v_permlane16_swap_b32 v81, v83
    global_store_dwordx4 v30, v[80:83], s[6:7]
    s_waitcnt lgkmcnt(0)
    v_pk_add_f32 v[110:111], v[110:111], v[114:115]
    v_pk_add_f32 v[112:113], v[112:113], v[116:117]
    v_pk_add_f32 v[110:111], v[110:111], v[118:119]
    v_pk_add_f32 v[112:113], v[112:113], v[120:121]
    v_pk_add_f32 v[110:111], v[110:111], v[122:123]
    v_pk_add_f32 v[112:113], v[112:113], v[124:125]
    v_lshlrev_b32 v114, 16, v64
    v_and_b32 v115, 0xffff0000, v64
    v_lshlrev_b32 v116, 16, v65
    v_and_b32 v117, 0xffff0000, v65
    v_pk_fma_f32 v[110:111], v[110:111], v[8:9], v[114:115]
    v_pk_fma_f32 v[112:113], v[112:113], v[10:11], v[116:117]
    v_cvt_pk_bf16_f32 v84, v110, v111
    v_cvt_pk_bf16_f32 v85, v112, v113
    global_store_dwordx2 v31, v[84:85], s[6:7]
    s_or_b32 s6, s2, s3
    s_cmp_lg_u32 s6, 0
    s_cbranch_scc1 L_ep_73
    v_mov_b32 v20, 0
    v_mov_b32 v21, s50
    s_mov_b64 exec, 1
    global_store_dword v20, v21, s[48:49] sc1
    s_mov_b64 exec, -1
L_ep_73:
L_FIN:
L_EXIT:
    s_endpgm
L_cfr_3:
    s_mov_b32 s90, 0
L_cf_1:
    s_sleep 2
    global_load_dword v125, v250, s[48:49] sc1
    s_add_u32 s90, s90, 1
    s_waitcnt vmcnt(0)
    v_cmp_ne_u32 vcc, s50, v125
    s_nop 0
    s_cbranch_vccz L_cfd_2
    s_cmp_gt_u32 s90, 65536
    s_cbranch_scc1 L_cfd_2
    s_branch L_cf_1
L_cfr_6:
    s_mov_b32 s90, 0
L_cf_4:
    s_sleep 2
    global_load_dword v124, v245, s[48:49] sc1
    s_add_u32 s90, s90, 1
    s_waitcnt vmcnt(0)
    v_cmp_ne_u32 vcc, s50, v124
    s_nop 0
    s_cbranch_vccz L_cfd_5
    s_cmp_gt_u32 s90, 65536
    s_cbranch_scc1 L_cfd_5
    s_branch L_cf_4
L_cfr_13:
    s_mov_b32 s90, 0
L_cf_11:
    s_sleep 2
    global_load_dwordx2 v[128:129], v207, s[48:49] sc1
    s_add_u32 s90, s90, 1
    s_waitcnt vmcnt(0)
    v_cmp_ne_u32 vcc, s50, v129
    s_nop 0
    s_cbranch_vccz L_cfd_12
    s_cmp_gt_u32 s90, 65536
    s_cbranch_scc1 L_cfd_12
    s_branch L_cf_11
L_cfr_16:
    s_mov_b32 s90, 0
L_cf_14:
    s_sleep 2
    global_load_dwordx2 v[130:131], v208, s[48:49] sc1
    s_add_u32 s90, s90, 1
    s_waitcnt vmcnt(0)
    v_cmp_ne_u32 vcc, s50, v131
    s_nop 0
    s_cbranch_vccz L_cfd_15
    s_cmp_gt_u32 s90, 65536
    s_cbranch_scc1 L_cfd_15
    s_branch L_cf_14
L_cfr_19:
    s_mov_b32 s90, 0
L_cf_17:
    s_sleep 2
    global_load_dword v125, v250, s[48:49] sc1
    s_add_u32 s90, s90, 1
    s_waitcnt vmcnt(0)
    v_cmp_ne_u32 vcc, s50, v125
    s_nop 0
    s_cbranch_vccz L_cfd_18
    s_cmp_gt_u32 s90, 65536
    s_cbranch_scc1 L_cfd_18
    s_branch L_cf_17
L_cfr_22:
    s_mov_b32 s90, 0
L_cf_20:
    s_sleep 2
    global_load_dword v28, v29, s[48:49] sc1
    s_add_u32 s90, s90, 1
    s_waitcnt vmcnt(0)
    v_cmp_ne_u32 vcc, s50, v28
    s_nop 0
    s_cbranch_vccz L_cfd_21
    s_cmp_gt_u32 s90, 65536
    s_cbranch_scc1 L_cfd_21
    s_branch L_cf_20
L_cfr_25:
    s_mov_b32 s90, 0
L_cf_23:
    s_sleep 2
    global_load_dword v124, v245, s[48:49] sc1
    s_add_u32 s90, s90, 1
    s_waitcnt vmcnt(0)
    v_cmp_ne_u32 vcc, s50, v124
    s_nop 0
    s_cbranch_vccz L_cfd_24
    s_cmp_gt_u32 s90, 65536
    s_cbranch_scc1 L_cfd_24
    s_branch L_cf_23
L_cfr_38:
    s_mov_b32 s90, 0
L_cf_36:
    s_sleep 8
    global_load_dwordx2 v[64:65], v36, s[48:49] sc1
    global_load_dwordx2 v[66:67], v37, s[48:49] sc1
    global_load_dwordx2 v[68:69], v38, s[48:49] sc1
    global_load_dwordx2 v[70:71], v39, s[48:49] sc1
    s_add_u32 s90, s90, 1
    s_waitcnt vmcnt(0)
    v_bitop3_b32 v54, v65, v67, s50 bitop3:0x7e
    v_bitop3_b32 v55, v69, v71, s50 bitop3:0x7e
    v_or_b32 v54, v54, v55
    v_cmp_ne_u32 vcc, 0, v54
    s_nop 0
    s_cbranch_vccz L_cfd_37
    s_cmp_gt_u32 s90, 65536
    s_cbranch_scc1 L_cfd_37
    s_branch L_cf_36
L_cfr_41:
    s_mov_b32 s90, 0
L_cf_39:
    s_sleep 8
    global_load_dwordx2 v[72:73], v40, s[48:49] sc1
    global_load_dwordx2 v[74:75], v41, s[48:49] sc1
    global_load_dwordx2 v[76:77], v42, s[48:49] sc1
    global_load_dwordx2 v[78:79], v43, s[48:49] sc1
    s_add_u32 s90, s90, 1
    s_waitcnt vmcnt(0)
    v_bitop3_b32 v54, v73, v75, s50 bitop3:0x7e
    v_bitop3_b32 v55, v77, v79, s50 bitop3:0x7e
    v_or_b32 v54, v54, v55
    v_cmp_ne_u32 vcc, 0, v54
    s_nop 0
    s_cbranch_vccz L_cfd_40
    s_cmp_gt_u32 s90, 65536
    s_cbranch_scc1 L_cfd_40
    s_branch L_cf_39
L_cfr_44:
    s_mov_b32 s90, 0
L_cf_42:
    s_sleep 8
    global_load_dwordx2 v[80:81], v44, s[48:49] sc1
    global_load_dwordx2 v[82:83], v45, s[48:49] sc1
    global_load_dwordx2 v[84:85], v46, s[48:49] sc1
    global_load_dwordx2 v[86:87], v47, s[48:49] sc1
    s_add_u32 s90, s90, 1
    s_waitcnt vmcnt(0)
    v_bitop3_b32 v54, v81, v83, s50 bitop3:0x7e
    v_bitop3_b32 v55, v85, v87, s50 bitop3:0x7e
    v_or_b32 v54, v54, v55
    v_cmp_ne_u32 vcc, 0, v54
    s_nop 0
    s_cbranch_vccz L_cfd_43
    s_cmp_gt_u32 s90, 65536
    s_cbranch_scc1 L_cfd_43
    s_branch L_cf_42
L_cfr_47:
    s_mov_b32 s90, 0
L_cf_45:
    s_sleep 8
    global_load_dwordx2 v[88:89], v48, s[48:49] sc1
    global_load_dwordx2 v[90:91], v49, s[48:49] sc1
    global_load_dwordx2 v[92:93], v50, s[48:49] sc1
    global_load_dwordx2 v[94:95], v51, s[48:49] sc1
    s_add_u32 s90, s90, 1
    s_waitcnt vmcnt(0)
    v_bitop3_b32 v54, v89, v91, s50 bitop3:0x7e
    v_bitop3_b32 v55, v93, v95, s50 bitop3:0x7e
    v_or_b32 v54, v54, v55
    v_cmp_ne_u32 vcc, 0, v54
    s_nop 0
    s_cbranch_vccz L_cfd_46
    s_cmp_gt_u32 s90, 65536
    s_cbranch_scc1 L_cfd_46
    s_branch L_cf_45
L_cfr_58:
    s_mov_b32 s90, 0
L_cf_56:
    s_sleep 0
    global_load_dwordx4 v[96:99], v11, s[48:49] sc1
    s_add_u32 s90, s90, 1
    s_waitcnt vmcnt(0)
    v_cmp_ne_u32 vcc, s50, v98
    s_nop 0
    s_cbranch_vccz L_cfd_57
    s_cmp_gt_u32 s90, 65536
    s_cbranch_scc1 L_cfd_57
    s_branch L_cf_56
L_cfr_61:
    s_mov_b32 s90, 0
L_cf_59:
    s_sleep 2
    global_load_dword v112, v13, s[48:49] sc1
    s_add_u32 s90, s90, 1
    s_waitcnt vmcnt(0)
    v_cmp_ne_u32 vcc, s50, v112
    s_nop 0
    s_cbranch_vccz L_cfd_60
    s_cmp_gt_u32 s90, 65536
    s_cbranch_scc1 L_cfd_60
    s_branch L_cf_59
L_cfr_65:
    s_mov_b32 s90, 0
L_cf_63:
    s_sleep 0
    global_load_dwordx4 v[96:99], v11, s[48:49] sc1
    s_add_u32 s90, s90, 1
    s_waitcnt vmcnt(0)
    v_cmp_ne_u32 vcc, s50, v98
    s_nop 0
    s_cbranch_vccz L_cfd_64
    s_cmp_gt_u32 s90, 65536
    s_cbranch_scc1 L_cfd_64
    s_branch L_cf_63
L_cfr_68:
    s_mov_b32 s90, 0
L_cf_66:
    s_sleep 2
    global_load_dword v112, v15, s[48:49] sc1
    s_add_u32 s90, s90, 1
    s_waitcnt vmcnt(0)
    v_cmp_ne_u32 vcc, s50, v112
    s_nop 0
    s_cbranch_vccz L_cfd_67
    s_cmp_gt_u32 s90, 65536
    s_cbranch_scc1 L_cfd_67
    s_branch L_cf_66
L_cfr_72:
    s_mov_b32 s90, 0
L_cf_70:
    s_sleep 2
    global_load_dword v13, v15, s[48:49] sc1
    s_add_u32 s90, s90, 1
    s_waitcnt vmcnt(0)
    v_cmp_ne_u32 vcc, s50, v13
    s_nop 0
    s_cbranch_vccz L_cfd_71
    s_cmp_gt_u32 s90, 65536
    s_cbranch_scc1 L_cfd_71
    s_branch L_cf_70
L_CODE_END:
    s_endpgm
.section .rodata,"a"
.p2align 6
.amdhsa_kernel adaLN_cond__ssm_conv_s4__dense_activation_silu__prompt_kernel
  .amdhsa_next_free_vgpr 512
  .amdhsa_next_free_sgpr 102
  .amdhsa_accum_offset 256
  .amdhsa_group_segment_fixed_size 0
  .amdhsa_kernarg_size 136
  .amdhsa_user_sgpr_count 2
  .amdhsa_user_sgpr_kernarg_segment_ptr 1
  .amdhsa_system_sgpr_workgroup_id_x 1
.end_amdhsa_kernel
```
